```python
import torch

def _softmax(x, axis=-1):
    return torch.softmax(x, dim=axis)
def _gelu(x):
    return torch.nn.functional.gelu(x, approximate="tanh")
def _silu(x):
    return torch.nn.functional.silu(x)
def _sigmoid(x):
    return torch.sigmoid(x)
def _layernorm(x, axis=-1, eps=1e-5):
    m = x.mean(dim=axis, keepdim=True)
    v = x.var(dim=axis, keepdim=True, unbiased=False)
    return (x - m) / torch.sqrt(v + eps)
def _scatter_add(tgt, idx, src, axis=0):
    return tgt.clone().index_add_(axis, idx, src)
def _segment_sum(src, seg, n):
    out = torch.zeros((n,) + src.shape[1:], dtype=src.dtype)
    return out.index_add_(0, seg, src)
def _pad(x, pw):
    flat = tuple(v for pair in reversed(pw) for v in pair)
    return torch.nn.functional.pad(x, flat)

kernel_name = 'recurrent_scan__compressed_kv_cla__mixer_s_mlp__prompt'

def setup_inputs():

    _w = (lambda a: (lambda t: t.to(torch.bfloat16) if t.is_floating_point() else t)(torch.as_tensor(a)))
    def _A_setup():
        B, H, Sq, Sk, D, M = 1, 32, 2048, 2048, 128, 512
        Dc = 4 * D
        return {
            "x": _w((lambda *s: torch.randn(*s, dtype=torch.bfloat16) * 0.05)(B, Sq, M)),
            "c_kv": _w((lambda *s: torch.randn(*s, dtype=torch.bfloat16) * 0.2)(B, Sk, Dc)),
            "w_q": _w((lambda *s: torch.randn(*s, dtype=torch.bfloat16) * 3.2)(M, H, D) * (M ** -0.5)),
            "w_uk": _w((lambda *s: torch.randn(*s, dtype=torch.bfloat16) * 3.2)(Dc, H, D) * (Dc ** -0.5)),
            "w_uv": _w((lambda *s: torch.randn(*s, dtype=torch.bfloat16) * 0.2)(Dc, H, D) * (Dc ** -0.5)),
            "w_o": _w((lambda *s: torch.randn(*s, dtype=torch.bfloat16) * 0.2)(H, D, M) * ((H * D) ** -0.5)),
        }
    _A_in = _A_setup()

    def _B_setup():
        B, S, D, F = 1, 2048, 512, 1376
        return {
            "x":  _w((lambda *s: torch.randn(*s, dtype=torch.bfloat16) * 0.05)(B, S, D)),
            "w1": _w((lambda *s: torch.randn(*s, dtype=torch.bfloat16) * 3.2)(D, D) * (D ** -0.5)),
            "w2": _w((lambda *s: torch.randn(*s, dtype=torch.bfloat16) * 3.2)(D, D) * (D ** -0.5)),
            "w3": _w((lambda *s: torch.randn(*s, dtype=torch.bfloat16) * 3.2)(D, F) * (D ** -0.5)),
            "w4": _w((lambda *s: torch.randn(*s, dtype=torch.bfloat16) * 1.6)(F, D) * (F ** -0.5)),
        }
    _B_in = _B_setup()

    return {
        "A_x": _A_in["x"],
        "A_c_kv": _A_in["c_kv"],
        "A_w_q": _A_in["w_q"],
        "A_w_uk": _A_in["w_uk"],
        "A_w_uv": _A_in["w_uv"],
        "A_w_o": _A_in["w_o"],
        "B_x": _B_in["x"],
        "B_w1": _B_in["w1"],
        "B_w2": _B_in["w2"],
        "B_w3": _B_in["w3"],
        "B_w4": _B_in["w4"],
    }

def reference(A_x, A_c_kv, A_w_q, A_w_uk, A_w_uv, A_w_o, B_x, B_w1, B_w2, B_w3, B_w4):
    def _A_ref(x, c_kv, w_q, w_uk, w_uv, w_o):
        B, Sq, M = x.shape[0], x.shape[1], x.shape[2]
        Sk = c_kv.shape[1]
        H, D = w_q.shape[1], w_q.shape[2]
        q = torch.einsum("bqm,mhd->bhqd", x, w_q)
        k = torch.einsum("bkc,chd->bhkd", c_kv, w_uk)
        v = torch.einsum("bkc,chd->bhkd", c_kv, w_uv)
        scores = torch.einsum("bhqd,bhkd->bhqk", q, k) * (D ** -0.5)
        off = Sk - Sq
        qi = torch.arange(Sq)[:, None]
        kj = torch.arange(Sk)[None, :]
        cmask = kj <= (qi + off)
        scores = torch.where(cmask[None, None], scores, -1e9)
        p = _softmax(scores, axis=-1)
        ctx = torch.einsum("bhqk,bhkd->bhqd", p, v)
        return torch.einsum("bhqd,hdm->bqm", ctx, w_o)

    def _B_ref(x, w1, w2, w3, w4):
        B, S, D = x.shape
        h = _gelu(_layernorm(x, axis=-1) @ w1)
        c = D // 4
        g0 = _pad(h[:, :, 0*c:1*c], ((0, 0), (1, 0), (0, 0)))[:, :S, :]
        g1 = _pad(h[:, :, 1*c:2*c], ((0, 0), (0, 1), (0, 0)))[:, 1:, :]
        g2 = _pad(h[:, :, 2*c:3*c], ((0, 0), (2, 0), (0, 0)))[:, :S, :]
        g3 = _pad(h[:, :, 3*c:   ], ((0, 0), (0, 2), (0, 0)))[:, 2:, :]
        hs = torch.concatenate([g0, g1, g2, g3], axis=-1) @ w2
        x1 = x + hs
        h2 = _gelu(_layernorm(x1, axis=-1) @ w3) @ w4
        return x1 + h2

    x = A_x
    xn = _layernorm(x, axis=-1)
    s = _A_ref(xn, A_c_kv, A_w_q, A_w_uk, A_w_uv, A_w_o)
    g = _silu(_B_ref(xn, B_w1, B_w2, B_w3, B_w4))
    return x + s * g
```

```asm
; @launch kernel=main_kernel grid=(256,1,1) block=(512,1,1) lds=163840
; @launch kernel=out_kernel grid=(256,1,1) block=(512,1,1) lds=131072
.amdgcn_target "amdgcn-amd-amdhsa--gfx950"
.text
.globl main_kernel
.p2align 8
.type main_kernel,@function
main_kernel:
  s_cmp_ge_u32 s2, 256
  s_cbranch_scc1 main_kernel_done
  s_load_dwordx4 s[40:43], s[0:1], 0
  s_load_dwordx4 s[48:51], s[0:1], 56
  s_getpc_b64 s[6:7]
main_kernel_pc:
  s_bfe_u32 s4, s2, 0x20003
  s_mul_i32 s4, s4, (main_kernel_done - main_kernel_pc + 0x3fff) / 0x4000 * 0x1000
  s_mov_b32 s5, (main_kernel_done - main_kernel_pc + 0x3fff) / 0x4000 * 8
  v_mul_lo_u32 v254, v0, s5
  v_add_u32 v254, s4, v254
  v_and_b32 v254, -4, v254
  v_min_u32 v254, main_kernel_done - main_kernel_pc, v254
  global_load_dword v255, v254, s[6:7]
  s_load_dwordx4 s[44:47], s[0:1], 24
  s_load_dwordx4 s[56:59], s[0:1], 96
  s_load_dwordx2 s[52:53], s[0:1], 72
  s_load_dwordx2 s[54:55], s[0:1], 16
  v_lshrrev_b32 v1, 6, v0
  v_and_b32 v2, 63, v0
  v_lshlrev_b32 v20, 4, v2
  v_readfirstlane_b32 s20, v1
  s_and_b32 s28, s2, 7
  s_lshl_b32 s28, s28, 2
  s_bfe_u32 s22, s2, 0x20003
  s_add_u32 s28, s28, s22
  s_lshr_b32 s29, s2, 5
  s_and_b32 s30, s20, 1
  s_lshr_b32 s31, s20, 1
  s_lshl_b32 s32, s28, 1
  s_add_u32 s32, s32, s30
  s_lshl_b32 s33, s32, 15
  s_lshl_b32 s22, s29, 12
  s_add_u32 s33, s33, s22
  s_lshl_b32 s22, s31, 10
  s_add_u32 s33, s33, s22
  v_and_b32 v21, 31, v2
  v_lshrrev_b32 v22, 5, v2
  v_lshrrev_b32 v23, 3, v2
  v_lshlrev_b32 v23, 10, v23
  v_bfe_u32 v5, v2, 4, 1
  v_lshlrev_b32 v5, 2, v5
  v_and_b32 v6, 7, v2
  v_xor_b32 v5, v5, v6
  v_lshl_add_u32 v23, v5, 4, v23
  v_lshlrev_b32 v7, 10, v21
  v_lshl_add_u32 v8, v22, 3, v7
  v_lshl_add_u32 v7, v22, 4, v7
  s_waitcnt lgkmcnt(0)
  s_mov_b32 s64, s40
  s_mov_b32 s65, s41
  s_mov_b32 s66, 0x200000
  s_mov_b32 s67, 0x00020000
  s_mov_b32 s68, s48
  s_mov_b32 s69, s49
  s_mov_b32 s70, 0x80000
  s_mov_b32 s71, 0x00020000
  s_lshl_b32 s22, s32, 15
  s_lshl_b32 s23, s31, 8
  s_add_u32 s22, s22, s23
  v_lshrrev_b32 v60, 4, v2
  v_and_b32 v61, 15, v2
  v_xor_b32 v61, v60, v61
  v_lshlrev_b32 v60, 10, v60
  v_lshl_add_u32 v60, v61, 4, v60
  v_xor_b32 v61, 64, v60
  v_xor_b32 v62, 128, v60
  v_xor_b32 v63, 192, v60
  s_lshl_b32 s23, s20, 11
  s_add_u32 m0, s23, 0
  s_nop 0
  buffer_load_dwordx4 v60, s[64:67], s22 offen lds
  s_add_u32 s22, s22, 4096
  s_add_u32 m0, s23, 1024
  s_nop 0
  buffer_load_dwordx4 v61, s[64:67], s22 offen lds
  s_add_u32 s22, s22, 4096
  s_add_u32 m0, s23, 16384
  s_nop 0
  buffer_load_dwordx4 v62, s[64:67], s22 offen lds
  s_add_u32 s22, s22, 4096
  s_add_u32 m0, s23, 17408
  s_nop 0
  buffer_load_dwordx4 v63, s[64:67], s22 offen lds
  s_add_u32 s22, s22, 4096
  s_add_u32 m0, s23, 32768
  s_nop 0
  buffer_load_dwordx4 v60, s[64:67], s22 offen lds
  s_add_u32 s22, s22, 4096
  s_add_u32 m0, s23, 33792
  s_nop 0
  buffer_load_dwordx4 v61, s[64:67], s22 offen lds
  s_add_u32 s22, s22, 4096
  s_add_u32 m0, s23, 49152
  s_nop 0
  buffer_load_dwordx4 v62, s[64:67], s22 offen lds
  s_add_u32 s22, s22, 4096
  s_add_u32 m0, s23, 50176
  s_nop 0
  buffer_load_dwordx4 v63, s[64:67], s22 offen lds
  v_lshrrev_b32 v235, 4, v21
  v_lshlrev_b32 v235, 15, v235
  v_bfe_u32 v236, v21, 3, 1
  v_lshl_add_u32 v235, v236, 14, v235
  v_and_b32 v236, 7, v21
  v_lshl_add_u32 v235, v236, 8, v235
  v_and_b32 v236, 15, v21
  v_xor_b32 v236, v22, v236
  v_lshl_add_u32 v235, v236, 4, v235
  v_add_u32 v235, s23, v235
  v_xor_b32 v236, 32, v235
  v_xor_b32 v237, 64, v235
  v_xor_b32 v238, 96, v235
  v_xor_b32 v239, 128, v235
  v_xor_b32 v240, 160, v235
  v_xor_b32 v241, 192, v235
  v_xor_b32 v242, 224, v235
  s_lshl_b32 s22, s20, 16
  s_lshl_b32 s23, s29, 7
  s_add_u32 s22, s22, s23
  s_lshl_b32 s23, s20, 13
  s_add_u32 s23, s23, 0x10000
  s_cmp_ge_u32 s20, 4
  s_cselect_b32 s34, 0x8000, 0
  s_add_u32 m0, s23, s34
  s_nop 0
  buffer_load_dwordx4 v23, s[68:71], s22 offen lds
  s_add_u32 m0, m0, 1024
  s_add_u32 s22, s22, 8192
  s_nop 0
  buffer_load_dwordx4 v23, s[68:71], s22 offen lds
  s_add_u32 m0, m0, 1024
  s_add_u32 s22, s22, 8192
  s_nop 0
  buffer_load_dwordx4 v23, s[68:71], s22 offen lds
  s_add_u32 m0, m0, 1024
  s_add_u32 s22, s22, 8192
  s_nop 0
  buffer_load_dwordx4 v23, s[68:71], s22 offen lds
  s_add_u32 m0, m0, 1024
  s_add_u32 s22, s22, 8192
  s_nop 0
  buffer_load_dwordx4 v23, s[68:71], s22 offen lds
  s_add_u32 m0, m0, 1024
  s_add_u32 s22, s22, 8192
  s_nop 0
  buffer_load_dwordx4 v23, s[68:71], s22 offen lds
  s_add_u32 m0, m0, 1024
  s_add_u32 s22, s22, 8192
  s_nop 0
  buffer_load_dwordx4 v23, s[68:71], s22 offen lds
  s_add_u32 m0, m0, 1024
  s_add_u32 s22, s22, 8192
  s_nop 0
  buffer_load_dwordx4 v23, s[68:71], s22 offen lds
  s_lshl_b32 s22, s32, 15
  s_lshl_b32 s23, s29, 7
  s_add_u32 s22, s22, s23
  s_lshl_b32 s23, s31, 5
  s_add_u32 s22, s22, s23
  s_lshl_b32 s22, s28, 16
  s_lshl_b32 s23, s20, 13
  s_add_u32 s22, s22, s23
  s_lshl_b32 s23, s29, 7
  s_add_u32 s22, s22, s23
  v_lshrrev_b32 v7, 3, v2
  v_and_b32 v8, 7, v2
  v_xor_b32 v8, v7, v8
  v_lshlrev_b32 v7, 10, v7
  v_lshl_add_u32 v8, v8, 4, v7
  s_lshl_b32 s23, s20, 10
  s_add_u32 m0, s23, 118784
  s_nop 0
  buffer_load_dwordx4 v8, s[64:67], s22 offen lds
  s_lshl_b32 s22, s31, 1
  v_and_b32 v243, 7, v21
  v_xor_b32 v243, s22, v243
  v_lshlrev_b32 v243, 4, v243
  v_lshl_add_u32 v243, v21, 7, v243
  v_lshl_add_u32 v243, v22, 3, v243
  s_lshl_b32 s22, s30, 12
  s_add_u32 s22, s22, 118784
  v_add_u32 v243, s22, v243
  v_xor_b32 v244, 16, v243
  s_lshr_b32 s36, s2, 5
  s_and_b32 s37, s2, 31
  s_bfe_u32 s21, s20, 0x10001
  s_mov_b32 s8, s42
  s_mov_b32 s9, s43
  s_mov_b32 s10, 0x200000
  s_mov_b32 s11, 0x00020000
  s_cmp_ge_u32 s20, 4
  s_cselect_b32 s4, s46, s44
  s_cselect_b32 s5, s47, s45
  s_mov_b32 s12, s4
  s_mov_b32 s13, s5
  s_mov_b32 s14, 0x400000
  s_mov_b32 s15, 0x00020000
  s_mov_b32 s16, s58
  s_mov_b32 s17, s59
  s_mov_b32 s18, 0x2000000
  s_mov_b32 s19, 0x00020000
  v_lshrrev_b32 v7, 3, v2
  v_lshlrev_b32 v7, 10, v7
  v_and_b32 v8, 7, v2
  v_lshrrev_b32 v9, 4, v2
  v_xor_b32 v8, v8, v9
  v_lshl_add_u32 v3, v8, 4, v7
  v_xor_b32 v8, 4, v8
  v_lshl_add_u32 v4, v8, 4, v7
  v_add_u32 v4, 7168, v4
  v_lshrrev_b32 v7, 4, v2
  v_and_b32 v8, 15, v2
  v_lshlrev_b32 v9, 2, v7
  v_xor_b32 v8, v9, v8
  v_lshlrev_b32 v7, 13, v7
  v_lshl_add_u32 v5, v8, 4, v7
  v_add_u32 v6, 31744, v5
  s_lshl_b32 s26, s20, 11
  s_lshl_b32 s24, s36, 18
  s_lshl_b32 s22, s20, 14
  s_add_u32 s24, s24, s22
  s_lshl_b32 s25, s37, 8
  s_and_b32 s22, s20, 3
  s_lshl_b32 s22, s22, 16
  s_add_u32 s25, s25, s22
  s_lshl_b32 s35, s2, 3
  s_add_u32 s35, s35, s20
  v_lshlrev_b32 v1, 7, v2
  s_mov_b32 s60, s50
  s_mov_b32 s61, s51
  s_mov_b32 s62, 0x80000
  s_mov_b32 s63, 0x00020000
  s_mov_b32 s38, s35
  s_sub_u32 s39, s35, 64
  s_cmp_ge_u32 s35, 64
  s_cselect_b32 s60, s52, s60
  s_cselect_b32 s61, s53, s61
  s_cselect_b32 s62, 0x158000, s62
  s_cselect_b32 s38, s39, s38
  s_sub_u32 s39, s35, 236
  s_cmp_ge_u32 s35, 236
  s_cselect_b32 s60, s54, s60
  s_cselect_b32 s61, s55, s61
  s_cselect_b32 s62, 0x400000, s62
  s_cselect_b32 s38, s39, s38
  s_lshl_b32 s38, s38, 13
  s_mov_b32 s43, s37
  s_mov_b32 s44, s36
  s_lshl_b32 s22, s44, 2
  s_sub_u32 s23, 60, s22
  s_add_u32 s23, s23, s20
  s_add_u32 s40, s22, 7
  s_sub_u32 s40, s40, s20
  s_cmp_lt_u32 s20, 4
  s_cselect_b32 s40, s23, s40
  s_lshl_b32 s41, s40, 15
  s_lshl_b32 s42, s20, 10
  s_lshl_b32 s45, s20, 15
  s_lshl_b32 s22, s43, 8
  s_add_u32 s45, s45, s22
  v_bfe_u32 v9, v2, 1, 3
  v_xor_b32 v9, v9, v22
  s_lshr_b32 s22, s20, 2
  s_lshl_b32 s22, s22, 14
  v_lshlrev_b32 v7, 7, v21
  v_add_u32 v7, s22, v7
  v_xor_b32 v8, 0, v9
  v_lshl_add_u32 v10, v8, 4, v7
  v_add_u32 v14, 0x10000, v10
  v_xor_b32 v8, 2, v9
  v_lshl_add_u32 v11, v8, 4, v7
  v_add_u32 v15, 0x10000, v11
  v_xor_b32 v8, 4, v9
  v_lshl_add_u32 v12, v8, 4, v7
  v_add_u32 v16, 0x10000, v12
  v_xor_b32 v8, 6, v9
  v_lshl_add_u32 v13, v8, 4, v7
  v_add_u32 v17, 0x10000, v13
  v_bfe_u32 v7, v2, 2, 2
  v_lshl_add_u32 v8, v22, 3, v7
  v_lshlrev_b32 v8, 8, v8
  v_bfe_u32 v9, v2, 4, 1
  v_lshl_add_u32 v8, v9, 5, v8
  v_and_b32 v9, 3, v2
  v_lshl_add_u32 v8, v9, 3, v8
  s_lshl_b32 s22, s21, 13
  s_add_u32 s22, s22, 98304
  v_add_u32 v8, s22, v8
  s_and_b32 s22, s20, 1
  s_lshl_b32 s22, s22, 1
  s_add_u32 s23, s22, 0
  v_xor_b32 v9, s23, v7
  v_lshl_add_u32 v18, v9, 6, v8
  s_add_u32 s23, s22, 1
  v_xor_b32 v9, s23, v7
  v_lshl_add_u32 v19, v9, 6, v8
  s_lshl_b32 s27, s37, 6
  s_lshl_b32 s23, s36, 3
  s_add_u32 s27, s27, s23
  s_lshr_b32 s23, s20, 2
  s_lshl_b32 s23, s23, 2
  s_add_u32 s27, s27, s23
  s_lshl_b32 s27, s27, 4
  s_lshl_b32 s23, s21, 3
  s_add_u32 s27, s27, s23
  s_and_b32 s22, s20, 1
  s_lshl_b32 s22, s22, 2
  s_add_u32 s27, s27, s22
  s_lshl_b32 s27, s27, 10
  s_add_u32 s72, s58, 0x3400000
  s_addc_u32 s73, s59, 0
  s_mov_b32 s74, 0x200000
  s_mov_b32 s75, 0x00020000
  s_add_u32 s76, s58, 0x2000000
  s_addc_u32 s77, s59, 0
  s_mov_b32 s78, 0x200000
  s_mov_b32 s79, 0x00020000
  s_mov_b32 s80, s56
  s_mov_b32 s81, s57
  s_mov_b32 s82, 0x100
  s_mov_b32 s83, 0x00020000
  s_add_u32 s84, s58, 0x3600000
  s_addc_u32 s85, s59, 0
  s_mov_b32 s86, 0x200000
  s_mov_b32 s87, 0x00020000
  s_add_u32 s88, s58, 0x2220000
  s_addc_u32 s89, s59, 0
  s_mov_b32 s90, 0x20000
  s_mov_b32 s91, 0x00020000
  s_add_u32 s92, s58, 0x3800000
  s_addc_u32 s93, s59, 0
  s_mov_b32 s94, 0x560000
  s_mov_b32 s95, 0x00020000
  s_lshl_b32 s22, s31, 14
  s_add_u32 s22, s22, 0x10000
  s_cmp_ge_u32 s31, 2
  s_cselect_b32 s34, 0x8000, 0
  s_add_u32 s22, s22, s34
  v_bfe_u32 v62, v2, 2, 2
  v_lshl_add_u32 v62, v22, 3, v62
  v_lshlrev_b32 v62, 7, v62
  v_bfe_u32 v63, v2, 4, 1
  v_lshl_add_u32 v62, v63, 5, v62
  v_and_b32 v63, 3, v2
  v_lshl_add_u32 v62, v63, 3, v62
  v_add_u32 v62, s22, v62
  v_bfe_u32 v63, v2, 3, 1
  v_xor_b32 v63, s30, v63
  v_lshl_add_u32 v60, v63, 6, v62
  v_xor_b32 v63, 1, v63
  v_lshl_add_u32 v61, v63, 6, v62
  v_mov_b32 v160, 0x3f803f80
  v_mov_b32 v161, 0x3f803f80
  v_mov_b32 v162, 0x3f803f80
  v_mov_b32 v163, 0x3f803f80
  v_mov_b32 v224, 0
  v_mov_b32 v225, 0
  v_mov_b32 v226, 0xc0135761
  v_mov_b32 v227, 0xbdd2d3e8
  s_mul_i32 s22, s30, 0x10000
  s_add_u32 s22, s22, 0x10000
  s_lshl_b32 s23, s31, 11
  s_add_u32 s23, s23, s22
  s_lshl_b32 s34, s30, 14
  s_add_u32 s4, s23, s34
  v_add_u32 v228, s4, v20
  s_xor_b32 s34, s34, 0x4000
  s_add_u32 s4, s23, s34
  v_add_u32 v229, s4, v20
  s_lshl_b32 s23, s31, 13
  s_add_u32 s23, s23, s22
  v_add_u32 v230, s23, v20
  s_waitcnt vmcnt(9)
  ds_read_b128 v[128:131], v235
  ds_read_b128 v[132:135], v236
  ds_read_b128 v[136:139], v237
  ds_read_b128 v[140:143], v238
  ds_read_b128 v[144:147], v239
  ds_read_b128 v[148:151], v240
  ds_read_b128 v[152:155], v241
  ds_read_b128 v[156:159], v242
  s_waitcnt vmcnt(0)
  s_barrier
  ds_read_b64 v[56:57], v243
  ds_read_b64 v[58:59], v244
  s_mov_b32 s64, s54
  s_mov_b32 s65, s55
  s_mov_b32 s66, 0x400000
  s_mov_b32 s67, 0x00020000
  ds_read_b64_tr_b16 v[64:65], v60 offset:0
  ds_read_b64_tr_b16 v[66:67], v60 offset:512
  ds_read_b64_tr_b16 v[68:69], v61 offset:0
  ds_read_b64_tr_b16 v[70:71], v61 offset:512
  ds_read_b64_tr_b16 v[72:73], v60 offset:2048
  ds_read_b64_tr_b16 v[74:75], v60 offset:2560
  ds_read_b64_tr_b16 v[76:77], v61 offset:2048
  ds_read_b64_tr_b16 v[78:79], v61 offset:2560
  ds_read_b64_tr_b16 v[80:81], v60 offset:4096
  ds_read_b64_tr_b16 v[82:83], v60 offset:4608
  ds_read_b64_tr_b16 v[84:85], v61 offset:4096
  ds_read_b64_tr_b16 v[86:87], v61 offset:4608
  s_waitcnt lgkmcnt(8)
  v_mfma_f32_32x32x16_bf16 v[176:191], v[64:67], v[128:131], 0
  v_dot2c_f32_bf16 v224, v128, v160
  v_dot2c_f32_bf16 v225, v128, v128
  v_dot2c_f32_bf16 v224, v129, v160
  v_dot2c_f32_bf16 v225, v129, v129
  v_mfma_f32_32x32x16_bf16 v[192:207], v[68:71], v[128:131], 0
  v_dot2c_f32_bf16 v224, v130, v160
  v_dot2c_f32_bf16 v225, v130, v130
  v_dot2c_f32_bf16 v224, v131, v160
  v_dot2c_f32_bf16 v225, v131, v131
  v_mfma_f32_32x32x16_bf16 v[208:223], v[64:67], v[160:163], 0
  ds_read_b64_tr_b16 v[88:89], v60 offset:6144
  ds_read_b64_tr_b16 v[90:91], v60 offset:6656
  ds_read_b64_tr_b16 v[92:93], v61 offset:6144
  ds_read_b64_tr_b16 v[94:95], v61 offset:6656
  s_add_u32 m0, s26, 0
  s_add_u32 s22, s24, 0
  buffer_load_dwordx4 v3, s[8:11], s22 offen lds
  buffer_load_dwordx4 v4, s[8:11], s22 offen offset:1024 lds
  s_waitcnt lgkmcnt(8)
  v_mfma_f32_32x32x16_bf16 v[176:191], v[72:75], v[132:135], v[176:191]
  v_dot2c_f32_bf16 v224, v132, v160
  v_dot2c_f32_bf16 v225, v132, v132
  v_dot2c_f32_bf16 v224, v133, v160
  v_dot2c_f32_bf16 v225, v133, v133
  v_mfma_f32_32x32x16_bf16 v[192:207], v[76:79], v[132:135], v[192:207]
  v_dot2c_f32_bf16 v224, v134, v160
  v_dot2c_f32_bf16 v225, v134, v134
  v_dot2c_f32_bf16 v224, v135, v160
  v_dot2c_f32_bf16 v225, v135, v135
  v_mfma_f32_32x32x16_bf16 v[208:223], v[72:75], v[160:163], v[208:223]
  ds_read_b64_tr_b16 v[64:65], v60 offset:8192
  ds_read_b64_tr_b16 v[66:67], v60 offset:8704
  ds_read_b64_tr_b16 v[68:69], v61 offset:8192
  ds_read_b64_tr_b16 v[70:71], v61 offset:8704
  s_add_u32 m0, s26, 98304
  s_add_u32 s23, s25, 0
  buffer_load_dwordx4 v5, s[12:15], s23 offen lds
  buffer_load_dwordx4 v6, s[12:15], s23 offen offset:1024 lds
  s_waitcnt lgkmcnt(8)
  v_mfma_f32_32x32x16_bf16 v[176:191], v[80:83], v[136:139], v[176:191]
  v_dot2c_f32_bf16 v224, v136, v160
  v_dot2c_f32_bf16 v225, v136, v136
  v_dot2c_f32_bf16 v224, v137, v160
  v_dot2c_f32_bf16 v225, v137, v137
  v_mfma_f32_32x32x16_bf16 v[192:207], v[84:87], v[136:139], v[192:207]
  v_dot2c_f32_bf16 v224, v138, v160
  v_dot2c_f32_bf16 v225, v138, v138
  v_dot2c_f32_bf16 v224, v139, v160
  v_dot2c_f32_bf16 v225, v139, v139
  v_mfma_f32_32x32x16_bf16 v[208:223], v[80:83], v[160:163], v[208:223]
  ds_read_b64_tr_b16 v[72:73], v60 offset:10240
  ds_read_b64_tr_b16 v[74:75], v60 offset:10752
  ds_read_b64_tr_b16 v[76:77], v61 offset:10240
  ds_read_b64_tr_b16 v[78:79], v61 offset:10752
  s_add_u32 m0, s26, 16384
  s_add_u32 s22, s24, 131072
  buffer_load_dwordx4 v3, s[8:11], s22 offen lds
  buffer_load_dwordx4 v4, s[8:11], s22 offen offset:1024 lds
  buffer_load_dword v1, v1, s[60:63], s38 offen
  s_waitcnt lgkmcnt(8)
  v_mfma_f32_32x32x16_bf16 v[176:191], v[88:91], v[140:143], v[176:191]
  v_dot2c_f32_bf16 v224, v140, v160
  v_dot2c_f32_bf16 v225, v140, v140
  v_dot2c_f32_bf16 v224, v141, v160
  v_dot2c_f32_bf16 v225, v141, v141
  v_mfma_f32_32x32x16_bf16 v[192:207], v[92:95], v[140:143], v[192:207]
  v_dot2c_f32_bf16 v224, v142, v160
  v_dot2c_f32_bf16 v225, v142, v142
  v_dot2c_f32_bf16 v224, v143, v160
  v_dot2c_f32_bf16 v225, v143, v143
  v_mfma_f32_32x32x16_bf16 v[208:223], v[88:91], v[160:163], v[208:223]
  ds_read_b64_tr_b16 v[80:81], v60 offset:12288
  ds_read_b64_tr_b16 v[82:83], v60 offset:12800
  ds_read_b64_tr_b16 v[84:85], v61 offset:12288
  ds_read_b64_tr_b16 v[86:87], v61 offset:12800
  s_add_u32 m0, s26, 32768
  s_add_u32 s22, s24, 128
  buffer_load_dwordx4 v3, s[8:11], s22 offen lds
  buffer_load_dwordx4 v4, s[8:11], s22 offen offset:1024 lds
  s_waitcnt lgkmcnt(8)
  v_mfma_f32_32x32x16_bf16 v[176:191], v[64:67], v[144:147], v[176:191]
  v_dot2c_f32_bf16 v224, v144, v160
  v_dot2c_f32_bf16 v225, v144, v144
  v_dot2c_f32_bf16 v224, v145, v160
  v_dot2c_f32_bf16 v225, v145, v145
  v_mfma_f32_32x32x16_bf16 v[192:207], v[68:71], v[144:147], v[192:207]
  v_dot2c_f32_bf16 v224, v146, v160
  v_dot2c_f32_bf16 v225, v146, v146
  v_dot2c_f32_bf16 v224, v147, v160
  v_dot2c_f32_bf16 v225, v147, v147
  v_mfma_f32_32x32x16_bf16 v[208:223], v[64:67], v[160:163], v[208:223]
  ds_read_b64_tr_b16 v[88:89], v60 offset:14336
  ds_read_b64_tr_b16 v[90:91], v60 offset:14848
  ds_read_b64_tr_b16 v[92:93], v61 offset:14336
  ds_read_b64_tr_b16 v[94:95], v61 offset:14848
  s_add_u32 m0, s26, 49152
  s_add_u32 s22, s24, 131200
  buffer_load_dwordx4 v3, s[8:11], s22 offen lds
  buffer_load_dwordx4 v4, s[8:11], s22 offen offset:1024 lds
  s_waitcnt lgkmcnt(8)
  v_mfma_f32_32x32x16_bf16 v[176:191], v[72:75], v[148:151], v[176:191]
  v_dot2c_f32_bf16 v224, v148, v160
  v_dot2c_f32_bf16 v225, v148, v148
  v_dot2c_f32_bf16 v224, v149, v160
  v_dot2c_f32_bf16 v225, v149, v149
  v_mfma_f32_32x32x16_bf16 v[192:207], v[76:79], v[148:151], v[192:207]
  v_dot2c_f32_bf16 v224, v150, v160
  v_dot2c_f32_bf16 v225, v150, v150
  v_dot2c_f32_bf16 v224, v151, v160
  v_dot2c_f32_bf16 v225, v151, v151
  v_mfma_f32_32x32x16_bf16 v[208:223], v[72:75], v[160:163], v[208:223]
  s_waitcnt lgkmcnt(4)
  v_mfma_f32_32x32x16_bf16 v[176:191], v[80:83], v[152:155], v[176:191]
  v_dot2c_f32_bf16 v224, v152, v160
  v_dot2c_f32_bf16 v225, v152, v152
  v_dot2c_f32_bf16 v224, v153, v160
  v_dot2c_f32_bf16 v225, v153, v153
  v_mfma_f32_32x32x16_bf16 v[192:207], v[84:87], v[152:155], v[192:207]
  v_dot2c_f32_bf16 v224, v154, v160
  v_dot2c_f32_bf16 v225, v154, v154
  v_dot2c_f32_bf16 v224, v155, v160
  v_dot2c_f32_bf16 v225, v155, v155
  v_mfma_f32_32x32x16_bf16 v[208:223], v[80:83], v[160:163], v[208:223]
  s_waitcnt lgkmcnt(0)
  v_mfma_f32_32x32x16_bf16 v[176:191], v[88:91], v[156:159], v[176:191]
  v_dot2c_f32_bf16 v224, v156, v160
  v_dot2c_f32_bf16 v225, v156, v156
  v_dot2c_f32_bf16 v224, v157, v160
  v_dot2c_f32_bf16 v225, v157, v157
  v_mfma_f32_32x32x16_bf16 v[192:207], v[92:95], v[156:159], v[192:207]
  v_dot2c_f32_bf16 v224, v158, v160
  v_dot2c_f32_bf16 v225, v158, v158
  v_dot2c_f32_bf16 v224, v159, v160
  v_dot2c_f32_bf16 v225, v159, v159
  v_mfma_f32_32x32x16_bf16 v[208:223], v[88:91], v[160:163], v[208:223]
  v_mov_b32 v231, v224
  s_nop 1
  v_permlane32_swap_b32 v224, v231
  s_nop 1
  v_add_f32 v224, v224, v231
  v_mov_b32 v231, v225
  s_nop 1
  v_permlane32_swap_b32 v225, v231
  s_nop 1
  v_add_f32 v225, v225, v231
  s_lshl_b32 s22, s30, 10
  s_lshl_b32 s23, s31, 8
  s_add_u32 s22, s22, s23
  s_add_u32 s22, s22, 114688
  v_lshlrev_b32 v232, 3, v21
  v_add_u32 v233, s22, v232
  s_lshl_b32 s22, s31, 8
  s_lshl_b32 s23, s30, 7
  s_add_u32 s22, s22, s23
  s_add_u32 s22, s22, 116736
  v_lshlrev_b32 v234, 4, v22
  v_add_u32 v234, s22, v234
  s_mov_b32 exec_hi, 0
  ds_write_b64 v233, v[224:225]
  s_mov_b32 exec_hi, -1
  s_nop 7
  s_barrier
  s_mov_b32 exec_lo, 1
  s_mov_b32 exec_hi, 1
  ds_write_b128 v234, v[208:211] offset:0
  ds_write_b128 v234, v[212:215] offset:32
  ds_write_b128 v234, v[216:219] offset:64
  ds_write_b128 v234, v[220:223] offset:96
  s_mov_b64 exec, -1
  ds_write_b128 v228, v[176:179] offset:0
  ds_write_b128 v228, v[180:183] offset:1024
  ds_write_b128 v228, v[184:187] offset:8192
  ds_write_b128 v228, v[188:191] offset:9216
  ds_write_b128 v229, v[192:195] offset:0
  ds_write_b128 v229, v[196:199] offset:1024
  ds_write_b128 v229, v[200:203] offset:8192
  ds_write_b128 v229, v[204:207] offset:9216
  s_waitcnt lgkmcnt(0)
  s_barrier
  ds_read_b128 v[128:131], v230 offset:0
  ds_read_b128 v[132:135], v230 offset:1024
  ds_read_b128 v[136:139], v230 offset:2048
  ds_read_b128 v[140:143], v230 offset:3072
  ds_read_b128 v[144:147], v230 offset:4096
  ds_read_b128 v[148:151], v230 offset:5120
  ds_read_b128 v[152:155], v230 offset:6144
  ds_read_b128 v[156:159], v230 offset:7168
  s_lshl_b32 s22, s30, 10
  s_add_u32 s22, s22, 114688
  v_add_u32 v233, s22, v232
  ds_read_b64 v[160:161], v233 offset:0
  ds_read_b64 v[162:163], v233 offset:256
  ds_read_b64 v[164:165], v233 offset:512
  ds_read_b64 v[166:167], v233 offset:768
  s_lshr_b32 s22, s31, 1
  s_lshl_b32 s22, s22, 7
  s_and_b32 s23, s31, 1
  s_lshl_b32 s23, s23, 6
  s_add_u32 s22, s22, s23
  s_add_u32 s22, s22, 116736
  v_lshlrev_b32 v234, 4, v22
  v_add_u32 v234, s22, v234
  s_waitcnt lgkmcnt(6)
  v_add_f32 v128, v128, v136
  v_add_f32 v129, v129, v137
  v_add_f32 v130, v130, v138
  v_add_f32 v131, v131, v139
  v_add_f32 v132, v132, v140
  v_add_f32 v133, v133, v141
  v_add_f32 v134, v134, v142
  v_add_f32 v135, v135, v143
  v_add_f32 v128, v128, v144
  v_add_f32 v129, v129, v145
  v_add_f32 v130, v130, v146
  v_add_f32 v131, v131, v147
  v_add_f32 v132, v132, v148
  v_add_f32 v133, v133, v149
  v_add_f32 v134, v134, v150
  v_add_f32 v135, v135, v151
  ds_read_b128 v[176:179], v234 offset:0
  ds_read_b128 v[180:183], v234 offset:32
  ds_read_b128 v[184:187], v234 offset:256
  ds_read_b128 v[188:191], v234 offset:288
  ds_read_b128 v[192:195], v234 offset:512
  ds_read_b128 v[196:199], v234 offset:544
  ds_read_b128 v[200:203], v234 offset:768
  ds_read_b128 v[204:207], v234 offset:800
  s_waitcnt lgkmcnt(8)
  v_add_f32 v128, v128, v152
  v_add_f32 v129, v129, v153
  v_add_f32 v130, v130, v154
  v_add_f32 v131, v131, v155
  v_add_f32 v132, v132, v156
  v_add_f32 v133, v133, v157
  v_add_f32 v134, v134, v158
  v_add_f32 v135, v135, v159
  v_add_f32 v160, v160, v162
  v_add_f32 v161, v161, v163
  v_add_f32 v164, v164, v166
  v_add_f32 v165, v165, v167
  v_add_f32 v160, v160, v164
  v_add_f32 v161, v161, v165
  v_mul_f32 v168, 0x3b000000, v160
  v_mul_f32 v169, 0x3b000000, v161
  v_fma_f32 v169, -v168, v168, v169
  v_max_f32 v169, 0, v169
  v_add_f32 v170, 0x3727c5ac, v169
  v_rsq_f32 v170, v170
  s_nop 0
  v_mul_f32 v171, v169, v170
  v_mul_f32 v171, v171, v170
  v_add_f32 v171, 0x3727c5ac, v171
  v_rsq_f32 v171, v171
  s_nop 0
  v_mul_f32 v171, v171, v170
  v_lshlrev_b32 v144, 16, v56
  v_and_b32 v145, 0xffff0000, v56
  v_lshlrev_b32 v146, 16, v57
  v_and_b32 v147, 0xffff0000, v57
  v_lshlrev_b32 v148, 16, v58
  v_and_b32 v149, 0xffff0000, v58
  v_lshlrev_b32 v150, 16, v59
  v_and_b32 v151, 0xffff0000, v59
  v_sub_f32 v144, v144, v168
  v_sub_f32 v145, v145, v168
  v_sub_f32 v146, v146, v168
  v_sub_f32 v147, v147, v168
  v_sub_f32 v148, v148, v168
  v_sub_f32 v149, v149, v168
  v_sub_f32 v150, v150, v168
  v_sub_f32 v151, v151, v168
  v_mul_f32 v144, v144, v170
  v_mul_f32 v145, v145, v170
  v_mul_f32 v146, v146, v170
  v_mul_f32 v147, v147, v170
  v_mul_f32 v148, v148, v170
  v_mul_f32 v149, v149, v170
  v_mul_f32 v150, v150, v170
  v_mul_f32 v151, v151, v170
  v_cvt_pk_bf16_f32 v56, v144, v145
  v_cvt_pk_bf16_f32 v57, v146, v147
  v_cvt_pk_bf16_f32 v58, v148, v149
  v_cvt_pk_bf16_f32 v59, v150, v151
  buffer_store_dwordx4 v[56:59], v20, s[76:79], s33 offen sc1
  s_waitcnt lgkmcnt(0)
  s_barrier
  s_add_u32 m0, s26, 114688
  s_add_u32 s23, s25, 262144
  buffer_load_dwordx4 v5, s[12:15], s23 offen lds
  buffer_load_dwordx4 v6, s[12:15], s23 offen offset:1024 lds
  s_add_u32 m0, s26, 131072
  s_add_u32 s23, s25, 524288
  buffer_load_dwordx4 v5, s[12:15], s23 offen lds
  buffer_load_dwordx4 v6, s[12:15], s23 offen offset:1024 lds
  s_add_u32 m0, s26, 147456
  s_add_u32 s23, s25, 786432
  buffer_load_dwordx4 v5, s[12:15], s23 offen lds
  buffer_load_dwordx4 v6, s[12:15], s23 offen offset:1024 lds
  v_add_f32 v176, v176, v184
  v_add_f32 v177, v177, v185
  v_add_f32 v178, v178, v186
  v_add_f32 v179, v179, v187
  v_add_f32 v180, v180, v188
  v_add_f32 v181, v181, v189
  v_add_f32 v182, v182, v190
  v_add_f32 v183, v183, v191
  v_add_f32 v176, v176, v192
  v_add_f32 v177, v177, v193
  v_add_f32 v178, v178, v194
  v_add_f32 v179, v179, v195
  v_add_f32 v180, v180, v196
  v_add_f32 v181, v181, v197
  v_add_f32 v182, v182, v198
  v_add_f32 v183, v183, v199
  v_add_f32 v176, v176, v200
  v_add_f32 v177, v177, v201
  v_add_f32 v178, v178, v202
  v_add_f32 v179, v179, v203
  v_add_f32 v180, v180, v204
  v_add_f32 v181, v181, v205
  v_add_f32 v182, v182, v206
  v_add_f32 v183, v183, v207
  v_fma_f32 v128, -v168, v176, v128
  v_fma_f32 v129, -v168, v177, v129
  v_fma_f32 v130, -v168, v178, v130
  v_fma_f32 v131, -v168, v179, v131
  v_fma_f32 v132, -v168, v180, v132
  v_fma_f32 v133, -v168, v181, v133
  v_fma_f32 v134, -v168, v182, v134
  v_fma_f32 v135, -v168, v183, v135
  v_mul_f32 v128, v128, v171
  v_mul_f32 v129, v129, v171
  v_mul_f32 v130, v130, v171
  v_mul_f32 v131, v131, v171
  v_mul_f32 v132, v132, v171
  v_mul_f32 v133, v133, v171
  v_mul_f32 v134, v134, v171
  v_mul_f32 v135, v135, v171
  v_mul_f32 v144, v128, v128
  v_mul_f32 v145, v129, v129
  v_mul_f32 v146, v130, v130
  v_mul_f32 v147, v131, v131
  v_mul_f32 v148, v132, v132
  v_mul_f32 v149, v133, v133
  v_mul_f32 v150, v134, v134
  v_mul_f32 v151, v135, v135
  v_fma_f32 v144, v144, v227, v226
  v_fma_f32 v145, v145, v227, v226
  v_fma_f32 v146, v146, v227, v226
  v_fma_f32 v147, v147, v227, v226
  v_fma_f32 v148, v148, v227, v226
  v_fma_f32 v149, v149, v227, v226
  v_fma_f32 v150, v150, v227, v226
  v_fma_f32 v151, v151, v227, v226
  v_mul_f32 v144, v144, v128
  v_mul_f32 v145, v145, v129
  v_mul_f32 v146, v146, v130
  v_mul_f32 v147, v147, v131
  v_mul_f32 v148, v148, v132
  v_mul_f32 v149, v149, v133
  v_mul_f32 v150, v150, v134
  v_mul_f32 v151, v151, v135
  v_exp_f32 v144, v144
  v_exp_f32 v145, v145
  v_exp_f32 v146, v146
  v_exp_f32 v147, v147
  v_exp_f32 v148, v148
  v_exp_f32 v149, v149
  v_exp_f32 v150, v150
  v_exp_f32 v151, v151
  s_nop 0
  v_add_f32 v144, 1.0, v144
  v_add_f32 v145, 1.0, v145
  v_add_f32 v146, 1.0, v146
  v_add_f32 v147, 1.0, v147
  v_add_f32 v148, 1.0, v148
  v_add_f32 v149, 1.0, v149
  v_add_f32 v150, 1.0, v150
  v_add_f32 v151, 1.0, v151
  v_rcp_f32 v144, v144
  v_rcp_f32 v145, v145
  v_rcp_f32 v146, v146
  v_rcp_f32 v147, v147
  v_rcp_f32 v148, v148
  v_rcp_f32 v149, v149
  v_rcp_f32 v150, v150
  v_rcp_f32 v151, v151
  s_nop 0
  v_mul_f32 v128, v128, v144
  v_mul_f32 v129, v129, v145
  v_mul_f32 v130, v130, v146
  v_mul_f32 v131, v131, v147
  v_mul_f32 v132, v132, v148
  v_mul_f32 v133, v133, v149
  v_mul_f32 v134, v134, v150
  v_mul_f32 v135, v135, v151
  v_cvt_pk_bf16_f32 v152, v128, v129
  v_cvt_pk_bf16_f32 v153, v130, v131
  v_cvt_pk_bf16_f32 v154, v132, v133
  v_cvt_pk_bf16_f32 v155, v134, v135
  buffer_store_dwordx4 v[152:155], v20, s[72:75], s33 offen sc1
  s_cmp_eq_u32 s21, 1
  s_cbranch_scc1 main_kernel_V
  s_waitcnt vmcnt(13)
  s_barrier
  ds_read_b128 v[64:67], v10 offset:0
  ds_read_b128 v[68:71], v10 offset:4096
  ds_read_b128 v[72:75], v10 offset:8192
  ds_read_b128 v[76:79], v10 offset:12288
  ds_read_b64_tr_b16 v[80:81], v18 offset:0
  ds_read_b64_tr_b16 v[82:83], v18 offset:1024
  ds_read_b64_tr_b16 v[84:85], v19 offset:0
  ds_read_b64_tr_b16 v[86:87], v19 offset:1024
  s_waitcnt lgkmcnt(0)
  v_mfma_f32_32x32x16_bf16 v[128:143], v[80:83], v[64:67], 0
  ds_read_b128 v[88:91], v11 offset:0
  ds_read_b128 v[92:95], v11 offset:4096
  v_mfma_f32_32x32x16_bf16 v[144:159], v[84:87], v[64:67], 0
  ds_read_b128 v[96:99], v11 offset:8192
  ds_read_b128 v[100:103], v11 offset:12288
  v_mfma_f32_32x32x16_bf16 v[160:175], v[80:83], v[68:71], 0
  ds_read_b64_tr_b16 v[104:105], v18 offset:4096
  ds_read_b64_tr_b16 v[106:107], v18 offset:5120
  v_mfma_f32_32x32x16_bf16 v[176:191], v[84:87], v[68:71], 0
  ds_read_b64_tr_b16 v[108:109], v19 offset:4096
  ds_read_b64_tr_b16 v[110:111], v19 offset:5120
  v_mfma_f32_32x32x16_bf16 v[192:207], v[80:83], v[72:75], 0
  s_add_u32 m0, s26, 65536
  s_add_u32 s22, s24, 256
  buffer_load_dwordx4 v3, s[8:11], s22 offen lds
  buffer_load_dwordx4 v4, s[8:11], s22 offen offset:1024 lds
  v_mfma_f32_32x32x16_bf16 v[208:223], v[84:87], v[72:75], 0
  v_mfma_f32_32x32x16_bf16 v[224:239], v[80:83], v[76:79], 0
  v_mfma_f32_32x32x16_bf16 v[240:255], v[84:87], v[76:79], 0
  s_waitcnt lgkmcnt(0)
  s_waitcnt vmcnt(7)
  s_barrier
  v_mfma_f32_32x32x16_bf16 v[128:143], v[104:107], v[88:91], v[128:143]
  ds_read_b128 v[64:67], v12 offset:0
  ds_read_b128 v[68:71], v12 offset:4096
  v_mfma_f32_32x32x16_bf16 v[144:159], v[108:111], v[88:91], v[144:159]
  ds_read_b128 v[72:75], v12 offset:8192
  ds_read_b128 v[76:79], v12 offset:12288
  v_mfma_f32_32x32x16_bf16 v[160:175], v[104:107], v[92:95], v[160:175]
  ds_read_b64_tr_b16 v[80:81], v18 offset:16384
  ds_read_b64_tr_b16 v[82:83], v18 offset:17408
  v_mfma_f32_32x32x16_bf16 v[176:191], v[108:111], v[92:95], v[176:191]
  ds_read_b64_tr_b16 v[84:85], v19 offset:16384
  ds_read_b64_tr_b16 v[86:87], v19 offset:17408
  v_mfma_f32_32x32x16_bf16 v[192:207], v[104:107], v[96:99], v[192:207]
  s_add_u32 m0, s26, 98304
  s_add_u32 s23, s25, 1048576
  buffer_load_dwordx4 v5, s[12:15], s23 offen lds
  buffer_load_dwordx4 v6, s[12:15], s23 offen offset:1024 lds
  v_mfma_f32_32x32x16_bf16 v[208:223], v[108:111], v[96:99], v[208:223]
  v_mfma_f32_32x32x16_bf16 v[224:239], v[104:107], v[100:103], v[224:239]
  v_mfma_f32_32x32x16_bf16 v[240:255], v[108:111], v[100:103], v[240:255]
  s_waitcnt lgkmcnt(0)
  v_mfma_f32_32x32x16_bf16 v[128:143], v[80:83], v[64:67], v[128:143]
  ds_read_b128 v[88:91], v13 offset:0
  ds_read_b128 v[92:95], v13 offset:4096
  v_mfma_f32_32x32x16_bf16 v[144:159], v[84:87], v[64:67], v[144:159]
  ds_read_b128 v[96:99], v13 offset:8192
  ds_read_b128 v[100:103], v13 offset:12288
  v_mfma_f32_32x32x16_bf16 v[160:175], v[80:83], v[68:71], v[160:175]
  ds_read_b64_tr_b16 v[104:105], v18 offset:20480
  ds_read_b64_tr_b16 v[106:107], v18 offset:21504
  v_mfma_f32_32x32x16_bf16 v[176:191], v[84:87], v[68:71], v[176:191]
  ds_read_b64_tr_b16 v[108:109], v19 offset:20480
  ds_read_b64_tr_b16 v[110:111], v19 offset:21504
  v_mfma_f32_32x32x16_bf16 v[192:207], v[80:83], v[72:75], v[192:207]
  s_add_u32 m0, s26, 81920
  s_add_u32 s22, s24, 131328
  buffer_load_dwordx4 v3, s[8:11], s22 offen lds
  buffer_load_dwordx4 v4, s[8:11], s22 offen offset:1024 lds
  v_mfma_f32_32x32x16_bf16 v[208:223], v[84:87], v[72:75], v[208:223]
  v_mfma_f32_32x32x16_bf16 v[224:239], v[80:83], v[76:79], v[224:239]
  v_mfma_f32_32x32x16_bf16 v[240:255], v[84:87], v[76:79], v[240:255]
  s_waitcnt lgkmcnt(0)
  s_waitcnt vmcnt(9)
  s_barrier
  v_mfma_f32_32x32x16_bf16 v[128:143], v[104:107], v[88:91], v[128:143]
  ds_read_b128 v[64:67], v10 offset:32768
  ds_read_b128 v[68:71], v10 offset:36864
  v_mfma_f32_32x32x16_bf16 v[144:159], v[108:111], v[88:91], v[144:159]
  ds_read_b128 v[72:75], v10 offset:40960
  ds_read_b128 v[76:79], v10 offset:45056
  v_mfma_f32_32x32x16_bf16 v[160:175], v[104:107], v[92:95], v[160:175]
  ds_read_b64_tr_b16 v[80:81], v18 offset:32768
  ds_read_b64_tr_b16 v[82:83], v18 offset:33792
  v_mfma_f32_32x32x16_bf16 v[176:191], v[108:111], v[92:95], v[176:191]
  ds_read_b64_tr_b16 v[84:85], v19 offset:32768
  ds_read_b64_tr_b16 v[86:87], v19 offset:33792
  v_mfma_f32_32x32x16_bf16 v[192:207], v[104:107], v[96:99], v[192:207]
  s_add_u32 m0, s26, 114688
  s_add_u32 s23, s25, 1310720
  buffer_load_dwordx4 v5, s[12:15], s23 offen lds
  buffer_load_dwordx4 v6, s[12:15], s23 offen offset:1024 lds
  v_mfma_f32_32x32x16_bf16 v[208:223], v[108:111], v[96:99], v[208:223]
  v_mfma_f32_32x32x16_bf16 v[224:239], v[104:107], v[100:103], v[224:239]
  s_add_u32 m0, s26, 0
  s_add_u32 s22, s24, 384
  buffer_load_dwordx4 v3, s[8:11], s22 offen lds
  buffer_load_dwordx4 v4, s[8:11], s22 offen offset:1024 lds
  v_mfma_f32_32x32x16_bf16 v[240:255], v[108:111], v[100:103], v[240:255]
  s_waitcnt lgkmcnt(0)
  v_mfma_f32_32x32x16_bf16 v[128:143], v[80:83], v[64:67], v[128:143]
  ds_read_b128 v[88:91], v11 offset:32768
  ds_read_b128 v[92:95], v11 offset:36864
  v_mfma_f32_32x32x16_bf16 v[144:159], v[84:87], v[64:67], v[144:159]
  ds_read_b128 v[96:99], v11 offset:40960
  ds_read_b128 v[100:103], v11 offset:45056
  v_mfma_f32_32x32x16_bf16 v[160:175], v[80:83], v[68:71], v[160:175]
  ds_read_b64_tr_b16 v[104:105], v18 offset:36864
  ds_read_b64_tr_b16 v[106:107], v18 offset:37888
  v_mfma_f32_32x32x16_bf16 v[176:191], v[84:87], v[68:71], v[176:191]
  ds_read_b64_tr_b16 v[108:109], v19 offset:36864
  ds_read_b64_tr_b16 v[110:111], v19 offset:37888
  v_mfma_f32_32x32x16_bf16 v[192:207], v[80:83], v[72:75], v[192:207]
  s_add_u32 m0, s26, 16384
  s_add_u32 s22, s24, 131456
  buffer_load_dwordx4 v3, s[8:11], s22 offen lds
  buffer_load_dwordx4 v4, s[8:11], s22 offen offset:1024 lds
  v_mfma_f32_32x32x16_bf16 v[208:223], v[84:87], v[72:75], v[208:223]
  v_mfma_f32_32x32x16_bf16 v[224:239], v[80:83], v[76:79], v[224:239]
  v_mfma_f32_32x32x16_bf16 v[240:255], v[84:87], v[76:79], v[240:255]
  s_waitcnt lgkmcnt(0)
  s_waitcnt vmcnt(13)
  s_barrier
  v_mfma_f32_32x32x16_bf16 v[128:143], v[104:107], v[88:91], v[128:143]
  ds_read_b128 v[64:67], v12 offset:32768
  ds_read_b128 v[68:71], v12 offset:36864
  v_mfma_f32_32x32x16_bf16 v[144:159], v[108:111], v[88:91], v[144:159]
  ds_read_b128 v[72:75], v12 offset:40960
  ds_read_b128 v[76:79], v12 offset:45056
  v_mfma_f32_32x32x16_bf16 v[160:175], v[104:107], v[92:95], v[160:175]
  ds_read_b64_tr_b16 v[80:81], v18 offset:49152
  ds_read_b64_tr_b16 v[82:83], v18 offset:50176
  v_mfma_f32_32x32x16_bf16 v[176:191], v[108:111], v[92:95], v[176:191]
  ds_read_b64_tr_b16 v[84:85], v19 offset:49152
  ds_read_b64_tr_b16 v[86:87], v19 offset:50176
  v_mfma_f32_32x32x16_bf16 v[192:207], v[104:107], v[96:99], v[192:207]
  s_add_u32 m0, s26, 131072
  s_add_u32 s23, s25, 1572864
  buffer_load_dwordx4 v5, s[12:15], s23 offen lds
  buffer_load_dwordx4 v6, s[12:15], s23 offen offset:1024 lds
  v_mfma_f32_32x32x16_bf16 v[208:223], v[108:111], v[96:99], v[208:223]
  v_mfma_f32_32x32x16_bf16 v[224:239], v[104:107], v[100:103], v[224:239]
  v_mfma_f32_32x32x16_bf16 v[240:255], v[108:111], v[100:103], v[240:255]
  s_waitcnt lgkmcnt(0)
  v_mfma_f32_32x32x16_bf16 v[128:143], v[80:83], v[64:67], v[128:143]
  ds_read_b128 v[88:91], v13 offset:32768
  ds_read_b128 v[92:95], v13 offset:36864
  v_mfma_f32_32x32x16_bf16 v[144:159], v[84:87], v[64:67], v[144:159]
  ds_read_b128 v[96:99], v13 offset:40960
  ds_read_b128 v[100:103], v13 offset:45056
  v_mfma_f32_32x32x16_bf16 v[160:175], v[80:83], v[68:71], v[160:175]
  ds_read_b64_tr_b16 v[104:105], v18 offset:53248
  ds_read_b64_tr_b16 v[106:107], v18 offset:54272
  v_mfma_f32_32x32x16_bf16 v[176:191], v[84:87], v[68:71], v[176:191]
  ds_read_b64_tr_b16 v[108:109], v19 offset:53248
  ds_read_b64_tr_b16 v[110:111], v19 offset:54272
  v_mfma_f32_32x32x16_bf16 v[192:207], v[80:83], v[72:75], v[192:207]
  v_mfma_f32_32x32x16_bf16 v[208:223], v[84:87], v[72:75], v[208:223]
  v_mfma_f32_32x32x16_bf16 v[224:239], v[80:83], v[76:79], v[224:239]
  v_mfma_f32_32x32x16_bf16 v[240:255], v[84:87], v[76:79], v[240:255]
  s_waitcnt lgkmcnt(0)
  s_waitcnt vmcnt(8)
  s_barrier
  v_mfma_f32_32x32x16_bf16 v[128:143], v[104:107], v[88:91], v[128:143]
  ds_read_b128 v[64:67], v14 offset:0
  ds_read_b128 v[68:71], v14 offset:4096
  v_mfma_f32_32x32x16_bf16 v[144:159], v[108:111], v[88:91], v[144:159]
  ds_read_b128 v[72:75], v14 offset:8192
  ds_read_b128 v[76:79], v14 offset:12288
  v_mfma_f32_32x32x16_bf16 v[160:175], v[104:107], v[92:95], v[160:175]
  ds_read_b64_tr_b16 v[80:81], v18 offset:0
  ds_read_b64_tr_b16 v[82:83], v18 offset:1024
  v_mfma_f32_32x32x16_bf16 v[176:191], v[108:111], v[92:95], v[176:191]
  ds_read_b64_tr_b16 v[84:85], v19 offset:0
  ds_read_b64_tr_b16 v[86:87], v19 offset:1024
  v_mfma_f32_32x32x16_bf16 v[192:207], v[104:107], v[96:99], v[192:207]
  s_add_u32 m0, s26, 147456
  s_add_u32 s23, s25, 1835008
  buffer_load_dwordx4 v5, s[12:15], s23 offen lds
  buffer_load_dwordx4 v6, s[12:15], s23 offen offset:1024 lds
  v_mfma_f32_32x32x16_bf16 v[208:223], v[108:111], v[96:99], v[208:223]
  v_mfma_f32_32x32x16_bf16 v[224:239], v[104:107], v[100:103], v[224:239]
  s_add_u32 m0, s26, 32768
  s_add_u32 s22, s24, 512
  buffer_load_dwordx4 v3, s[8:11], s22 offen lds
  buffer_load_dwordx4 v4, s[8:11], s22 offen offset:1024 lds
  v_mfma_f32_32x32x16_bf16 v[240:255], v[108:111], v[100:103], v[240:255]
  s_waitcnt lgkmcnt(0)
  v_mfma_f32_32x32x16_bf16 v[128:143], v[80:83], v[64:67], v[128:143]
  ds_read_b128 v[88:91], v15 offset:0
  ds_read_b128 v[92:95], v15 offset:4096
  v_mfma_f32_32x32x16_bf16 v[144:159], v[84:87], v[64:67], v[144:159]
  ds_read_b128 v[96:99], v15 offset:8192
  ds_read_b128 v[100:103], v15 offset:12288
  v_mfma_f32_32x32x16_bf16 v[160:175], v[80:83], v[68:71], v[160:175]
  ds_read_b64_tr_b16 v[104:105], v18 offset:4096
  ds_read_b64_tr_b16 v[106:107], v18 offset:5120
  v_mfma_f32_32x32x16_bf16 v[176:191], v[84:87], v[68:71], v[176:191]
  ds_read_b64_tr_b16 v[108:109], v19 offset:4096
  ds_read_b64_tr_b16 v[110:111], v19 offset:5120
  v_mfma_f32_32x32x16_bf16 v[192:207], v[80:83], v[72:75], v[192:207]
  s_add_u32 m0, s26, 49152
  s_add_u32 s22, s24, 131584
  buffer_load_dwordx4 v3, s[8:11], s22 offen lds
  buffer_load_dwordx4 v4, s[8:11], s22 offen offset:1024 lds
  v_mfma_f32_32x32x16_bf16 v[208:223], v[84:87], v[72:75], v[208:223]
  v_mfma_f32_32x32x16_bf16 v[224:239], v[80:83], v[76:79], v[224:239]
  v_mfma_f32_32x32x16_bf16 v[240:255], v[84:87], v[76:79], v[240:255]
  s_waitcnt lgkmcnt(0)
  s_waitcnt vmcnt(12)
  s_barrier
  s_cmp_lg_u32 s20, 0
  s_cbranch_scc1 main_kernel_sig_1
  s_lshl_b32 s22, s28, 2
  v_mov_b32 v62, 0
  v_mov_b32 v63, 1
  s_mov_b64 exec, 1
  buffer_atomic_add v63, v62, s[80:83], s22 offen
  s_mov_b64 exec, -1
main_kernel_sig_1:
  v_mfma_f32_32x32x16_bf16 v[128:143], v[104:107], v[88:91], v[128:143]
  ds_read_b128 v[64:67], v16 offset:0
  ds_read_b128 v[68:71], v16 offset:4096
  v_mfma_f32_32x32x16_bf16 v[144:159], v[108:111], v[88:91], v[144:159]
  ds_read_b128 v[72:75], v16 offset:8192
  ds_read_b128 v[76:79], v16 offset:12288
  v_mfma_f32_32x32x16_bf16 v[160:175], v[104:107], v[92:95], v[160:175]
  ds_read_b64_tr_b16 v[80:81], v18 offset:16384
  ds_read_b64_tr_b16 v[82:83], v18 offset:17408
  v_mfma_f32_32x32x16_bf16 v[176:191], v[108:111], v[92:95], v[176:191]
  ds_read_b64_tr_b16 v[84:85], v19 offset:16384
  ds_read_b64_tr_b16 v[86:87], v19 offset:17408
  v_mfma_f32_32x32x16_bf16 v[192:207], v[104:107], v[96:99], v[192:207]
  s_add_u32 m0, s26, 98304
  s_add_u32 s23, s25, 2097152
  buffer_load_dwordx4 v5, s[12:15], s23 offen lds
  buffer_load_dwordx4 v6, s[12:15], s23 offen offset:1024 lds
  v_mfma_f32_32x32x16_bf16 v[208:223], v[108:111], v[96:99], v[208:223]
  v_mfma_f32_32x32x16_bf16 v[224:239], v[104:107], v[100:103], v[224:239]
  v_mfma_f32_32x32x16_bf16 v[240:255], v[108:111], v[100:103], v[240:255]
  s_waitcnt lgkmcnt(0)
  v_mfma_f32_32x32x16_bf16 v[128:143], v[80:83], v[64:67], v[128:143]
  ds_read_b128 v[88:91], v17 offset:0
  ds_read_b128 v[92:95], v17 offset:4096
  v_mfma_f32_32x32x16_bf16 v[144:159], v[84:87], v[64:67], v[144:159]
  ds_read_b128 v[96:99], v17 offset:8192
  ds_read_b128 v[100:103], v17 offset:12288
  v_mfma_f32_32x32x16_bf16 v[160:175], v[80:83], v[68:71], v[160:175]
  ds_read_b64_tr_b16 v[104:105], v18 offset:20480
  ds_read_b64_tr_b16 v[106:107], v18 offset:21504
  v_mfma_f32_32x32x16_bf16 v[176:191], v[84:87], v[68:71], v[176:191]
  ds_read_b64_tr_b16 v[108:109], v19 offset:20480
  ds_read_b64_tr_b16 v[110:111], v19 offset:21504
  v_mfma_f32_32x32x16_bf16 v[192:207], v[80:83], v[72:75], v[192:207]
  v_mfma_f32_32x32x16_bf16 v[208:223], v[84:87], v[72:75], v[208:223]
  v_mfma_f32_32x32x16_bf16 v[224:239], v[80:83], v[76:79], v[224:239]
  v_mfma_f32_32x32x16_bf16 v[240:255], v[84:87], v[76:79], v[240:255]
  s_waitcnt lgkmcnt(0)
  s_waitcnt vmcnt(8)
  s_barrier
  v_mfma_f32_32x32x16_bf16 v[128:143], v[104:107], v[88:91], v[128:143]
  ds_read_b128 v[64:67], v10 offset:0
  ds_read_b128 v[68:71], v10 offset:4096
  v_mfma_f32_32x32x16_bf16 v[144:159], v[108:111], v[88:91], v[144:159]
  ds_read_b128 v[72:75], v10 offset:8192
  ds_read_b128 v[76:79], v10 offset:12288
  v_mfma_f32_32x32x16_bf16 v[160:175], v[104:107], v[92:95], v[160:175]
  ds_read_b64_tr_b16 v[80:81], v18 offset:32768
  ds_read_b64_tr_b16 v[82:83], v18 offset:33792
  v_mfma_f32_32x32x16_bf16 v[176:191], v[108:111], v[92:95], v[176:191]
  ds_read_b64_tr_b16 v[84:85], v19 offset:32768
  ds_read_b64_tr_b16 v[86:87], v19 offset:33792
  v_mfma_f32_32x32x16_bf16 v[192:207], v[104:107], v[96:99], v[192:207]
  s_add_u32 m0, s26, 114688
  s_add_u32 s23, s25, 2359296
  buffer_load_dwordx4 v5, s[12:15], s23 offen lds
  buffer_load_dwordx4 v6, s[12:15], s23 offen offset:1024 lds
  v_mfma_f32_32x32x16_bf16 v[208:223], v[108:111], v[96:99], v[208:223]
  v_mfma_f32_32x32x16_bf16 v[224:239], v[104:107], v[100:103], v[224:239]
  s_add_u32 m0, s26, 65536
  s_add_u32 s22, s24, 640
  buffer_load_dwordx4 v3, s[8:11], s22 offen lds
  buffer_load_dwordx4 v4, s[8:11], s22 offen offset:1024 lds
  v_mfma_f32_32x32x16_bf16 v[240:255], v[108:111], v[100:103], v[240:255]
  s_waitcnt lgkmcnt(0)
  v_mfma_f32_32x32x16_bf16 v[128:143], v[80:83], v[64:67], v[128:143]
  ds_read_b128 v[88:91], v11 offset:0
  ds_read_b128 v[92:95], v11 offset:4096
  v_mfma_f32_32x32x16_bf16 v[144:159], v[84:87], v[64:67], v[144:159]
  ds_read_b128 v[96:99], v11 offset:8192
  ds_read_b128 v[100:103], v11 offset:12288
  v_mfma_f32_32x32x16_bf16 v[160:175], v[80:83], v[68:71], v[160:175]
  ds_read_b64_tr_b16 v[104:105], v18 offset:36864
  ds_read_b64_tr_b16 v[106:107], v18 offset:37888
  v_mfma_f32_32x32x16_bf16 v[176:191], v[84:87], v[68:71], v[176:191]
  ds_read_b64_tr_b16 v[108:109], v19 offset:36864
  ds_read_b64_tr_b16 v[110:111], v19 offset:37888
  v_mfma_f32_32x32x16_bf16 v[192:207], v[80:83], v[72:75], v[192:207]
  s_add_u32 m0, s26, 81920
  s_add_u32 s22, s24, 131712
  buffer_load_dwordx4 v3, s[8:11], s22 offen lds
  buffer_load_dwordx4 v4, s[8:11], s22 offen offset:1024 lds
  v_mfma_f32_32x32x16_bf16 v[208:223], v[84:87], v[72:75], v[208:223]
  v_mfma_f32_32x32x16_bf16 v[224:239], v[80:83], v[76:79], v[224:239]
  v_mfma_f32_32x32x16_bf16 v[240:255], v[84:87], v[76:79], v[240:255]
  s_waitcnt lgkmcnt(0)
  s_waitcnt vmcnt(12)
  s_barrier
  v_mfma_f32_32x32x16_bf16 v[128:143], v[104:107], v[88:91], v[128:143]
  ds_read_b128 v[64:67], v12 offset:0
  ds_read_b128 v[68:71], v12 offset:4096
  v_mfma_f32_32x32x16_bf16 v[144:159], v[108:111], v[88:91], v[144:159]
  ds_read_b128 v[72:75], v12 offset:8192
  ds_read_b128 v[76:79], v12 offset:12288
  v_mfma_f32_32x32x16_bf16 v[160:175], v[104:107], v[92:95], v[160:175]
  ds_read_b64_tr_b16 v[80:81], v18 offset:49152
  ds_read_b64_tr_b16 v[82:83], v18 offset:50176
  v_mfma_f32_32x32x16_bf16 v[176:191], v[108:111], v[92:95], v[176:191]
  ds_read_b64_tr_b16 v[84:85], v19 offset:49152
  ds_read_b64_tr_b16 v[86:87], v19 offset:50176
  v_mfma_f32_32x32x16_bf16 v[192:207], v[104:107], v[96:99], v[192:207]
  s_add_u32 m0, s26, 131072
  s_add_u32 s23, s25, 2621440
  buffer_load_dwordx4 v5, s[12:15], s23 offen lds
  buffer_load_dwordx4 v6, s[12:15], s23 offen offset:1024 lds
  v_mfma_f32_32x32x16_bf16 v[208:223], v[108:111], v[96:99], v[208:223]
  v_mfma_f32_32x32x16_bf16 v[224:239], v[104:107], v[100:103], v[224:239]
  v_mfma_f32_32x32x16_bf16 v[240:255], v[108:111], v[100:103], v[240:255]
  s_waitcnt lgkmcnt(0)
  v_mfma_f32_32x32x16_bf16 v[128:143], v[80:83], v[64:67], v[128:143]
  ds_read_b128 v[88:91], v13 offset:0
  ds_read_b128 v[92:95], v13 offset:4096
  v_mfma_f32_32x32x16_bf16 v[144:159], v[84:87], v[64:67], v[144:159]
  ds_read_b128 v[96:99], v13 offset:8192
  ds_read_b128 v[100:103], v13 offset:12288
  v_mfma_f32_32x32x16_bf16 v[160:175], v[80:83], v[68:71], v[160:175]
  ds_read_b64_tr_b16 v[104:105], v18 offset:53248
  ds_read_b64_tr_b16 v[106:107], v18 offset:54272
  v_mfma_f32_32x32x16_bf16 v[176:191], v[84:87], v[68:71], v[176:191]
  ds_read_b64_tr_b16 v[108:109], v19 offset:53248
  ds_read_b64_tr_b16 v[110:111], v19 offset:54272
  v_mfma_f32_32x32x16_bf16 v[192:207], v[80:83], v[72:75], v[192:207]
  v_mfma_f32_32x32x16_bf16 v[208:223], v[84:87], v[72:75], v[208:223]
  v_mfma_f32_32x32x16_bf16 v[224:239], v[80:83], v[76:79], v[224:239]
  v_mfma_f32_32x32x16_bf16 v[240:255], v[84:87], v[76:79], v[240:255]
  s_waitcnt lgkmcnt(0)
  s_waitcnt vmcnt(8)
  s_barrier
  v_mfma_f32_32x32x16_bf16 v[128:143], v[104:107], v[88:91], v[128:143]
  ds_read_b128 v[64:67], v10 offset:32768
  ds_read_b128 v[68:71], v10 offset:36864
  v_mfma_f32_32x32x16_bf16 v[144:159], v[108:111], v[88:91], v[144:159]
  ds_read_b128 v[72:75], v10 offset:40960
  ds_read_b128 v[76:79], v10 offset:45056
  v_mfma_f32_32x32x16_bf16 v[160:175], v[104:107], v[92:95], v[160:175]
  ds_read_b64_tr_b16 v[80:81], v18 offset:0
  ds_read_b64_tr_b16 v[82:83], v18 offset:1024
  v_mfma_f32_32x32x16_bf16 v[176:191], v[108:111], v[92:95], v[176:191]
  ds_read_b64_tr_b16 v[84:85], v19 offset:0
  ds_read_b64_tr_b16 v[86:87], v19 offset:1024
  v_mfma_f32_32x32x16_bf16 v[192:207], v[104:107], v[96:99], v[192:207]
  s_add_u32 m0, s26, 147456
  s_add_u32 s23, s25, 2883584
  buffer_load_dwordx4 v5, s[12:15], s23 offen lds
  buffer_load_dwordx4 v6, s[12:15], s23 offen offset:1024 lds
  v_mfma_f32_32x32x16_bf16 v[208:223], v[108:111], v[96:99], v[208:223]
  v_mfma_f32_32x32x16_bf16 v[224:239], v[104:107], v[100:103], v[224:239]
  s_add_u32 m0, s26, 0
  s_add_u32 s22, s24, 768
  buffer_load_dwordx4 v3, s[8:11], s22 offen lds
  buffer_load_dwordx4 v4, s[8:11], s22 offen offset:1024 lds
  v_mfma_f32_32x32x16_bf16 v[240:255], v[108:111], v[100:103], v[240:255]
  s_waitcnt lgkmcnt(0)
  v_mfma_f32_32x32x16_bf16 v[128:143], v[80:83], v[64:67], v[128:143]
  ds_read_b128 v[88:91], v11 offset:32768
  ds_read_b128 v[92:95], v11 offset:36864
  v_mfma_f32_32x32x16_bf16 v[144:159], v[84:87], v[64:67], v[144:159]
  ds_read_b128 v[96:99], v11 offset:40960
  ds_read_b128 v[100:103], v11 offset:45056
  v_mfma_f32_32x32x16_bf16 v[160:175], v[80:83], v[68:71], v[160:175]
  ds_read_b64_tr_b16 v[104:105], v18 offset:4096
  ds_read_b64_tr_b16 v[106:107], v18 offset:5120
  v_mfma_f32_32x32x16_bf16 v[176:191], v[84:87], v[68:71], v[176:191]
  ds_read_b64_tr_b16 v[108:109], v19 offset:4096
  ds_read_b64_tr_b16 v[110:111], v19 offset:5120
  v_mfma_f32_32x32x16_bf16 v[192:207], v[80:83], v[72:75], v[192:207]
  s_add_u32 m0, s26, 16384
  s_add_u32 s22, s24, 131840
  buffer_load_dwordx4 v3, s[8:11], s22 offen lds
  buffer_load_dwordx4 v4, s[8:11], s22 offen offset:1024 lds
  v_mfma_f32_32x32x16_bf16 v[208:223], v[84:87], v[72:75], v[208:223]
  v_mfma_f32_32x32x16_bf16 v[224:239], v[80:83], v[76:79], v[224:239]
  v_mfma_f32_32x32x16_bf16 v[240:255], v[84:87], v[76:79], v[240:255]
  s_waitcnt lgkmcnt(0)
  s_waitcnt vmcnt(12)
  s_barrier
  s_mov_b32 s68, s50
  s_mov_b32 s69, s51
  s_mov_b32 s70, 0x80000
  s_mov_b32 s71, 0x00020000
  v_add_u32 v61, s28, v2
  v_subrev_u32 v61, 1, v61
  v_max_i32 v61, 0, v61
  v_min_i32 v61, 31, v61
  s_lshr_b32 s22, s40, 1
  v_writelane_b32 v61, s22, 3
  v_lshlrev_b32 v61, 2, v61
  buffer_load_dword v60, v61, s[80:83], 0 offen sc1
  v_mfma_f32_32x32x16_bf16 v[128:143], v[104:107], v[88:91], v[128:143]
  ds_read_b128 v[64:67], v12 offset:32768
  ds_read_b128 v[68:71], v12 offset:36864
  v_mfma_f32_32x32x16_bf16 v[144:159], v[108:111], v[88:91], v[144:159]
  ds_read_b128 v[72:75], v12 offset:40960
  ds_read_b128 v[76:79], v12 offset:45056
  v_mfma_f32_32x32x16_bf16 v[160:175], v[104:107], v[92:95], v[160:175]
  ds_read_b64_tr_b16 v[80:81], v18 offset:16384
  ds_read_b64_tr_b16 v[82:83], v18 offset:17408
  v_mfma_f32_32x32x16_bf16 v[176:191], v[108:111], v[92:95], v[176:191]
  ds_read_b64_tr_b16 v[84:85], v19 offset:16384
  ds_read_b64_tr_b16 v[86:87], v19 offset:17408
  v_mfma_f32_32x32x16_bf16 v[192:207], v[104:107], v[96:99], v[192:207]
  s_add_u32 m0, s26, 98304
  s_add_u32 s23, s25, 3145728
  buffer_load_dwordx4 v5, s[12:15], s23 offen lds
  buffer_load_dwordx4 v6, s[12:15], s23 offen offset:1024 lds
  v_mfma_f32_32x32x16_bf16 v[208:223], v[108:111], v[96:99], v[208:223]
  v_mfma_f32_32x32x16_bf16 v[224:239], v[104:107], v[100:103], v[224:239]
  v_mfma_f32_32x32x16_bf16 v[240:255], v[108:111], v[100:103], v[240:255]
  s_waitcnt lgkmcnt(0)
  v_mfma_f32_32x32x16_bf16 v[128:143], v[80:83], v[64:67], v[128:143]
  ds_read_b128 v[88:91], v13 offset:32768
  ds_read_b128 v[92:95], v13 offset:36864
  v_mfma_f32_32x32x16_bf16 v[144:159], v[84:87], v[64:67], v[144:159]
  ds_read_b128 v[96:99], v13 offset:40960
  ds_read_b128 v[100:103], v13 offset:45056
  v_mfma_f32_32x32x16_bf16 v[160:175], v[80:83], v[68:71], v[160:175]
  ds_read_b64_tr_b16 v[104:105], v18 offset:20480
  ds_read_b64_tr_b16 v[106:107], v18 offset:21504
  v_mfma_f32_32x32x16_bf16 v[176:191], v[84:87], v[68:71], v[176:191]
  ds_read_b64_tr_b16 v[108:109], v19 offset:20480
  ds_read_b64_tr_b16 v[110:111], v19 offset:21504
  v_mfma_f32_32x32x16_bf16 v[192:207], v[80:83], v[72:75], v[192:207]
  v_mfma_f32_32x32x16_bf16 v[208:223], v[84:87], v[72:75], v[208:223]
  v_mfma_f32_32x32x16_bf16 v[224:239], v[80:83], v[76:79], v[224:239]
  v_mfma_f32_32x32x16_bf16 v[240:255], v[84:87], v[76:79], v[240:255]
  s_waitcnt lgkmcnt(0)
  s_waitcnt vmcnt(9)
  s_barrier
  v_mfma_f32_32x32x16_bf16 v[128:143], v[104:107], v[88:91], v[128:143]
  ds_read_b128 v[64:67], v14 offset:0
  ds_read_b128 v[68:71], v14 offset:4096
  v_mfma_f32_32x32x16_bf16 v[144:159], v[108:111], v[88:91], v[144:159]
  ds_read_b128 v[72:75], v14 offset:8192
  ds_read_b128 v[76:79], v14 offset:12288
  v_mfma_f32_32x32x16_bf16 v[160:175], v[104:107], v[92:95], v[160:175]
  ds_read_b64_tr_b16 v[80:81], v18 offset:32768
  ds_read_b64_tr_b16 v[82:83], v18 offset:33792
  v_mfma_f32_32x32x16_bf16 v[176:191], v[108:111], v[92:95], v[176:191]
  ds_read_b64_tr_b16 v[84:85], v19 offset:32768
  ds_read_b64_tr_b16 v[86:87], v19 offset:33792
  v_mfma_f32_32x32x16_bf16 v[192:207], v[104:107], v[96:99], v[192:207]
  s_add_u32 m0, s26, 114688
  s_add_u32 s23, s25, 3407872
  buffer_load_dwordx4 v5, s[12:15], s23 offen lds
  buffer_load_dwordx4 v6, s[12:15], s23 offen offset:1024 lds
  v_mfma_f32_32x32x16_bf16 v[208:223], v[108:111], v[96:99], v[208:223]
  v_mfma_f32_32x32x16_bf16 v[224:239], v[104:107], v[100:103], v[224:239]
  s_add_u32 m0, s26, 32768
  s_add_u32 s22, s24, 896
  buffer_load_dwordx4 v3, s[8:11], s22 offen lds
  buffer_load_dwordx4 v4, s[8:11], s22 offen offset:1024 lds
  v_mfma_f32_32x32x16_bf16 v[240:255], v[108:111], v[100:103], v[240:255]
  s_waitcnt lgkmcnt(0)
  v_mfma_f32_32x32x16_bf16 v[128:143], v[80:83], v[64:67], v[128:143]
  ds_read_b128 v[88:91], v15 offset:0
  ds_read_b128 v[92:95], v15 offset:4096
  v_mfma_f32_32x32x16_bf16 v[144:159], v[84:87], v[64:67], v[144:159]
  ds_read_b128 v[96:99], v15 offset:8192
  ds_read_b128 v[100:103], v15 offset:12288
  v_mfma_f32_32x32x16_bf16 v[160:175], v[80:83], v[68:71], v[160:175]
  ds_read_b64_tr_b16 v[104:105], v18 offset:36864
  ds_read_b64_tr_b16 v[106:107], v18 offset:37888
  v_mfma_f32_32x32x16_bf16 v[176:191], v[84:87], v[68:71], v[176:191]
  ds_read_b64_tr_b16 v[108:109], v19 offset:36864
  ds_read_b64_tr_b16 v[110:111], v19 offset:37888
  v_mfma_f32_32x32x16_bf16 v[192:207], v[80:83], v[72:75], v[192:207]
  s_add_u32 m0, s26, 49152
  s_add_u32 s22, s24, 131968
  buffer_load_dwordx4 v3, s[8:11], s22 offen lds
  buffer_load_dwordx4 v4, s[8:11], s22 offen offset:1024 lds
  v_mfma_f32_32x32x16_bf16 v[208:223], v[84:87], v[72:75], v[208:223]
  v_mfma_f32_32x32x16_bf16 v[224:239], v[80:83], v[76:79], v[224:239]
  v_mfma_f32_32x32x16_bf16 v[240:255], v[84:87], v[76:79], v[240:255]
  s_waitcnt lgkmcnt(0)
  s_waitcnt vmcnt(13)
  s_barrier
  v_mfma_f32_32x32x16_bf16 v[128:143], v[104:107], v[88:91], v[128:143]
  ds_read_b128 v[64:67], v16 offset:0
  ds_read_b128 v[68:71], v16 offset:4096
  v_mfma_f32_32x32x16_bf16 v[144:159], v[108:111], v[88:91], v[144:159]
  ds_read_b128 v[72:75], v16 offset:8192
  ds_read_b128 v[76:79], v16 offset:12288
  v_mfma_f32_32x32x16_bf16 v[160:175], v[104:107], v[92:95], v[160:175]
  ds_read_b64_tr_b16 v[80:81], v18 offset:49152
  ds_read_b64_tr_b16 v[82:83], v18 offset:50176
  v_mfma_f32_32x32x16_bf16 v[176:191], v[108:111], v[92:95], v[176:191]
  ds_read_b64_tr_b16 v[84:85], v19 offset:49152
  ds_read_b64_tr_b16 v[86:87], v19 offset:50176
  v_mfma_f32_32x32x16_bf16 v[192:207], v[104:107], v[96:99], v[192:207]
  s_add_u32 m0, s26, 131072
  s_add_u32 s23, s25, 3670016
  buffer_load_dwordx4 v5, s[12:15], s23 offen lds
  buffer_load_dwordx4 v6, s[12:15], s23 offen offset:1024 lds
  v_mfma_f32_32x32x16_bf16 v[208:223], v[108:111], v[96:99], v[208:223]
  v_mfma_f32_32x32x16_bf16 v[224:239], v[104:107], v[100:103], v[224:239]
  v_mfma_f32_32x32x16_bf16 v[240:255], v[108:111], v[100:103], v[240:255]
  s_waitcnt lgkmcnt(0)
  v_mfma_f32_32x32x16_bf16 v[128:143], v[80:83], v[64:67], v[128:143]
  ds_read_b128 v[88:91], v17 offset:0
  ds_read_b128 v[92:95], v17 offset:4096
  v_mfma_f32_32x32x16_bf16 v[144:159], v[84:87], v[64:67], v[144:159]
  ds_read_b128 v[96:99], v17 offset:8192
  ds_read_b128 v[100:103], v17 offset:12288
  v_mfma_f32_32x32x16_bf16 v[160:175], v[80:83], v[68:71], v[160:175]
  ds_read_b64_tr_b16 v[104:105], v18 offset:53248
  ds_read_b64_tr_b16 v[106:107], v18 offset:54272
  v_mfma_f32_32x32x16_bf16 v[176:191], v[84:87], v[68:71], v[176:191]
  ds_read_b64_tr_b16 v[108:109], v19 offset:53248
  ds_read_b64_tr_b16 v[110:111], v19 offset:54272
  v_mfma_f32_32x32x16_bf16 v[192:207], v[80:83], v[72:75], v[192:207]
  v_mfma_f32_32x32x16_bf16 v[208:223], v[84:87], v[72:75], v[208:223]
  v_mfma_f32_32x32x16_bf16 v[224:239], v[80:83], v[76:79], v[224:239]
  v_mfma_f32_32x32x16_bf16 v[240:255], v[84:87], v[76:79], v[240:255]
  s_waitcnt lgkmcnt(0)
  s_waitcnt vmcnt(8)
  s_barrier
  s_mov_b32 s35, 65536
main_kernel_spin_3:
  v_and_b32 v60, 15, v60
  v_cmp_gt_u32 vcc, 8, v60
  s_nop 1
  s_and_b32 s22, vcc_lo, 15
  s_cbranch_scc0 main_kernel_ok_2
  s_sub_u32 s35, s35, 1
  s_cbranch_scc1 main_kernel_ok_2
  s_sleep 8
  buffer_load_dword v60, v61, s[80:83], 0 offen offset:0 sc1
  s_waitcnt vmcnt(0)
  s_branch main_kernel_spin_3
main_kernel_ok_2:
  v_mfma_f32_32x32x16_bf16 v[128:143], v[104:107], v[88:91], v[128:143]
  ds_read_b128 v[64:67], v10 offset:0
  ds_read_b128 v[68:71], v10 offset:4096
  v_mfma_f32_32x32x16_bf16 v[144:159], v[108:111], v[88:91], v[144:159]
  ds_read_b128 v[72:75], v10 offset:8192
  ds_read_b128 v[76:79], v10 offset:12288
  v_mfma_f32_32x32x16_bf16 v[160:175], v[104:107], v[92:95], v[160:175]
  ds_read_b64_tr_b16 v[80:81], v18 offset:0
  ds_read_b64_tr_b16 v[82:83], v18 offset:1024
  v_mfma_f32_32x32x16_bf16 v[176:191], v[108:111], v[92:95], v[176:191]
  ds_read_b64_tr_b16 v[84:85], v19 offset:0
  ds_read_b64_tr_b16 v[86:87], v19 offset:1024
  v_mfma_f32_32x32x16_bf16 v[192:207], v[104:107], v[96:99], v[192:207]
  s_mul_i32 s22, s20, 32768
  s_add_u32 s22, s22, 0
  s_lshl_b32 s23, s29, 7
  s_add_u32 s22, s22, s23
  s_mul_i32 s23, s20, 4096
  s_add_u32 m0, s23, 65536
  s_nop 0
  buffer_load_dwordx4 v23, s[68:71], s22 offen lds
  s_add_u32 m0, m0, 1024
  s_add_u32 s22, s22, 8192
  s_nop 0
  buffer_load_dwordx4 v23, s[68:71], s22 offen lds
  s_add_u32 m0, m0, 1024
  s_add_u32 s22, s22, 8192
  s_nop 0
  buffer_load_dwordx4 v23, s[68:71], s22 offen lds
  s_add_u32 m0, m0, 1024
  s_add_u32 s22, s22, 8192
  s_nop 0
  buffer_load_dwordx4 v23, s[68:71], s22 offen lds
  v_mfma_f32_32x32x16_bf16 v[208:223], v[108:111], v[96:99], v[208:223]
  v_mfma_f32_32x32x16_bf16 v[224:239], v[104:107], v[100:103], v[224:239]
  s_add_u32 m0, s26, 147456
  s_add_u32 s23, s25, 3932160
  buffer_load_dwordx4 v5, s[12:15], s23 offen lds
  buffer_load_dwordx4 v6, s[12:15], s23 offen offset:1024 lds
  v_mfma_f32_32x32x16_bf16 v[240:255], v[108:111], v[100:103], v[240:255]
  s_waitcnt lgkmcnt(0)
  v_mfma_f32_32x32x16_bf16 v[128:143], v[80:83], v[64:67], v[128:143]
  ds_read_b128 v[88:91], v11 offset:0
  ds_read_b128 v[92:95], v11 offset:4096
  v_mfma_f32_32x32x16_bf16 v[144:159], v[84:87], v[64:67], v[144:159]
  ds_read_b128 v[96:99], v11 offset:8192
  ds_read_b128 v[100:103], v11 offset:12288
  v_mfma_f32_32x32x16_bf16 v[160:175], v[80:83], v[68:71], v[160:175]
  ds_read_b64_tr_b16 v[104:105], v18 offset:4096
  ds_read_b64_tr_b16 v[106:107], v18 offset:5120
  v_mfma_f32_32x32x16_bf16 v[176:191], v[84:87], v[68:71], v[176:191]
  ds_read_b64_tr_b16 v[108:109], v19 offset:4096
  ds_read_b64_tr_b16 v[110:111], v19 offset:5120
  v_mfma_f32_32x32x16_bf16 v[192:207], v[80:83], v[72:75], v[192:207]
  v_mfma_f32_32x32x16_bf16 v[208:223], v[84:87], v[72:75], v[208:223]
  v_mfma_f32_32x32x16_bf16 v[224:239], v[80:83], v[76:79], v[224:239]
  v_mfma_f32_32x32x16_bf16 v[240:255], v[84:87], v[76:79], v[240:255]
  s_waitcnt lgkmcnt(0)
  s_waitcnt vmcnt(12)
  s_barrier
  v_mfma_f32_32x32x16_bf16 v[128:143], v[104:107], v[88:91], v[128:143]
  ds_read_b128 v[64:67], v12 offset:0
  ds_read_b128 v[68:71], v12 offset:4096
  v_mfma_f32_32x32x16_bf16 v[144:159], v[108:111], v[88:91], v[144:159]
  ds_read_b128 v[72:75], v12 offset:8192
  ds_read_b128 v[76:79], v12 offset:12288
  v_mfma_f32_32x32x16_bf16 v[160:175], v[104:107], v[92:95], v[160:175]
  ds_read_b64_tr_b16 v[80:81], v18 offset:16384
  ds_read_b64_tr_b16 v[82:83], v18 offset:17408
  v_mfma_f32_32x32x16_bf16 v[176:191], v[108:111], v[92:95], v[176:191]
  ds_read_b64_tr_b16 v[84:85], v19 offset:16384
  ds_read_b64_tr_b16 v[86:87], v19 offset:17408
  v_mfma_f32_32x32x16_bf16 v[192:207], v[104:107], v[96:99], v[192:207]
  s_mul_i32 s22, s20, 16384
  s_add_u32 s22, s22, 262144
  s_lshl_b32 s23, s29, 7
  s_add_u32 s22, s22, s23
  s_mul_i32 s23, s20, 2048
  s_add_u32 m0, s23, 98304
  s_nop 0
  buffer_load_dwordx4 v23, s[68:71], s22 offen lds
  s_add_u32 m0, m0, 1024
  s_add_u32 s22, s22, 8192
  s_nop 0
  buffer_load_dwordx4 v23, s[68:71], s22 offen lds
  v_mfma_f32_32x32x16_bf16 v[208:223], v[108:111], v[96:99], v[208:223]
  v_mfma_f32_32x32x16_bf16 v[224:239], v[104:107], v[100:103], v[224:239]
  s_lshr_b32 s23, s31, 1
  s_add_u32 s23, s23, 1
  s_sub_u32 s34, 0, s23
  s_bitcmp1_b32 s31, 0
  s_cselect_b32 s23, s23, s34
  s_lshl_b32 s22, s32, 5
  s_add_u32 s22, s22, s23
  v_add_u32 v61, s22, v21
  v_ashrrev_i32 v62, 5, v61
  v_lshlrev_b32 v62, 15, v62
  v_and_b32 v61, 31, v61
  v_lshl_add_u32 v62, v61, 4, v62
  v_lshl_add_u32 v62, v22, 9, v62
  s_lshl_b32 s22, s31, 13
  s_add_u32 s23, s22, 4096
  buffer_load_dwordx4 v[24:27], v62, s[72:75], s22 offen sc1
  buffer_load_dwordx4 v[28:31], v62, s[72:75], s22 offen offset:1024 sc1
  buffer_load_dwordx4 v[32:35], v62, s[72:75], s22 offen offset:2048 sc1
  buffer_load_dwordx4 v[36:39], v62, s[72:75], s22 offen offset:3072 sc1
  buffer_load_dwordx4 v[40:43], v62, s[72:75], s23 offen sc1
  buffer_load_dwordx4 v[44:47], v62, s[72:75], s23 offen offset:1024 sc1
  buffer_load_dwordx4 v[48:51], v62, s[72:75], s23 offen offset:2048 sc1
  buffer_load_dwordx4 v[52:55], v62, s[72:75], s23 offen offset:3072 sc1
  v_mfma_f32_32x32x16_bf16 v[240:255], v[108:111], v[100:103], v[240:255]
  s_waitcnt lgkmcnt(0)
  v_mfma_f32_32x32x16_bf16 v[128:143], v[80:83], v[64:67], v[128:143]
  ds_read_b128 v[88:91], v13 offset:0
  ds_read_b128 v[92:95], v13 offset:4096
  v_mfma_f32_32x32x16_bf16 v[144:159], v[84:87], v[64:67], v[144:159]
  ds_read_b128 v[96:99], v13 offset:8192
  ds_read_b128 v[100:103], v13 offset:12288
  v_mfma_f32_32x32x16_bf16 v[160:175], v[80:83], v[68:71], v[160:175]
  ds_read_b64_tr_b16 v[104:105], v18 offset:20480
  ds_read_b64_tr_b16 v[106:107], v18 offset:21504
  v_mfma_f32_32x32x16_bf16 v[176:191], v[84:87], v[68:71], v[176:191]
  ds_read_b64_tr_b16 v[108:109], v19 offset:20480
  ds_read_b64_tr_b16 v[110:111], v19 offset:21504
  v_mfma_f32_32x32x16_bf16 v[192:207], v[80:83], v[72:75], v[192:207]
  v_mfma_f32_32x32x16_bf16 v[208:223], v[84:87], v[72:75], v[208:223]
  v_mfma_f32_32x32x16_bf16 v[224:239], v[80:83], v[76:79], v[224:239]
  v_mfma_f32_32x32x16_bf16 v[240:255], v[84:87], v[76:79], v[240:255]
  s_waitcnt lgkmcnt(0)
  s_waitcnt vmcnt(16)
  s_barrier
  v_mfma_f32_32x32x16_bf16 v[128:143], v[104:107], v[88:91], v[128:143]
  ds_read_b128 v[64:67], v10 offset:32768
  ds_read_b128 v[68:71], v10 offset:36864
  v_mfma_f32_32x32x16_bf16 v[144:159], v[108:111], v[88:91], v[144:159]
  ds_read_b128 v[72:75], v10 offset:40960
  ds_read_b128 v[76:79], v10 offset:45056
  v_mfma_f32_32x32x16_bf16 v[160:175], v[104:107], v[92:95], v[160:175]
  ds_read_b64_tr_b16 v[80:81], v18 offset:32768
  ds_read_b64_tr_b16 v[82:83], v18 offset:33792
  v_mfma_f32_32x32x16_bf16 v[176:191], v[108:111], v[92:95], v[176:191]
  ds_read_b64_tr_b16 v[84:85], v19 offset:32768
  ds_read_b64_tr_b16 v[86:87], v19 offset:33792
  v_mfma_f32_32x32x16_bf16 v[192:207], v[104:107], v[96:99], v[192:207]
  s_mul_i32 s22, s20, 16384
  s_add_u32 s22, s22, 393216
  s_lshl_b32 s23, s29, 7
  s_add_u32 s22, s22, s23
  s_mul_i32 s23, s20, 2048
  s_add_u32 m0, s23, 114688
  s_nop 0
  buffer_load_dwordx4 v23, s[68:71], s22 offen lds
  s_add_u32 m0, m0, 1024
  s_add_u32 s22, s22, 8192
  s_nop 0
  buffer_load_dwordx4 v23, s[68:71], s22 offen lds
  v_mfma_f32_32x32x16_bf16 v[208:223], v[108:111], v[96:99], v[208:223]
  v_mfma_f32_32x32x16_bf16 v[224:239], v[104:107], v[100:103], v[224:239]
  s_add_u32 m0, s42, 0
  s_add_u32 s22, s45, 0
  buffer_load_dwordx4 v5, s[64:67], s22 offen lds
  s_add_u32 m0, s42, 8192
  s_add_u32 s22, s45, 262144
  buffer_load_dwordx4 v5, s[64:67], s22 offen lds
  s_add_u32 m0, s42, 16384
  s_add_u32 s22, s45, 524288
  buffer_load_dwordx4 v5, s[64:67], s22 offen lds
  s_add_u32 m0, s42, 24576
  s_add_u32 s22, s45, 786432
  buffer_load_dwordx4 v5, s[64:67], s22 offen lds
  v_mfma_f32_32x32x16_bf16 v[240:255], v[108:111], v[100:103], v[240:255]
  s_waitcnt lgkmcnt(0)
  v_mfma_f32_32x32x16_bf16 v[128:143], v[80:83], v[64:67], v[128:143]
  ds_read_b128 v[88:91], v11 offset:32768
  ds_read_b128 v[92:95], v11 offset:36864
  v_mfma_f32_32x32x16_bf16 v[144:159], v[84:87], v[64:67], v[144:159]
  ds_read_b128 v[96:99], v11 offset:40960
  ds_read_b128 v[100:103], v11 offset:45056
  v_mfma_f32_32x32x16_bf16 v[160:175], v[80:83], v[68:71], v[160:175]
  ds_read_b64_tr_b16 v[104:105], v18 offset:36864
  ds_read_b64_tr_b16 v[106:107], v18 offset:37888
  v_mfma_f32_32x32x16_bf16 v[176:191], v[84:87], v[68:71], v[176:191]
  ds_read_b64_tr_b16 v[108:109], v19 offset:36864
  ds_read_b64_tr_b16 v[110:111], v19 offset:37888
  v_mfma_f32_32x32x16_bf16 v[192:207], v[80:83], v[72:75], v[192:207]
  v_mfma_f32_32x32x16_bf16 v[208:223], v[84:87], v[72:75], v[208:223]
  v_mfma_f32_32x32x16_bf16 v[224:239], v[80:83], v[76:79], v[224:239]
  v_mfma_f32_32x32x16_bf16 v[240:255], v[84:87], v[76:79], v[240:255]
  s_waitcnt lgkmcnt(0)
  s_waitcnt vmcnt(16)
  s_barrier
  v_mfma_f32_32x32x16_bf16 v[128:143], v[104:107], v[88:91], v[128:143]
  ds_read_b128 v[64:67], v12 offset:32768
  ds_read_b128 v[68:71], v12 offset:36864
  v_mfma_f32_32x32x16_bf16 v[144:159], v[108:111], v[88:91], v[144:159]
  ds_read_b128 v[72:75], v12 offset:40960
  ds_read_b128 v[76:79], v12 offset:45056
  v_mfma_f32_32x32x16_bf16 v[160:175], v[104:107], v[92:95], v[160:175]
  ds_read_b64_tr_b16 v[80:81], v18 offset:49152
  ds_read_b64_tr_b16 v[82:83], v18 offset:50176
  v_mfma_f32_32x32x16_bf16 v[176:191], v[108:111], v[92:95], v[176:191]
  ds_read_b64_tr_b16 v[84:85], v19 offset:49152
  ds_read_b64_tr_b16 v[86:87], v19 offset:50176
  v_mfma_f32_32x32x16_bf16 v[192:207], v[104:107], v[96:99], v[192:207]
  v_mfma_f32_32x32x16_bf16 v[208:223], v[108:111], v[96:99], v[208:223]
  v_mfma_f32_32x32x16_bf16 v[224:239], v[104:107], v[100:103], v[224:239]
  v_mfma_f32_32x32x16_bf16 v[240:255], v[108:111], v[100:103], v[240:255]
  s_waitcnt lgkmcnt(0)
  v_mfma_f32_32x32x16_bf16 v[128:143], v[80:83], v[64:67], v[128:143]
  ds_read_b128 v[88:91], v13 offset:32768
  ds_read_b128 v[92:95], v13 offset:36864
  v_mfma_f32_32x32x16_bf16 v[144:159], v[84:87], v[64:67], v[144:159]
  ds_read_b128 v[96:99], v13 offset:40960
  ds_read_b128 v[100:103], v13 offset:45056
  v_mfma_f32_32x32x16_bf16 v[160:175], v[80:83], v[68:71], v[160:175]
  ds_read_b64_tr_b16 v[104:105], v18 offset:53248
  ds_read_b64_tr_b16 v[106:107], v18 offset:54272
  v_mfma_f32_32x32x16_bf16 v[176:191], v[84:87], v[68:71], v[176:191]
  ds_read_b64_tr_b16 v[108:109], v19 offset:53248
  ds_read_b64_tr_b16 v[110:111], v19 offset:54272
  v_mfma_f32_32x32x16_bf16 v[192:207], v[80:83], v[72:75], v[192:207]
  v_mfma_f32_32x32x16_bf16 v[208:223], v[84:87], v[72:75], v[208:223]
  v_mfma_f32_32x32x16_bf16 v[224:239], v[80:83], v[76:79], v[224:239]
  v_mfma_f32_32x32x16_bf16 v[240:255], v[84:87], v[76:79], v[240:255]
  s_waitcnt lgkmcnt(0)
  v_mfma_f32_32x32x16_bf16 v[128:143], v[104:107], v[88:91], v[128:143]
  v_mfma_f32_32x32x16_bf16 v[144:159], v[108:111], v[88:91], v[144:159]
  v_mfma_f32_32x32x16_bf16 v[160:175], v[104:107], v[92:95], v[160:175]
  v_mfma_f32_32x32x16_bf16 v[176:191], v[108:111], v[92:95], v[176:191]
  v_mfma_f32_32x32x16_bf16 v[192:207], v[104:107], v[96:99], v[192:207]
  v_mfma_f32_32x32x16_bf16 v[208:223], v[108:111], v[96:99], v[208:223]
  v_mfma_f32_32x32x16_bf16 v[224:239], v[104:107], v[100:103], v[224:239]
  v_mfma_f32_32x32x16_bf16 v[240:255], v[108:111], v[100:103], v[240:255]
  s_branch main_kernel_J
main_kernel_V:
  s_waitcnt vmcnt(13)
  s_barrier
  ds_read_b128 v[64:67], v10 offset:0
  ds_read_b128 v[68:71], v10 offset:4096
  ds_read_b128 v[72:75], v10 offset:8192
  ds_read_b128 v[76:79], v10 offset:12288
  ds_read_b64_tr_b16 v[80:81], v18 offset:0
  ds_read_b64_tr_b16 v[82:83], v18 offset:1024
  ds_read_b64_tr_b16 v[84:85], v19 offset:0
  ds_read_b64_tr_b16 v[86:87], v19 offset:1024
  s_waitcnt lgkmcnt(0)
  v_mfma_f32_32x32x16_bf16 v[128:143], v[64:67], v[80:83], 0
  ds_read_b128 v[88:91], v11 offset:0
  ds_read_b128 v[92:95], v11 offset:4096
  v_mfma_f32_32x32x16_bf16 v[144:159], v[64:67], v[84:87], 0
  ds_read_b128 v[96:99], v11 offset:8192
  ds_read_b128 v[100:103], v11 offset:12288
  v_mfma_f32_32x32x16_bf16 v[160:175], v[68:71], v[80:83], 0
  ds_read_b64_tr_b16 v[104:105], v18 offset:4096
  ds_read_b64_tr_b16 v[106:107], v18 offset:5120
  v_mfma_f32_32x32x16_bf16 v[176:191], v[68:71], v[84:87], 0
  ds_read_b64_tr_b16 v[108:109], v19 offset:4096
  ds_read_b64_tr_b16 v[110:111], v19 offset:5120
  v_mfma_f32_32x32x16_bf16 v[192:207], v[72:75], v[80:83], 0
  s_add_u32 m0, s26, 65536
  s_add_u32 s22, s24, 256
  buffer_load_dwordx4 v3, s[8:11], s22 offen lds
  buffer_load_dwordx4 v4, s[8:11], s22 offen offset:1024 lds
  v_mfma_f32_32x32x16_bf16 v[208:223], v[72:75], v[84:87], 0
  v_mfma_f32_32x32x16_bf16 v[224:239], v[76:79], v[80:83], 0
  v_mfma_f32_32x32x16_bf16 v[240:255], v[76:79], v[84:87], 0
  s_waitcnt lgkmcnt(0)
  s_waitcnt vmcnt(7)
  s_barrier
  v_mfma_f32_32x32x16_bf16 v[128:143], v[88:91], v[104:107], v[128:143]
  ds_read_b128 v[64:67], v12 offset:0
  ds_read_b128 v[68:71], v12 offset:4096
  v_mfma_f32_32x32x16_bf16 v[144:159], v[88:91], v[108:111], v[144:159]
  ds_read_b128 v[72:75], v12 offset:8192
  ds_read_b128 v[76:79], v12 offset:12288
  v_mfma_f32_32x32x16_bf16 v[160:175], v[92:95], v[104:107], v[160:175]
  ds_read_b64_tr_b16 v[80:81], v18 offset:16384
  ds_read_b64_tr_b16 v[82:83], v18 offset:17408
  v_mfma_f32_32x32x16_bf16 v[176:191], v[92:95], v[108:111], v[176:191]
  ds_read_b64_tr_b16 v[84:85], v19 offset:16384
  ds_read_b64_tr_b16 v[86:87], v19 offset:17408
  v_mfma_f32_32x32x16_bf16 v[192:207], v[96:99], v[104:107], v[192:207]
  s_add_u32 m0, s26, 98304
  s_add_u32 s23, s25, 1048576
  buffer_load_dwordx4 v5, s[12:15], s23 offen lds
  buffer_load_dwordx4 v6, s[12:15], s23 offen offset:1024 lds
  v_mfma_f32_32x32x16_bf16 v[208:223], v[96:99], v[108:111], v[208:223]
  v_mfma_f32_32x32x16_bf16 v[224:239], v[100:103], v[104:107], v[224:239]
  v_mfma_f32_32x32x16_bf16 v[240:255], v[100:103], v[108:111], v[240:255]
  s_waitcnt lgkmcnt(0)
  v_mfma_f32_32x32x16_bf16 v[128:143], v[64:67], v[80:83], v[128:143]
  ds_read_b128 v[88:91], v13 offset:0
  ds_read_b128 v[92:95], v13 offset:4096
  v_mfma_f32_32x32x16_bf16 v[144:159], v[64:67], v[84:87], v[144:159]
  ds_read_b128 v[96:99], v13 offset:8192
  ds_read_b128 v[100:103], v13 offset:12288
  v_mfma_f32_32x32x16_bf16 v[160:175], v[68:71], v[80:83], v[160:175]
  ds_read_b64_tr_b16 v[104:105], v18 offset:20480
  ds_read_b64_tr_b16 v[106:107], v18 offset:21504
  v_mfma_f32_32x32x16_bf16 v[176:191], v[68:71], v[84:87], v[176:191]
  ds_read_b64_tr_b16 v[108:109], v19 offset:20480
  ds_read_b64_tr_b16 v[110:111], v19 offset:21504
  v_mfma_f32_32x32x16_bf16 v[192:207], v[72:75], v[80:83], v[192:207]
  s_add_u32 m0, s26, 81920
  s_add_u32 s22, s24, 131328
  buffer_load_dwordx4 v3, s[8:11], s22 offen lds
  buffer_load_dwordx4 v4, s[8:11], s22 offen offset:1024 lds
  v_mfma_f32_32x32x16_bf16 v[208:223], v[72:75], v[84:87], v[208:223]
  v_mfma_f32_32x32x16_bf16 v[224:239], v[76:79], v[80:83], v[224:239]
  v_mfma_f32_32x32x16_bf16 v[240:255], v[76:79], v[84:87], v[240:255]
  s_waitcnt lgkmcnt(0)
  s_waitcnt vmcnt(9)
  s_barrier
  v_mfma_f32_32x32x16_bf16 v[128:143], v[88:91], v[104:107], v[128:143]
  ds_read_b128 v[64:67], v10 offset:32768
  ds_read_b128 v[68:71], v10 offset:36864
  v_mfma_f32_32x32x16_bf16 v[144:159], v[88:91], v[108:111], v[144:159]
  ds_read_b128 v[72:75], v10 offset:40960
  ds_read_b128 v[76:79], v10 offset:45056
  v_mfma_f32_32x32x16_bf16 v[160:175], v[92:95], v[104:107], v[160:175]
  ds_read_b64_tr_b16 v[80:81], v18 offset:32768
  ds_read_b64_tr_b16 v[82:83], v18 offset:33792
  v_mfma_f32_32x32x16_bf16 v[176:191], v[92:95], v[108:111], v[176:191]
  ds_read_b64_tr_b16 v[84:85], v19 offset:32768
  ds_read_b64_tr_b16 v[86:87], v19 offset:33792
  v_mfma_f32_32x32x16_bf16 v[192:207], v[96:99], v[104:107], v[192:207]
  s_add_u32 m0, s26, 114688
  s_add_u32 s23, s25, 1310720
  buffer_load_dwordx4 v5, s[12:15], s23 offen lds
  buffer_load_dwordx4 v6, s[12:15], s23 offen offset:1024 lds
  v_mfma_f32_32x32x16_bf16 v[208:223], v[96:99], v[108:111], v[208:223]
  v_mfma_f32_32x32x16_bf16 v[224:239], v[100:103], v[104:107], v[224:239]
  s_add_u32 m0, s26, 0
  s_add_u32 s22, s24, 384
  buffer_load_dwordx4 v3, s[8:11], s22 offen lds
  buffer_load_dwordx4 v4, s[8:11], s22 offen offset:1024 lds
  v_mfma_f32_32x32x16_bf16 v[240:255], v[100:103], v[108:111], v[240:255]
  s_waitcnt lgkmcnt(0)
  v_mfma_f32_32x32x16_bf16 v[128:143], v[64:67], v[80:83], v[128:143]
  ds_read_b128 v[88:91], v11 offset:32768
  ds_read_b128 v[92:95], v11 offset:36864
  v_mfma_f32_32x32x16_bf16 v[144:159], v[64:67], v[84:87], v[144:159]
  ds_read_b128 v[96:99], v11 offset:40960
  ds_read_b128 v[100:103], v11 offset:45056
  v_mfma_f32_32x32x16_bf16 v[160:175], v[68:71], v[80:83], v[160:175]
  ds_read_b64_tr_b16 v[104:105], v18 offset:36864
  ds_read_b64_tr_b16 v[106:107], v18 offset:37888
  v_mfma_f32_32x32x16_bf16 v[176:191], v[68:71], v[84:87], v[176:191]
  ds_read_b64_tr_b16 v[108:109], v19 offset:36864
  ds_read_b64_tr_b16 v[110:111], v19 offset:37888
  v_mfma_f32_32x32x16_bf16 v[192:207], v[72:75], v[80:83], v[192:207]
  s_add_u32 m0, s26, 16384
  s_add_u32 s22, s24, 131456
  buffer_load_dwordx4 v3, s[8:11], s22 offen lds
  buffer_load_dwordx4 v4, s[8:11], s22 offen offset:1024 lds
  v_mfma_f32_32x32x16_bf16 v[208:223], v[72:75], v[84:87], v[208:223]
  v_mfma_f32_32x32x16_bf16 v[224:239], v[76:79], v[80:83], v[224:239]
  v_mfma_f32_32x32x16_bf16 v[240:255], v[76:79], v[84:87], v[240:255]
  s_waitcnt lgkmcnt(0)
  s_waitcnt vmcnt(13)
  s_barrier
  v_mfma_f32_32x32x16_bf16 v[128:143], v[88:91], v[104:107], v[128:143]
  ds_read_b128 v[64:67], v12 offset:32768
  ds_read_b128 v[68:71], v12 offset:36864
  v_mfma_f32_32x32x16_bf16 v[144:159], v[88:91], v[108:111], v[144:159]
  ds_read_b128 v[72:75], v12 offset:40960
  ds_read_b128 v[76:79], v12 offset:45056
  v_mfma_f32_32x32x16_bf16 v[160:175], v[92:95], v[104:107], v[160:175]
  ds_read_b64_tr_b16 v[80:81], v18 offset:49152
  ds_read_b64_tr_b16 v[82:83], v18 offset:50176
  v_mfma_f32_32x32x16_bf16 v[176:191], v[92:95], v[108:111], v[176:191]
  ds_read_b64_tr_b16 v[84:85], v19 offset:49152
  ds_read_b64_tr_b16 v[86:87], v19 offset:50176
  v_mfma_f32_32x32x16_bf16 v[192:207], v[96:99], v[104:107], v[192:207]
  s_add_u32 m0, s26, 131072
  s_add_u32 s23, s25, 1572864
  buffer_load_dwordx4 v5, s[12:15], s23 offen lds
  buffer_load_dwordx4 v6, s[12:15], s23 offen offset:1024 lds
  v_mfma_f32_32x32x16_bf16 v[208:223], v[96:99], v[108:111], v[208:223]
  v_mfma_f32_32x32x16_bf16 v[224:239], v[100:103], v[104:107], v[224:239]
  v_mfma_f32_32x32x16_bf16 v[240:255], v[100:103], v[108:111], v[240:255]
  s_waitcnt lgkmcnt(0)
  v_mfma_f32_32x32x16_bf16 v[128:143], v[64:67], v[80:83], v[128:143]
  ds_read_b128 v[88:91], v13 offset:32768
  ds_read_b128 v[92:95], v13 offset:36864
  v_mfma_f32_32x32x16_bf16 v[144:159], v[64:67], v[84:87], v[144:159]
  ds_read_b128 v[96:99], v13 offset:40960
  ds_read_b128 v[100:103], v13 offset:45056
  v_mfma_f32_32x32x16_bf16 v[160:175], v[68:71], v[80:83], v[160:175]
  ds_read_b64_tr_b16 v[104:105], v18 offset:53248
  ds_read_b64_tr_b16 v[106:107], v18 offset:54272
  v_mfma_f32_32x32x16_bf16 v[176:191], v[68:71], v[84:87], v[176:191]
  ds_read_b64_tr_b16 v[108:109], v19 offset:53248
  ds_read_b64_tr_b16 v[110:111], v19 offset:54272
  v_mfma_f32_32x32x16_bf16 v[192:207], v[72:75], v[80:83], v[192:207]
  v_mfma_f32_32x32x16_bf16 v[208:223], v[72:75], v[84:87], v[208:223]
  v_mfma_f32_32x32x16_bf16 v[224:239], v[76:79], v[80:83], v[224:239]
  v_mfma_f32_32x32x16_bf16 v[240:255], v[76:79], v[84:87], v[240:255]
  s_waitcnt lgkmcnt(0)
  s_waitcnt vmcnt(8)
  s_barrier
  v_mfma_f32_32x32x16_bf16 v[128:143], v[88:91], v[104:107], v[128:143]
  ds_read_b128 v[64:67], v14 offset:0
  ds_read_b128 v[68:71], v14 offset:4096
  v_mfma_f32_32x32x16_bf16 v[144:159], v[88:91], v[108:111], v[144:159]
  ds_read_b128 v[72:75], v14 offset:8192
  ds_read_b128 v[76:79], v14 offset:12288
  v_mfma_f32_32x32x16_bf16 v[160:175], v[92:95], v[104:107], v[160:175]
  ds_read_b64_tr_b16 v[80:81], v18 offset:0
  ds_read_b64_tr_b16 v[82:83], v18 offset:1024
  v_mfma_f32_32x32x16_bf16 v[176:191], v[92:95], v[108:111], v[176:191]
  ds_read_b64_tr_b16 v[84:85], v19 offset:0
  ds_read_b64_tr_b16 v[86:87], v19 offset:1024
  v_mfma_f32_32x32x16_bf16 v[192:207], v[96:99], v[104:107], v[192:207]
  s_add_u32 m0, s26, 147456
  s_add_u32 s23, s25, 1835008
  buffer_load_dwordx4 v5, s[12:15], s23 offen lds
  buffer_load_dwordx4 v6, s[12:15], s23 offen offset:1024 lds
  v_mfma_f32_32x32x16_bf16 v[208:223], v[96:99], v[108:111], v[208:223]
  v_mfma_f32_32x32x16_bf16 v[224:239], v[100:103], v[104:107], v[224:239]
  s_add_u32 m0, s26, 32768
  s_add_u32 s22, s24, 512
  buffer_load_dwordx4 v3, s[8:11], s22 offen lds
  buffer_load_dwordx4 v4, s[8:11], s22 offen offset:1024 lds
  v_mfma_f32_32x32x16_bf16 v[240:255], v[100:103], v[108:111], v[240:255]
  s_waitcnt lgkmcnt(0)
  v_mfma_f32_32x32x16_bf16 v[128:143], v[64:67], v[80:83], v[128:143]
  ds_read_b128 v[88:91], v15 offset:0
  ds_read_b128 v[92:95], v15 offset:4096
  v_mfma_f32_32x32x16_bf16 v[144:159], v[64:67], v[84:87], v[144:159]
  ds_read_b128 v[96:99], v15 offset:8192
  ds_read_b128 v[100:103], v15 offset:12288
  v_mfma_f32_32x32x16_bf16 v[160:175], v[68:71], v[80:83], v[160:175]
  ds_read_b64_tr_b16 v[104:105], v18 offset:4096
  ds_read_b64_tr_b16 v[106:107], v18 offset:5120
  v_mfma_f32_32x32x16_bf16 v[176:191], v[68:71], v[84:87], v[176:191]
  ds_read_b64_tr_b16 v[108:109], v19 offset:4096
  ds_read_b64_tr_b16 v[110:111], v19 offset:5120
  v_mfma_f32_32x32x16_bf16 v[192:207], v[72:75], v[80:83], v[192:207]
  s_add_u32 m0, s26, 49152
  s_add_u32 s22, s24, 131584
  buffer_load_dwordx4 v3, s[8:11], s22 offen lds
  buffer_load_dwordx4 v4, s[8:11], s22 offen offset:1024 lds
  v_mfma_f32_32x32x16_bf16 v[208:223], v[72:75], v[84:87], v[208:223]
  v_mfma_f32_32x32x16_bf16 v[224:239], v[76:79], v[80:83], v[224:239]
  v_mfma_f32_32x32x16_bf16 v[240:255], v[76:79], v[84:87], v[240:255]
  s_waitcnt lgkmcnt(0)
  s_waitcnt vmcnt(12)
  s_barrier
  s_cmp_lg_u32 s20, 0
  s_cbranch_scc1 main_kernel_sig_4
  s_lshl_b32 s22, s28, 2
  v_mov_b32 v62, 0
  v_mov_b32 v63, 1
  s_mov_b64 exec, 1
  buffer_atomic_add v63, v62, s[80:83], s22 offen
  s_mov_b64 exec, -1
main_kernel_sig_4:
  v_mfma_f32_32x32x16_bf16 v[128:143], v[88:91], v[104:107], v[128:143]
  ds_read_b128 v[64:67], v16 offset:0
  ds_read_b128 v[68:71], v16 offset:4096
  v_mfma_f32_32x32x16_bf16 v[144:159], v[88:91], v[108:111], v[144:159]
  ds_read_b128 v[72:75], v16 offset:8192
  ds_read_b128 v[76:79], v16 offset:12288
  v_mfma_f32_32x32x16_bf16 v[160:175], v[92:95], v[104:107], v[160:175]
  ds_read_b64_tr_b16 v[80:81], v18 offset:16384
  ds_read_b64_tr_b16 v[82:83], v18 offset:17408
  v_mfma_f32_32x32x16_bf16 v[176:191], v[92:95], v[108:111], v[176:191]
  ds_read_b64_tr_b16 v[84:85], v19 offset:16384
  ds_read_b64_tr_b16 v[86:87], v19 offset:17408
  v_mfma_f32_32x32x16_bf16 v[192:207], v[96:99], v[104:107], v[192:207]
  s_add_u32 m0, s26, 98304
  s_add_u32 s23, s25, 2097152
  buffer_load_dwordx4 v5, s[12:15], s23 offen lds
  buffer_load_dwordx4 v6, s[12:15], s23 offen offset:1024 lds
  v_mfma_f32_32x32x16_bf16 v[208:223], v[96:99], v[108:111], v[208:223]
  v_mfma_f32_32x32x16_bf16 v[224:239], v[100:103], v[104:107], v[224:239]
  v_mfma_f32_32x32x16_bf16 v[240:255], v[100:103], v[108:111], v[240:255]
  s_waitcnt lgkmcnt(0)
  v_mfma_f32_32x32x16_bf16 v[128:143], v[64:67], v[80:83], v[128:143]
  ds_read_b128 v[88:91], v17 offset:0
  ds_read_b128 v[92:95], v17 offset:4096
  v_mfma_f32_32x32x16_bf16 v[144:159], v[64:67], v[84:87], v[144:159]
  ds_read_b128 v[96:99], v17 offset:8192
  ds_read_b128 v[100:103], v17 offset:12288
  v_mfma_f32_32x32x16_bf16 v[160:175], v[68:71], v[80:83], v[160:175]
  ds_read_b64_tr_b16 v[104:105], v18 offset:20480
  ds_read_b64_tr_b16 v[106:107], v18 offset:21504
  v_mfma_f32_32x32x16_bf16 v[176:191], v[68:71], v[84:87], v[176:191]
  ds_read_b64_tr_b16 v[108:109], v19 offset:20480
  ds_read_b64_tr_b16 v[110:111], v19 offset:21504
  v_mfma_f32_32x32x16_bf16 v[192:207], v[72:75], v[80:83], v[192:207]
  v_mfma_f32_32x32x16_bf16 v[208:223], v[72:75], v[84:87], v[208:223]
  v_mfma_f32_32x32x16_bf16 v[224:239], v[76:79], v[80:83], v[224:239]
  v_mfma_f32_32x32x16_bf16 v[240:255], v[76:79], v[84:87], v[240:255]
  s_waitcnt lgkmcnt(0)
  s_waitcnt vmcnt(8)
  s_barrier
  v_mfma_f32_32x32x16_bf16 v[128:143], v[88:91], v[104:107], v[128:143]
  ds_read_b128 v[64:67], v10 offset:0
  ds_read_b128 v[68:71], v10 offset:4096
  v_mfma_f32_32x32x16_bf16 v[144:159], v[88:91], v[108:111], v[144:159]
  ds_read_b128 v[72:75], v10 offset:8192
  ds_read_b128 v[76:79], v10 offset:12288
  v_mfma_f32_32x32x16_bf16 v[160:175], v[92:95], v[104:107], v[160:175]
  ds_read_b64_tr_b16 v[80:81], v18 offset:32768
  ds_read_b64_tr_b16 v[82:83], v18 offset:33792
  v_mfma_f32_32x32x16_bf16 v[176:191], v[92:95], v[108:111], v[176:191]
  ds_read_b64_tr_b16 v[84:85], v19 offset:32768
  ds_read_b64_tr_b16 v[86:87], v19 offset:33792
  v_mfma_f32_32x32x16_bf16 v[192:207], v[96:99], v[104:107], v[192:207]
  s_add_u32 m0, s26, 114688
  s_add_u32 s23, s25, 2359296
  buffer_load_dwordx4 v5, s[12:15], s23 offen lds
  buffer_load_dwordx4 v6, s[12:15], s23 offen offset:1024 lds
  v_mfma_f32_32x32x16_bf16 v[208:223], v[96:99], v[108:111], v[208:223]
  v_mfma_f32_32x32x16_bf16 v[224:239], v[100:103], v[104:107], v[224:239]
  s_add_u32 m0, s26, 65536
  s_add_u32 s22, s24, 640
  buffer_load_dwordx4 v3, s[8:11], s22 offen lds
  buffer_load_dwordx4 v4, s[8:11], s22 offen offset:1024 lds
  v_mfma_f32_32x32x16_bf16 v[240:255], v[100:103], v[108:111], v[240:255]
  s_waitcnt lgkmcnt(0)
  v_mfma_f32_32x32x16_bf16 v[128:143], v[64:67], v[80:83], v[128:143]
  ds_read_b128 v[88:91], v11 offset:0
  ds_read_b128 v[92:95], v11 offset:4096
  v_mfma_f32_32x32x16_bf16 v[144:159], v[64:67], v[84:87], v[144:159]
  ds_read_b128 v[96:99], v11 offset:8192
  ds_read_b128 v[100:103], v11 offset:12288
  v_mfma_f32_32x32x16_bf16 v[160:175], v[68:71], v[80:83], v[160:175]
  ds_read_b64_tr_b16 v[104:105], v18 offset:36864
  ds_read_b64_tr_b16 v[106:107], v18 offset:37888
  v_mfma_f32_32x32x16_bf16 v[176:191], v[68:71], v[84:87], v[176:191]
  ds_read_b64_tr_b16 v[108:109], v19 offset:36864
  ds_read_b64_tr_b16 v[110:111], v19 offset:37888
  v_mfma_f32_32x32x16_bf16 v[192:207], v[72:75], v[80:83], v[192:207]
  s_add_u32 m0, s26, 81920
  s_add_u32 s22, s24, 131712
  buffer_load_dwordx4 v3, s[8:11], s22 offen lds
  buffer_load_dwordx4 v4, s[8:11], s22 offen offset:1024 lds
  v_mfma_f32_32x32x16_bf16 v[208:223], v[72:75], v[84:87], v[208:223]
  v_mfma_f32_32x32x16_bf16 v[224:239], v[76:79], v[80:83], v[224:239]
  v_mfma_f32_32x32x16_bf16 v[240:255], v[76:79], v[84:87], v[240:255]
  s_waitcnt lgkmcnt(0)
  s_waitcnt vmcnt(12)
  s_barrier
  v_mfma_f32_32x32x16_bf16 v[128:143], v[88:91], v[104:107], v[128:143]
  ds_read_b128 v[64:67], v12 offset:0
  ds_read_b128 v[68:71], v12 offset:4096
  v_mfma_f32_32x32x16_bf16 v[144:159], v[88:91], v[108:111], v[144:159]
  ds_read_b128 v[72:75], v12 offset:8192
  ds_read_b128 v[76:79], v12 offset:12288
  v_mfma_f32_32x32x16_bf16 v[160:175], v[92:95], v[104:107], v[160:175]
  ds_read_b64_tr_b16 v[80:81], v18 offset:49152
  ds_read_b64_tr_b16 v[82:83], v18 offset:50176
  v_mfma_f32_32x32x16_bf16 v[176:191], v[92:95], v[108:111], v[176:191]
  ds_read_b64_tr_b16 v[84:85], v19 offset:49152
  ds_read_b64_tr_b16 v[86:87], v19 offset:50176
  v_mfma_f32_32x32x16_bf16 v[192:207], v[96:99], v[104:107], v[192:207]
  s_add_u32 m0, s26, 131072
  s_add_u32 s23, s25, 2621440
  buffer_load_dwordx4 v5, s[12:15], s23 offen lds
  buffer_load_dwordx4 v6, s[12:15], s23 offen offset:1024 lds
  v_mfma_f32_32x32x16_bf16 v[208:223], v[96:99], v[108:111], v[208:223]
  v_mfma_f32_32x32x16_bf16 v[224:239], v[100:103], v[104:107], v[224:239]
  v_mfma_f32_32x32x16_bf16 v[240:255], v[100:103], v[108:111], v[240:255]
  s_waitcnt lgkmcnt(0)
  v_mfma_f32_32x32x16_bf16 v[128:143], v[64:67], v[80:83], v[128:143]
  ds_read_b128 v[88:91], v13 offset:0
  ds_read_b128 v[92:95], v13 offset:4096
  v_mfma_f32_32x32x16_bf16 v[144:159], v[64:67], v[84:87], v[144:159]
  ds_read_b128 v[96:99], v13 offset:8192
  ds_read_b128 v[100:103], v13 offset:12288
  v_mfma_f32_32x32x16_bf16 v[160:175], v[68:71], v[80:83], v[160:175]
  ds_read_b64_tr_b16 v[104:105], v18 offset:53248
  ds_read_b64_tr_b16 v[106:107], v18 offset:54272
  v_mfma_f32_32x32x16_bf16 v[176:191], v[68:71], v[84:87], v[176:191]
  ds_read_b64_tr_b16 v[108:109], v19 offset:53248
  ds_read_b64_tr_b16 v[110:111], v19 offset:54272
  v_mfma_f32_32x32x16_bf16 v[192:207], v[72:75], v[80:83], v[192:207]
  v_mfma_f32_32x32x16_bf16 v[208:223], v[72:75], v[84:87], v[208:223]
  v_mfma_f32_32x32x16_bf16 v[224:239], v[76:79], v[80:83], v[224:239]
  v_mfma_f32_32x32x16_bf16 v[240:255], v[76:79], v[84:87], v[240:255]
  s_waitcnt lgkmcnt(0)
  s_waitcnt vmcnt(8)
  s_barrier
  v_mfma_f32_32x32x16_bf16 v[128:143], v[88:91], v[104:107], v[128:143]
  ds_read_b128 v[64:67], v10 offset:32768
  ds_read_b128 v[68:71], v10 offset:36864
  v_mfma_f32_32x32x16_bf16 v[144:159], v[88:91], v[108:111], v[144:159]
  ds_read_b128 v[72:75], v10 offset:40960
  ds_read_b128 v[76:79], v10 offset:45056
  v_mfma_f32_32x32x16_bf16 v[160:175], v[92:95], v[104:107], v[160:175]
  ds_read_b64_tr_b16 v[80:81], v18 offset:0
  ds_read_b64_tr_b16 v[82:83], v18 offset:1024
  v_mfma_f32_32x32x16_bf16 v[176:191], v[92:95], v[108:111], v[176:191]
  ds_read_b64_tr_b16 v[84:85], v19 offset:0
  ds_read_b64_tr_b16 v[86:87], v19 offset:1024
  v_mfma_f32_32x32x16_bf16 v[192:207], v[96:99], v[104:107], v[192:207]
  s_add_u32 m0, s26, 147456
  s_add_u32 s23, s25, 2883584
  buffer_load_dwordx4 v5, s[12:15], s23 offen lds
  buffer_load_dwordx4 v6, s[12:15], s23 offen offset:1024 lds
  v_mfma_f32_32x32x16_bf16 v[208:223], v[96:99], v[108:111], v[208:223]
  v_mfma_f32_32x32x16_bf16 v[224:239], v[100:103], v[104:107], v[224:239]
  s_add_u32 m0, s26, 0
  s_add_u32 s22, s24, 768
  buffer_load_dwordx4 v3, s[8:11], s22 offen lds
  buffer_load_dwordx4 v4, s[8:11], s22 offen offset:1024 lds
  v_mfma_f32_32x32x16_bf16 v[240:255], v[100:103], v[108:111], v[240:255]
  s_waitcnt lgkmcnt(0)
  v_mfma_f32_32x32x16_bf16 v[128:143], v[64:67], v[80:83], v[128:143]
  ds_read_b128 v[88:91], v11 offset:32768
  ds_read_b128 v[92:95], v11 offset:36864
  v_mfma_f32_32x32x16_bf16 v[144:159], v[64:67], v[84:87], v[144:159]
  ds_read_b128 v[96:99], v11 offset:40960
  ds_read_b128 v[100:103], v11 offset:45056
  v_mfma_f32_32x32x16_bf16 v[160:175], v[68:71], v[80:83], v[160:175]
  ds_read_b64_tr_b16 v[104:105], v18 offset:4096
  ds_read_b64_tr_b16 v[106:107], v18 offset:5120
  v_mfma_f32_32x32x16_bf16 v[176:191], v[68:71], v[84:87], v[176:191]
  ds_read_b64_tr_b16 v[108:109], v19 offset:4096
  ds_read_b64_tr_b16 v[110:111], v19 offset:5120
  v_mfma_f32_32x32x16_bf16 v[192:207], v[72:75], v[80:83], v[192:207]
  s_add_u32 m0, s26, 16384
  s_add_u32 s22, s24, 131840
  buffer_load_dwordx4 v3, s[8:11], s22 offen lds
  buffer_load_dwordx4 v4, s[8:11], s22 offen offset:1024 lds
  v_mfma_f32_32x32x16_bf16 v[208:223], v[72:75], v[84:87], v[208:223]
  v_mfma_f32_32x32x16_bf16 v[224:239], v[76:79], v[80:83], v[224:239]
  v_mfma_f32_32x32x16_bf16 v[240:255], v[76:79], v[84:87], v[240:255]
  s_waitcnt lgkmcnt(0)
  s_waitcnt vmcnt(12)
  s_barrier
  s_mov_b32 s68, s50
  s_mov_b32 s69, s51
  s_mov_b32 s70, 0x80000
  s_mov_b32 s71, 0x00020000
  v_add_u32 v61, s28, v2
  v_subrev_u32 v61, 1, v61
  v_max_i32 v61, 0, v61
  v_min_i32 v61, 31, v61
  s_lshr_b32 s22, s40, 1
  v_writelane_b32 v61, s22, 3
  v_lshlrev_b32 v61, 2, v61
  buffer_load_dword v60, v61, s[80:83], 0 offen sc1
  v_mfma_f32_32x32x16_bf16 v[128:143], v[88:91], v[104:107], v[128:143]
  ds_read_b128 v[64:67], v12 offset:32768
  ds_read_b128 v[68:71], v12 offset:36864
  v_mfma_f32_32x32x16_bf16 v[144:159], v[88:91], v[108:111], v[144:159]
  ds_read_b128 v[72:75], v12 offset:40960
  ds_read_b128 v[76:79], v12 offset:45056
  v_mfma_f32_32x32x16_bf16 v[160:175], v[92:95], v[104:107], v[160:175]
  ds_read_b64_tr_b16 v[80:81], v18 offset:16384
  ds_read_b64_tr_b16 v[82:83], v18 offset:17408
  v_mfma_f32_32x32x16_bf16 v[176:191], v[92:95], v[108:111], v[176:191]
  ds_read_b64_tr_b16 v[84:85], v19 offset:16384
  ds_read_b64_tr_b16 v[86:87], v19 offset:17408
  v_mfma_f32_32x32x16_bf16 v[192:207], v[96:99], v[104:107], v[192:207]
  s_add_u32 m0, s26, 98304
  s_add_u32 s23, s25, 3145728
  buffer_load_dwordx4 v5, s[12:15], s23 offen lds
  buffer_load_dwordx4 v6, s[12:15], s23 offen offset:1024 lds
  v_mfma_f32_32x32x16_bf16 v[208:223], v[96:99], v[108:111], v[208:223]
  v_mfma_f32_32x32x16_bf16 v[224:239], v[100:103], v[104:107], v[224:239]
  v_mfma_f32_32x32x16_bf16 v[240:255], v[100:103], v[108:111], v[240:255]
  s_waitcnt lgkmcnt(0)
  v_mfma_f32_32x32x16_bf16 v[128:143], v[64:67], v[80:83], v[128:143]
  ds_read_b128 v[88:91], v13 offset:32768
  ds_read_b128 v[92:95], v13 offset:36864
  v_mfma_f32_32x32x16_bf16 v[144:159], v[64:67], v[84:87], v[144:159]
  ds_read_b128 v[96:99], v13 offset:40960
  ds_read_b128 v[100:103], v13 offset:45056
  v_mfma_f32_32x32x16_bf16 v[160:175], v[68:71], v[80:83], v[160:175]
  ds_read_b64_tr_b16 v[104:105], v18 offset:20480
  ds_read_b64_tr_b16 v[106:107], v18 offset:21504
  v_mfma_f32_32x32x16_bf16 v[176:191], v[68:71], v[84:87], v[176:191]
  ds_read_b64_tr_b16 v[108:109], v19 offset:20480
  ds_read_b64_tr_b16 v[110:111], v19 offset:21504
  v_mfma_f32_32x32x16_bf16 v[192:207], v[72:75], v[80:83], v[192:207]
  v_mfma_f32_32x32x16_bf16 v[208:223], v[72:75], v[84:87], v[208:223]
  v_mfma_f32_32x32x16_bf16 v[224:239], v[76:79], v[80:83], v[224:239]
  v_mfma_f32_32x32x16_bf16 v[240:255], v[76:79], v[84:87], v[240:255]
  s_waitcnt lgkmcnt(0)
  s_waitcnt vmcnt(9)
  s_barrier
  v_mfma_f32_32x32x16_bf16 v[128:143], v[88:91], v[104:107], v[128:143]
  ds_read_b128 v[64:67], v14 offset:0
  ds_read_b128 v[68:71], v14 offset:4096
  v_mfma_f32_32x32x16_bf16 v[144:159], v[88:91], v[108:111], v[144:159]
  ds_read_b128 v[72:75], v14 offset:8192
  ds_read_b128 v[76:79], v14 offset:12288
  v_mfma_f32_32x32x16_bf16 v[160:175], v[92:95], v[104:107], v[160:175]
  ds_read_b64_tr_b16 v[80:81], v18 offset:32768
  ds_read_b64_tr_b16 v[82:83], v18 offset:33792
  v_mfma_f32_32x32x16_bf16 v[176:191], v[92:95], v[108:111], v[176:191]
  ds_read_b64_tr_b16 v[84:85], v19 offset:32768
  ds_read_b64_tr_b16 v[86:87], v19 offset:33792
  v_mfma_f32_32x32x16_bf16 v[192:207], v[96:99], v[104:107], v[192:207]
  s_add_u32 m0, s26, 114688
  s_add_u32 s23, s25, 3407872
  buffer_load_dwordx4 v5, s[12:15], s23 offen lds
  buffer_load_dwordx4 v6, s[12:15], s23 offen offset:1024 lds
  v_mfma_f32_32x32x16_bf16 v[208:223], v[96:99], v[108:111], v[208:223]
  v_mfma_f32_32x32x16_bf16 v[224:239], v[100:103], v[104:107], v[224:239]
  s_add_u32 m0, s26, 32768
  s_add_u32 s22, s24, 896
  buffer_load_dwordx4 v3, s[8:11], s22 offen lds
  buffer_load_dwordx4 v4, s[8:11], s22 offen offset:1024 lds
  v_mfma_f32_32x32x16_bf16 v[240:255], v[100:103], v[108:111], v[240:255]
  s_waitcnt lgkmcnt(0)
  v_mfma_f32_32x32x16_bf16 v[128:143], v[64:67], v[80:83], v[128:143]
  ds_read_b128 v[88:91], v15 offset:0
  ds_read_b128 v[92:95], v15 offset:4096
  v_mfma_f32_32x32x16_bf16 v[144:159], v[64:67], v[84:87], v[144:159]
  ds_read_b128 v[96:99], v15 offset:8192
  ds_read_b128 v[100:103], v15 offset:12288
  v_mfma_f32_32x32x16_bf16 v[160:175], v[68:71], v[80:83], v[160:175]
  ds_read_b64_tr_b16 v[104:105], v18 offset:36864
  ds_read_b64_tr_b16 v[106:107], v18 offset:37888
  v_mfma_f32_32x32x16_bf16 v[176:191], v[68:71], v[84:87], v[176:191]
  ds_read_b64_tr_b16 v[108:109], v19 offset:36864
  ds_read_b64_tr_b16 v[110:111], v19 offset:37888
  v_mfma_f32_32x32x16_bf16 v[192:207], v[72:75], v[80:83], v[192:207]
  s_add_u32 m0, s26, 49152
  s_add_u32 s22, s24, 131968
  buffer_load_dwordx4 v3, s[8:11], s22 offen lds
  buffer_load_dwordx4 v4, s[8:11], s22 offen offset:1024 lds
  v_mfma_f32_32x32x16_bf16 v[208:223], v[72:75], v[84:87], v[208:223]
  v_mfma_f32_32x32x16_bf16 v[224:239], v[76:79], v[80:83], v[224:239]
  v_mfma_f32_32x32x16_bf16 v[240:255], v[76:79], v[84:87], v[240:255]
  s_waitcnt lgkmcnt(0)
  s_waitcnt vmcnt(13)
  s_barrier
  v_mfma_f32_32x32x16_bf16 v[128:143], v[88:91], v[104:107], v[128:143]
  ds_read_b128 v[64:67], v16 offset:0
  ds_read_b128 v[68:71], v16 offset:4096
  v_mfma_f32_32x32x16_bf16 v[144:159], v[88:91], v[108:111], v[144:159]
  ds_read_b128 v[72:75], v16 offset:8192
  ds_read_b128 v[76:79], v16 offset:12288
  v_mfma_f32_32x32x16_bf16 v[160:175], v[92:95], v[104:107], v[160:175]
  ds_read_b64_tr_b16 v[80:81], v18 offset:49152
  ds_read_b64_tr_b16 v[82:83], v18 offset:50176
  v_mfma_f32_32x32x16_bf16 v[176:191], v[92:95], v[108:111], v[176:191]
  ds_read_b64_tr_b16 v[84:85], v19 offset:49152
  ds_read_b64_tr_b16 v[86:87], v19 offset:50176
  v_mfma_f32_32x32x16_bf16 v[192:207], v[96:99], v[104:107], v[192:207]
  s_add_u32 m0, s26, 131072
  s_add_u32 s23, s25, 3670016
  buffer_load_dwordx4 v5, s[12:15], s23 offen lds
  buffer_load_dwordx4 v6, s[12:15], s23 offen offset:1024 lds
  v_mfma_f32_32x32x16_bf16 v[208:223], v[96:99], v[108:111], v[208:223]
  v_mfma_f32_32x32x16_bf16 v[224:239], v[100:103], v[104:107], v[224:239]
  v_mfma_f32_32x32x16_bf16 v[240:255], v[100:103], v[108:111], v[240:255]
  s_waitcnt lgkmcnt(0)
  v_mfma_f32_32x32x16_bf16 v[128:143], v[64:67], v[80:83], v[128:143]
  ds_read_b128 v[88:91], v17 offset:0
  ds_read_b128 v[92:95], v17 offset:4096
  v_mfma_f32_32x32x16_bf16 v[144:159], v[64:67], v[84:87], v[144:159]
  ds_read_b128 v[96:99], v17 offset:8192
  ds_read_b128 v[100:103], v17 offset:12288
  v_mfma_f32_32x32x16_bf16 v[160:175], v[68:71], v[80:83], v[160:175]
  ds_read_b64_tr_b16 v[104:105], v18 offset:53248
  ds_read_b64_tr_b16 v[106:107], v18 offset:54272
  v_mfma_f32_32x32x16_bf16 v[176:191], v[68:71], v[84:87], v[176:191]
  ds_read_b64_tr_b16 v[108:109], v19 offset:53248
  ds_read_b64_tr_b16 v[110:111], v19 offset:54272
  v_mfma_f32_32x32x16_bf16 v[192:207], v[72:75], v[80:83], v[192:207]
  v_mfma_f32_32x32x16_bf16 v[208:223], v[72:75], v[84:87], v[208:223]
  v_mfma_f32_32x32x16_bf16 v[224:239], v[76:79], v[80:83], v[224:239]
  v_mfma_f32_32x32x16_bf16 v[240:255], v[76:79], v[84:87], v[240:255]
  s_waitcnt lgkmcnt(0)
  s_waitcnt vmcnt(8)
  s_barrier
  s_mov_b32 s35, 65536
main_kernel_spin_6:
  v_and_b32 v60, 15, v60
  v_cmp_gt_u32 vcc, 8, v60
  s_nop 1
  s_and_b32 s22, vcc_lo, 15
  s_cbranch_scc0 main_kernel_ok_5
  s_sub_u32 s35, s35, 1
  s_cbranch_scc1 main_kernel_ok_5
  s_sleep 8
  buffer_load_dword v60, v61, s[80:83], 0 offen offset:0 sc1
  s_waitcnt vmcnt(0)
  s_branch main_kernel_spin_6
main_kernel_ok_5:
  v_mfma_f32_32x32x16_bf16 v[128:143], v[88:91], v[104:107], v[128:143]
  ds_read_b128 v[64:67], v10 offset:0
  ds_read_b128 v[68:71], v10 offset:4096
  v_mfma_f32_32x32x16_bf16 v[144:159], v[88:91], v[108:111], v[144:159]
  ds_read_b128 v[72:75], v10 offset:8192
  ds_read_b128 v[76:79], v10 offset:12288
  v_mfma_f32_32x32x16_bf16 v[160:175], v[92:95], v[104:107], v[160:175]
  ds_read_b64_tr_b16 v[80:81], v18 offset:0
  ds_read_b64_tr_b16 v[82:83], v18 offset:1024
  v_mfma_f32_32x32x16_bf16 v[176:191], v[92:95], v[108:111], v[176:191]
  ds_read_b64_tr_b16 v[84:85], v19 offset:0
  ds_read_b64_tr_b16 v[86:87], v19 offset:1024
  v_mfma_f32_32x32x16_bf16 v[192:207], v[96:99], v[104:107], v[192:207]
  s_mul_i32 s22, s20, 32768
  s_add_u32 s22, s22, 0
  s_lshl_b32 s23, s29, 7
  s_add_u32 s22, s22, s23
  s_mul_i32 s23, s20, 4096
  s_add_u32 m0, s23, 65536
  s_nop 0
  buffer_load_dwordx4 v23, s[68:71], s22 offen lds
  s_add_u32 m0, m0, 1024
  s_add_u32 s22, s22, 8192
  s_nop 0
  buffer_load_dwordx4 v23, s[68:71], s22 offen lds
  s_add_u32 m0, m0, 1024
  s_add_u32 s22, s22, 8192
  s_nop 0
  buffer_load_dwordx4 v23, s[68:71], s22 offen lds
  s_add_u32 m0, m0, 1024
  s_add_u32 s22, s22, 8192
  s_nop 0
  buffer_load_dwordx4 v23, s[68:71], s22 offen lds
  v_mfma_f32_32x32x16_bf16 v[208:223], v[96:99], v[108:111], v[208:223]
  v_mfma_f32_32x32x16_bf16 v[224:239], v[100:103], v[104:107], v[224:239]
  s_add_u32 m0, s26, 147456
  s_add_u32 s23, s25, 3932160
  buffer_load_dwordx4 v5, s[12:15], s23 offen lds
  buffer_load_dwordx4 v6, s[12:15], s23 offen offset:1024 lds
  v_mfma_f32_32x32x16_bf16 v[240:255], v[100:103], v[108:111], v[240:255]
  s_waitcnt lgkmcnt(0)
  v_mfma_f32_32x32x16_bf16 v[128:143], v[64:67], v[80:83], v[128:143]
  ds_read_b128 v[88:91], v11 offset:0
  ds_read_b128 v[92:95], v11 offset:4096
  v_mfma_f32_32x32x16_bf16 v[144:159], v[64:67], v[84:87], v[144:159]
  ds_read_b128 v[96:99], v11 offset:8192
  ds_read_b128 v[100:103], v11 offset:12288
  v_mfma_f32_32x32x16_bf16 v[160:175], v[68:71], v[80:83], v[160:175]
  ds_read_b64_tr_b16 v[104:105], v18 offset:4096
  ds_read_b64_tr_b16 v[106:107], v18 offset:5120
  v_mfma_f32_32x32x16_bf16 v[176:191], v[68:71], v[84:87], v[176:191]
  ds_read_b64_tr_b16 v[108:109], v19 offset:4096
  ds_read_b64_tr_b16 v[110:111], v19 offset:5120
  v_mfma_f32_32x32x16_bf16 v[192:207], v[72:75], v[80:83], v[192:207]
  v_mfma_f32_32x32x16_bf16 v[208:223], v[72:75], v[84:87], v[208:223]
  v_mfma_f32_32x32x16_bf16 v[224:239], v[76:79], v[80:83], v[224:239]
  v_mfma_f32_32x32x16_bf16 v[240:255], v[76:79], v[84:87], v[240:255]
  s_waitcnt lgkmcnt(0)
  s_waitcnt vmcnt(12)
  s_barrier
  v_mfma_f32_32x32x16_bf16 v[128:143], v[88:91], v[104:107], v[128:143]
  ds_read_b128 v[64:67], v12 offset:0
  ds_read_b128 v[68:71], v12 offset:4096
  v_mfma_f32_32x32x16_bf16 v[144:159], v[88:91], v[108:111], v[144:159]
  ds_read_b128 v[72:75], v12 offset:8192
  ds_read_b128 v[76:79], v12 offset:12288
  v_mfma_f32_32x32x16_bf16 v[160:175], v[92:95], v[104:107], v[160:175]
  ds_read_b64_tr_b16 v[80:81], v18 offset:16384
  ds_read_b64_tr_b16 v[82:83], v18 offset:17408
  v_mfma_f32_32x32x16_bf16 v[176:191], v[92:95], v[108:111], v[176:191]
  ds_read_b64_tr_b16 v[84:85], v19 offset:16384
  ds_read_b64_tr_b16 v[86:87], v19 offset:17408
  v_mfma_f32_32x32x16_bf16 v[192:207], v[96:99], v[104:107], v[192:207]
  s_mul_i32 s22, s20, 16384
  s_add_u32 s22, s22, 262144
  s_lshl_b32 s23, s29, 7
  s_add_u32 s22, s22, s23
  s_mul_i32 s23, s20, 2048
  s_add_u32 m0, s23, 98304
  s_nop 0
  buffer_load_dwordx4 v23, s[68:71], s22 offen lds
  s_add_u32 m0, m0, 1024
  s_add_u32 s22, s22, 8192
  s_nop 0
  buffer_load_dwordx4 v23, s[68:71], s22 offen lds
  v_mfma_f32_32x32x16_bf16 v[208:223], v[96:99], v[108:111], v[208:223]
  v_mfma_f32_32x32x16_bf16 v[224:239], v[100:103], v[104:107], v[224:239]
  s_lshr_b32 s23, s31, 1
  s_add_u32 s23, s23, 1
  s_sub_u32 s34, 0, s23
  s_bitcmp1_b32 s31, 0
  s_cselect_b32 s23, s23, s34
  s_lshl_b32 s22, s32, 5
  s_add_u32 s22, s22, s23
  v_add_u32 v61, s22, v21
  v_ashrrev_i32 v62, 5, v61
  v_lshlrev_b32 v62, 15, v62
  v_and_b32 v61, 31, v61
  v_lshl_add_u32 v62, v61, 4, v62
  v_lshl_add_u32 v62, v22, 9, v62
  s_lshl_b32 s22, s31, 13
  s_add_u32 s23, s22, 4096
  buffer_load_dwordx4 v[24:27], v62, s[72:75], s22 offen sc1
  buffer_load_dwordx4 v[28:31], v62, s[72:75], s22 offen offset:1024 sc1
  buffer_load_dwordx4 v[32:35], v62, s[72:75], s22 offen offset:2048 sc1
  buffer_load_dwordx4 v[36:39], v62, s[72:75], s22 offen offset:3072 sc1
  buffer_load_dwordx4 v[40:43], v62, s[72:75], s23 offen sc1
  buffer_load_dwordx4 v[44:47], v62, s[72:75], s23 offen offset:1024 sc1
  buffer_load_dwordx4 v[48:51], v62, s[72:75], s23 offen offset:2048 sc1
  buffer_load_dwordx4 v[52:55], v62, s[72:75], s23 offen offset:3072 sc1
  v_mfma_f32_32x32x16_bf16 v[240:255], v[100:103], v[108:111], v[240:255]
  s_waitcnt lgkmcnt(0)
  v_mfma_f32_32x32x16_bf16 v[128:143], v[64:67], v[80:83], v[128:143]
  ds_read_b128 v[88:91], v13 offset:0
  ds_read_b128 v[92:95], v13 offset:4096
  v_mfma_f32_32x32x16_bf16 v[144:159], v[64:67], v[84:87], v[144:159]
  ds_read_b128 v[96:99], v13 offset:8192
  ds_read_b128 v[100:103], v13 offset:12288
  v_mfma_f32_32x32x16_bf16 v[160:175], v[68:71], v[80:83], v[160:175]
  ds_read_b64_tr_b16 v[104:105], v18 offset:20480
  ds_read_b64_tr_b16 v[106:107], v18 offset:21504
  v_mfma_f32_32x32x16_bf16 v[176:191], v[68:71], v[84:87], v[176:191]
  ds_read_b64_tr_b16 v[108:109], v19 offset:20480
  ds_read_b64_tr_b16 v[110:111], v19 offset:21504
  v_mfma_f32_32x32x16_bf16 v[192:207], v[72:75], v[80:83], v[192:207]
  v_mfma_f32_32x32x16_bf16 v[208:223], v[72:75], v[84:87], v[208:223]
  v_mfma_f32_32x32x16_bf16 v[224:239], v[76:79], v[80:83], v[224:239]
  v_mfma_f32_32x32x16_bf16 v[240:255], v[76:79], v[84:87], v[240:255]
  s_waitcnt lgkmcnt(0)
  s_waitcnt vmcnt(16)
  s_barrier
  v_mfma_f32_32x32x16_bf16 v[128:143], v[88:91], v[104:107], v[128:143]
  ds_read_b128 v[64:67], v10 offset:32768
  ds_read_b128 v[68:71], v10 offset:36864
  v_mfma_f32_32x32x16_bf16 v[144:159], v[88:91], v[108:111], v[144:159]
  ds_read_b128 v[72:75], v10 offset:40960
  ds_read_b128 v[76:79], v10 offset:45056
  v_mfma_f32_32x32x16_bf16 v[160:175], v[92:95], v[104:107], v[160:175]
  ds_read_b64_tr_b16 v[80:81], v18 offset:32768
  ds_read_b64_tr_b16 v[82:83], v18 offset:33792
  v_mfma_f32_32x32x16_bf16 v[176:191], v[92:95], v[108:111], v[176:191]
  ds_read_b64_tr_b16 v[84:85], v19 offset:32768
  ds_read_b64_tr_b16 v[86:87], v19 offset:33792
  v_mfma_f32_32x32x16_bf16 v[192:207], v[96:99], v[104:107], v[192:207]
  s_mul_i32 s22, s20, 16384
  s_add_u32 s22, s22, 393216
  s_lshl_b32 s23, s29, 7
  s_add_u32 s22, s22, s23
  s_mul_i32 s23, s20, 2048
  s_add_u32 m0, s23, 114688
  s_nop 0
  buffer_load_dwordx4 v23, s[68:71], s22 offen lds
  s_add_u32 m0, m0, 1024
  s_add_u32 s22, s22, 8192
  s_nop 0
  buffer_load_dwordx4 v23, s[68:71], s22 offen lds
  v_mfma_f32_32x32x16_bf16 v[208:223], v[96:99], v[108:111], v[208:223]
  v_mfma_f32_32x32x16_bf16 v[224:239], v[100:103], v[104:107], v[224:239]
  s_add_u32 m0, s42, 0
  s_add_u32 s22, s45, 0
  buffer_load_dwordx4 v5, s[64:67], s22 offen lds
  s_add_u32 m0, s42, 8192
  s_add_u32 s22, s45, 262144
  buffer_load_dwordx4 v5, s[64:67], s22 offen lds
  s_add_u32 m0, s42, 16384
  s_add_u32 s22, s45, 524288
  buffer_load_dwordx4 v5, s[64:67], s22 offen lds
  s_add_u32 m0, s42, 24576
  s_add_u32 s22, s45, 786432
  buffer_load_dwordx4 v5, s[64:67], s22 offen lds
  v_mfma_f32_32x32x16_bf16 v[240:255], v[100:103], v[108:111], v[240:255]
  s_waitcnt lgkmcnt(0)
  v_mfma_f32_32x32x16_bf16 v[128:143], v[64:67], v[80:83], v[128:143]
  ds_read_b128 v[88:91], v11 offset:32768
  ds_read_b128 v[92:95], v11 offset:36864
  v_mfma_f32_32x32x16_bf16 v[144:159], v[64:67], v[84:87], v[144:159]
  ds_read_b128 v[96:99], v11 offset:40960
  ds_read_b128 v[100:103], v11 offset:45056
  v_mfma_f32_32x32x16_bf16 v[160:175], v[68:71], v[80:83], v[160:175]
  ds_read_b64_tr_b16 v[104:105], v18 offset:36864
  ds_read_b64_tr_b16 v[106:107], v18 offset:37888
  v_mfma_f32_32x32x16_bf16 v[176:191], v[68:71], v[84:87], v[176:191]
  ds_read_b64_tr_b16 v[108:109], v19 offset:36864
  ds_read_b64_tr_b16 v[110:111], v19 offset:37888
  v_mfma_f32_32x32x16_bf16 v[192:207], v[72:75], v[80:83], v[192:207]
  v_mfma_f32_32x32x16_bf16 v[208:223], v[72:75], v[84:87], v[208:223]
  v_mfma_f32_32x32x16_bf16 v[224:239], v[76:79], v[80:83], v[224:239]
  v_mfma_f32_32x32x16_bf16 v[240:255], v[76:79], v[84:87], v[240:255]
  s_waitcnt lgkmcnt(0)
  s_waitcnt vmcnt(16)
  s_barrier
  v_mfma_f32_32x32x16_bf16 v[128:143], v[88:91], v[104:107], v[128:143]
  ds_read_b128 v[64:67], v12 offset:32768
  ds_read_b128 v[68:71], v12 offset:36864
  v_mfma_f32_32x32x16_bf16 v[144:159], v[88:91], v[108:111], v[144:159]
  ds_read_b128 v[72:75], v12 offset:40960
  ds_read_b128 v[76:79], v12 offset:45056
  v_mfma_f32_32x32x16_bf16 v[160:175], v[92:95], v[104:107], v[160:175]
  ds_read_b64_tr_b16 v[80:81], v18 offset:49152
  ds_read_b64_tr_b16 v[82:83], v18 offset:50176
  v_mfma_f32_32x32x16_bf16 v[176:191], v[92:95], v[108:111], v[176:191]
  ds_read_b64_tr_b16 v[84:85], v19 offset:49152
  ds_read_b64_tr_b16 v[86:87], v19 offset:50176
  v_mfma_f32_32x32x16_bf16 v[192:207], v[96:99], v[104:107], v[192:207]
  v_mfma_f32_32x32x16_bf16 v[208:223], v[96:99], v[108:111], v[208:223]
  v_mfma_f32_32x32x16_bf16 v[224:239], v[100:103], v[104:107], v[224:239]
  v_mfma_f32_32x32x16_bf16 v[240:255], v[100:103], v[108:111], v[240:255]
  s_waitcnt lgkmcnt(0)
  v_mfma_f32_32x32x16_bf16 v[128:143], v[64:67], v[80:83], v[128:143]
  ds_read_b128 v[88:91], v13 offset:32768
  ds_read_b128 v[92:95], v13 offset:36864
  v_mfma_f32_32x32x16_bf16 v[144:159], v[64:67], v[84:87], v[144:159]
  ds_read_b128 v[96:99], v13 offset:40960
  ds_read_b128 v[100:103], v13 offset:45056
  v_mfma_f32_32x32x16_bf16 v[160:175], v[68:71], v[80:83], v[160:175]
  ds_read_b64_tr_b16 v[104:105], v18 offset:53248
  ds_read_b64_tr_b16 v[106:107], v18 offset:54272
  v_mfma_f32_32x32x16_bf16 v[176:191], v[68:71], v[84:87], v[176:191]
  ds_read_b64_tr_b16 v[108:109], v19 offset:53248
  ds_read_b64_tr_b16 v[110:111], v19 offset:54272
  v_mfma_f32_32x32x16_bf16 v[192:207], v[72:75], v[80:83], v[192:207]
  v_mfma_f32_32x32x16_bf16 v[208:223], v[72:75], v[84:87], v[208:223]
  v_mfma_f32_32x32x16_bf16 v[224:239], v[76:79], v[80:83], v[224:239]
  v_mfma_f32_32x32x16_bf16 v[240:255], v[76:79], v[84:87], v[240:255]
  s_waitcnt lgkmcnt(0)
  v_mfma_f32_32x32x16_bf16 v[128:143], v[88:91], v[104:107], v[128:143]
  v_mfma_f32_32x32x16_bf16 v[144:159], v[88:91], v[108:111], v[144:159]
  v_mfma_f32_32x32x16_bf16 v[160:175], v[92:95], v[104:107], v[160:175]
  v_mfma_f32_32x32x16_bf16 v[176:191], v[92:95], v[108:111], v[176:191]
  v_mfma_f32_32x32x16_bf16 v[192:207], v[96:99], v[104:107], v[192:207]
  v_mfma_f32_32x32x16_bf16 v[208:223], v[96:99], v[108:111], v[208:223]
  v_mfma_f32_32x32x16_bf16 v[224:239], v[100:103], v[104:107], v[224:239]
  v_mfma_f32_32x32x16_bf16 v[240:255], v[100:103], v[108:111], v[240:255]
main_kernel_J:
  s_lshl_b32 s22, s31, 14
  s_add_u32 s22, s22, 0x10000
  v_bfe_u32 v62, v2, 2, 2
  v_lshl_add_u32 v62, v22, 2, v62
  v_lshlrev_b32 v62, 7, v62
  v_bfe_u32 v63, v2, 4, 1
  v_lshl_add_u32 v62, v63, 5, v62
  v_and_b32 v63, 3, v2
  v_lshl_add_u32 v62, v63, 3, v62
  v_add_u32 v62, s22, v62
  v_bfe_u32 v63, v2, 3, 1
  v_lshl_add_u32 v60, v63, 6, v62
  v_xor_b32 v63, 1, v63
  v_lshl_add_u32 v61, v63, 6, v62
  s_mul_i32 s22, s30, 98304
  s_add_u32 s22, s22, 32768
  s_lshl_b32 s23, s31, 11
  s_add_u32 s23, s23, s22
  v_add_u32 v62, s23, v20
  s_lshl_b32 s23, s31, 13
  s_add_u32 s34, s23, s22
  v_add_u32 v63, s34, v20
  s_mov_b32 s4, s34
  s_waitcnt vmcnt(4)
  s_barrier
  ds_read_b64_tr_b16 v[64:65], v60 offset:0
  ds_read_b64_tr_b16 v[66:67], v60 offset:1024
  ds_read_b64_tr_b16 v[68:69], v61 offset:0
  ds_read_b64_tr_b16 v[70:71], v61 offset:1024
  ds_read_b64_tr_b16 v[72:73], v60 offset:2048
  ds_read_b64_tr_b16 v[74:75], v60 offset:3072
  ds_read_b64_tr_b16 v[76:77], v61 offset:2048
  ds_read_b64_tr_b16 v[78:79], v61 offset:3072
  ds_read_b64_tr_b16 v[80:81], v60 offset:4096
  ds_read_b64_tr_b16 v[82:83], v60 offset:5120
  ds_read_b64_tr_b16 v[84:85], v61 offset:4096
  ds_read_b64_tr_b16 v[86:87], v61 offset:5120
  s_waitcnt lgkmcnt(8)
  v_mfma_f32_32x32x16_bf16 v[96:111], v[64:67], v[24:27], 0
  v_cvt_pk_bf16_f32 v128, v128, v129
  v_cvt_pk_bf16_f32 v129, v130, v131
  v_cvt_pk_bf16_f32 v130, v132, v133
  v_cvt_pk_bf16_f32 v131, v134, v135
  v_mfma_f32_32x32x16_bf16 v[112:127], v[68:71], v[24:27], 0
  v_cvt_pk_bf16_f32 v132, v136, v137
  v_cvt_pk_bf16_f32 v133, v138, v139
  v_cvt_pk_bf16_f32 v134, v140, v141
  v_cvt_pk_bf16_f32 v135, v142, v143
  ds_read_b64_tr_b16 v[88:89], v60 offset:6144
  ds_read_b64_tr_b16 v[90:91], v60 offset:7168
  ds_read_b64_tr_b16 v[92:93], v61 offset:6144
  ds_read_b64_tr_b16 v[94:95], v61 offset:7168
  s_waitcnt lgkmcnt(8)
  v_mfma_f32_32x32x16_bf16 v[96:111], v[72:75], v[28:31], v[96:111]
  v_cvt_pk_bf16_f32 v136, v144, v145
  v_cvt_pk_bf16_f32 v137, v146, v147
  v_cvt_pk_bf16_f32 v138, v148, v149
  v_cvt_pk_bf16_f32 v139, v150, v151
  v_mfma_f32_32x32x16_bf16 v[112:127], v[76:79], v[28:31], v[112:127]
  v_cvt_pk_bf16_f32 v140, v152, v153
  v_cvt_pk_bf16_f32 v141, v154, v155
  v_cvt_pk_bf16_f32 v142, v156, v157
  v_cvt_pk_bf16_f32 v143, v158, v159
  ds_read_b64_tr_b16 v[64:65], v60 offset:8192
  ds_read_b64_tr_b16 v[66:67], v60 offset:9216
  ds_read_b64_tr_b16 v[68:69], v61 offset:8192
  ds_read_b64_tr_b16 v[70:71], v61 offset:9216
  s_waitcnt lgkmcnt(8)
  v_mfma_f32_32x32x16_bf16 v[96:111], v[80:83], v[32:35], v[96:111]
  v_cvt_pk_bf16_f32 v144, v160, v161
  v_cvt_pk_bf16_f32 v145, v162, v163
  v_cvt_pk_bf16_f32 v146, v164, v165
  v_cvt_pk_bf16_f32 v147, v166, v167
  v_mfma_f32_32x32x16_bf16 v[112:127], v[84:87], v[32:35], v[112:127]
  v_cvt_pk_bf16_f32 v148, v168, v169
  v_cvt_pk_bf16_f32 v149, v170, v171
  v_cvt_pk_bf16_f32 v150, v172, v173
  v_cvt_pk_bf16_f32 v151, v174, v175
  ds_read_b64_tr_b16 v[72:73], v60 offset:10240
  ds_read_b64_tr_b16 v[74:75], v60 offset:11264
  ds_read_b64_tr_b16 v[76:77], v61 offset:10240
  ds_read_b64_tr_b16 v[78:79], v61 offset:11264
  s_waitcnt lgkmcnt(8)
  v_mfma_f32_32x32x16_bf16 v[96:111], v[88:91], v[36:39], v[96:111]
  v_cvt_pk_bf16_f32 v152, v176, v177
  v_cvt_pk_bf16_f32 v153, v178, v179
  v_cvt_pk_bf16_f32 v154, v180, v181
  v_cvt_pk_bf16_f32 v155, v182, v183
  v_mfma_f32_32x32x16_bf16 v[112:127], v[92:95], v[36:39], v[112:127]
  v_cvt_pk_bf16_f32 v156, v184, v185
  v_cvt_pk_bf16_f32 v157, v186, v187
  v_cvt_pk_bf16_f32 v158, v188, v189
  v_cvt_pk_bf16_f32 v159, v190, v191
  ds_read_b64_tr_b16 v[80:81], v60 offset:12288
  ds_read_b64_tr_b16 v[82:83], v60 offset:13312
  ds_read_b64_tr_b16 v[84:85], v61 offset:12288
  ds_read_b64_tr_b16 v[86:87], v61 offset:13312
  s_waitcnt lgkmcnt(8)
  v_mfma_f32_32x32x16_bf16 v[96:111], v[64:67], v[40:43], v[96:111]
  v_cvt_pk_bf16_f32 v160, v192, v193
  v_cvt_pk_bf16_f32 v161, v194, v195
  v_cvt_pk_bf16_f32 v162, v196, v197
  v_cvt_pk_bf16_f32 v163, v198, v199
  v_mfma_f32_32x32x16_bf16 v[112:127], v[68:71], v[40:43], v[112:127]
  v_cvt_pk_bf16_f32 v164, v200, v201
  v_cvt_pk_bf16_f32 v165, v202, v203
  v_cvt_pk_bf16_f32 v166, v204, v205
  v_cvt_pk_bf16_f32 v167, v206, v207
  ds_read_b64_tr_b16 v[88:89], v60 offset:14336
  ds_read_b64_tr_b16 v[90:91], v60 offset:15360
  ds_read_b64_tr_b16 v[92:93], v61 offset:14336
  ds_read_b64_tr_b16 v[94:95], v61 offset:15360
  s_waitcnt lgkmcnt(8)
  v_mfma_f32_32x32x16_bf16 v[96:111], v[72:75], v[44:47], v[96:111]
  v_cvt_pk_bf16_f32 v168, v208, v209
  v_cvt_pk_bf16_f32 v169, v210, v211
  v_cvt_pk_bf16_f32 v170, v212, v213
  v_cvt_pk_bf16_f32 v171, v214, v215
  v_mfma_f32_32x32x16_bf16 v[112:127], v[76:79], v[44:47], v[112:127]
  v_cvt_pk_bf16_f32 v172, v216, v217
  v_cvt_pk_bf16_f32 v173, v218, v219
  v_cvt_pk_bf16_f32 v174, v220, v221
  v_cvt_pk_bf16_f32 v175, v222, v223
  s_waitcnt lgkmcnt(4)
  v_mfma_f32_32x32x16_bf16 v[96:111], v[80:83], v[48:51], v[96:111]
  v_cvt_pk_bf16_f32 v176, v224, v225
  v_cvt_pk_bf16_f32 v177, v226, v227
  v_cvt_pk_bf16_f32 v178, v228, v229
  v_cvt_pk_bf16_f32 v179, v230, v231
  v_mfma_f32_32x32x16_bf16 v[112:127], v[84:87], v[48:51], v[112:127]
  v_cvt_pk_bf16_f32 v180, v232, v233
  v_cvt_pk_bf16_f32 v181, v234, v235
  v_cvt_pk_bf16_f32 v182, v236, v237
  v_cvt_pk_bf16_f32 v183, v238, v239
  s_waitcnt lgkmcnt(0)
  v_mfma_f32_32x32x16_bf16 v[96:111], v[88:91], v[52:55], v[96:111]
  v_cvt_pk_bf16_f32 v184, v240, v241
  v_cvt_pk_bf16_f32 v185, v242, v243
  v_cvt_pk_bf16_f32 v186, v244, v245
  v_cvt_pk_bf16_f32 v187, v246, v247
  v_mfma_f32_32x32x16_bf16 v[112:127], v[92:95], v[52:55], v[112:127]
  v_cvt_pk_bf16_f32 v188, v248, v249
  v_cvt_pk_bf16_f32 v189, v250, v251
  v_cvt_pk_bf16_f32 v190, v252, v253
  v_cvt_pk_bf16_f32 v191, v254, v255
  s_add_u32 s23, s41, 0
  buffer_load_dwordx4 v[192:195], v20, s[76:79], s23 offen sc1
  s_add_u32 s23, s41, 0
  buffer_load_dwordx4 v[196:199], v20, s[76:79], s23 offen offset:1024 sc1
  s_add_u32 s23, s41, 0
  buffer_load_dwordx4 v[200:203], v20, s[76:79], s23 offen offset:2048 sc1
  s_add_u32 s23, s41, 0
  buffer_load_dwordx4 v[204:207], v20, s[76:79], s23 offen offset:3072 sc1
  s_add_u32 s22, s27, 0
  buffer_store_dwordx4 v[128:131], v20, s[16:19], s22 offen sc1
  s_nop 7
  ds_write_b128 v62, v[96:99] offset:0
  ds_write_b128 v62, v[100:103] offset:1024
  ds_write_b128 v62, v[104:107] offset:8192
  ds_write_b128 v62, v[108:111] offset:9216
  ds_write_b128 v62, v[112:115] offset:16384
  ds_write_b128 v62, v[116:119] offset:17408
  ds_write_b128 v62, v[120:123] offset:24576
  ds_write_b128 v62, v[124:127] offset:25600
  s_waitcnt lgkmcnt(0)
  s_barrier
  ds_read_b128 v[64:67], v63 offset:0
  ds_read_b128 v[68:71], v63 offset:1024
  ds_read_b128 v[72:75], v63 offset:2048
  ds_read_b128 v[76:79], v63 offset:3072
  ds_read_b128 v[80:83], v63 offset:4096
  ds_read_b128 v[84:87], v63 offset:5120
  ds_read_b128 v[88:91], v63 offset:6144
  ds_read_b128 v[92:95], v63 offset:7168
  s_add_u32 s23, s41, 4096
  buffer_load_dwordx4 v[208:211], v20, s[76:79], s23 offen sc1
  s_add_u32 s23, s41, 4096
  buffer_load_dwordx4 v[212:215], v20, s[76:79], s23 offen offset:1024 sc1
  s_add_u32 s23, s41, 4096
  buffer_load_dwordx4 v[216:219], v20, s[76:79], s23 offen offset:2048 sc1
  s_add_u32 s23, s41, 4096
  buffer_load_dwordx4 v[220:223], v20, s[76:79], s23 offen offset:3072 sc1
  s_add_u32 m0, s42, 65536
  s_add_u32 s22, s45, 1048576
  buffer_load_dwordx4 v5, s[64:67], s22 offen lds
  s_add_u32 m0, s42, 73728
  s_add_u32 s22, s45, 1310720
  buffer_load_dwordx4 v5, s[64:67], s22 offen lds
  s_add_u32 m0, s42, 81920
  s_add_u32 s22, s45, 1572864
  buffer_load_dwordx4 v5, s[64:67], s22 offen lds
  s_add_u32 m0, s42, 90112
  s_add_u32 s22, s45, 1835008
  buffer_load_dwordx4 v5, s[64:67], s22 offen lds
  s_add_u32 s22, s27, 1024
  buffer_store_dwordx4 v[132:135], v20, s[16:19], s22 offen sc1
  v_lshlrev_b32 v24, 16, v56
  v_and_b32 v25, 0xffff0000, v56
  v_lshlrev_b32 v26, 16, v57
  v_and_b32 v27, 0xffff0000, v57
  v_lshlrev_b32 v28, 16, v58
  v_and_b32 v29, 0xffff0000, v58
  v_lshlrev_b32 v30, 16, v59
  v_and_b32 v31, 0xffff0000, v59
  s_waitcnt lgkmcnt(0)
  v_add_f32 v64, v64, v72
  v_add_f32 v65, v65, v73
  v_add_f32 v66, v66, v74
  v_add_f32 v67, v67, v75
  v_add_f32 v68, v68, v76
  v_add_f32 v69, v69, v77
  v_add_f32 v70, v70, v78
  v_add_f32 v71, v71, v79
  v_add_f32 v64, v64, v80
  v_add_f32 v65, v65, v81
  v_add_f32 v66, v66, v82
  v_add_f32 v67, v67, v83
  v_add_f32 v68, v68, v84
  v_add_f32 v69, v69, v85
  v_add_f32 v70, v70, v86
  v_add_f32 v71, v71, v87
  v_add_f32 v64, v64, v88
  v_add_f32 v65, v65, v89
  v_add_f32 v66, v66, v90
  v_add_f32 v67, v67, v91
  v_add_f32 v68, v68, v92
  v_add_f32 v69, v69, v93
  v_add_f32 v70, v70, v94
  v_add_f32 v71, v71, v95
  v_add_f32 v64, v64, v24
  v_add_f32 v65, v65, v25
  v_add_f32 v66, v66, v26
  v_add_f32 v67, v67, v27
  v_add_f32 v68, v68, v28
  v_add_f32 v69, v69, v29
  v_add_f32 v70, v70, v30
  v_add_f32 v71, v71, v31
  v_cvt_pk_bf16_f32 v32, v64, v65
  v_cvt_pk_bf16_f32 v33, v66, v67
  v_cvt_pk_bf16_f32 v34, v68, v69
  v_cvt_pk_bf16_f32 v35, v70, v71
  buffer_store_dwordx4 v[32:35], v20, s[84:87], s33 offen sc1
  s_add_u32 s23, s41, 8192
  buffer_load_dwordx4 v[224:227], v20, s[76:79], s23 offen sc1
  s_add_u32 s23, s41, 8192
  buffer_load_dwordx4 v[228:231], v20, s[76:79], s23 offen offset:1024 sc1
  s_add_u32 s23, s41, 8192
  buffer_load_dwordx4 v[232:235], v20, s[76:79], s23 offen offset:2048 sc1
  s_add_u32 s23, s41, 8192
  buffer_load_dwordx4 v[236:239], v20, s[76:79], s23 offen offset:3072 sc1
  s_add_u32 m0, s42, 98304
  s_add_u32 s22, s45, 2097152
  buffer_load_dwordx4 v5, s[64:67], s22 offen lds
  s_add_u32 m0, s42, 106496
  s_add_u32 s22, s45, 2359296
  buffer_load_dwordx4 v5, s[64:67], s22 offen lds
  s_add_u32 m0, s42, 114688
  s_add_u32 s22, s45, 2621440
  buffer_load_dwordx4 v5, s[64:67], s22 offen lds
  s_add_u32 m0, s42, 122880
  s_add_u32 s22, s45, 2883584
  buffer_load_dwordx4 v5, s[64:67], s22 offen lds
  s_add_u32 s22, s27, 2048
  buffer_store_dwordx4 v[136:139], v20, s[16:19], s22 offen sc1
  v_add_f32 v36, v64, v65
  v_mul_f32 v37, v64, v64
  v_fmac_f32 v37, v65, v65
  v_add_f32 v36, v36, v66
  v_fmac_f32 v37, v66, v66
  v_add_f32 v36, v36, v67
  v_fmac_f32 v37, v67, v67
  v_add_f32 v36, v36, v68
  v_fmac_f32 v37, v68, v68
  v_add_f32 v36, v36, v69
  v_fmac_f32 v37, v69, v69
  v_add_f32 v36, v36, v70
  v_fmac_f32 v37, v70, v70
  v_add_f32 v36, v36, v71
  v_fmac_f32 v37, v71, v71
  v_mov_b32 v38, v36
  s_nop 1
  v_permlane32_swap_b32 v36, v38
  s_nop 1
  v_add_f32 v36, v36, v38
  v_mov_b32 v38, v37
  s_nop 1
  v_permlane32_swap_b32 v37, v38
  s_nop 1
  v_add_f32 v37, v37, v38
  v_lshlrev_b32 v39, 3, v21
  v_add_u32 v39, s4, v39
  s_mov_b32 exec_hi, 0
  ds_write_b64 v39, v[36:37]
  s_mov_b32 exec_hi, -1
  s_waitcnt lgkmcnt(0)
  s_barrier
  s_cmp_lg_u32 s20, 0
  s_cbranch_scc1 main_kernel_st0
  v_mul_u32_u24 v40, 98304, v22
  v_lshl_add_u32 v40, v21, 3, v40
  v_add_u32 v40, 32768, v40
  v_lshlrev_b32 v39, 3, v2
  ds_read_b64 v[42:43], v40 offset:0
  ds_read_b64 v[44:45], v40 offset:8192
  ds_read_b64 v[46:47], v40 offset:16384
  ds_read_b64 v[48:49], v40 offset:24576
  s_waitcnt lgkmcnt(0)
  v_add_f32 v42, v42, v44
  v_add_f32 v43, v43, v45
  v_add_f32 v42, v42, v46
  v_add_f32 v43, v43, v47
  v_add_f32 v42, v42, v48
  v_add_f32 v43, v43, v49
  s_lshl_b32 s22, s29, 14
  s_lshl_b32 s23, s28, 9
  s_add_u32 s22, s22, s23
  buffer_store_dwordx2 v[42:43], v39, s[88:91], s22 offen sc1
main_kernel_st0:
  s_add_u32 s23, s41, 12288
  buffer_load_dwordx4 v[240:243], v20, s[76:79], s23 offen sc1
  s_add_u32 s23, s41, 12288
  buffer_load_dwordx4 v[244:247], v20, s[76:79], s23 offen offset:1024 sc1
  s_add_u32 s23, s41, 12288
  buffer_load_dwordx4 v[248:251], v20, s[76:79], s23 offen offset:2048 sc1
  s_add_u32 s23, s41, 12288
  buffer_load_dwordx4 v[252:255], v20, s[76:79], s23 offen offset:3072 sc1
  s_add_u32 s22, s27, 3072
  buffer_store_dwordx4 v[140:143], v20, s[16:19], s22 offen sc1
  s_and_b32 s37, s2, 7
  s_lshl_b32 s37, s37, 1
  s_bfe_u32 s22, s2, 0x10003
  s_add_u32 s37, s37, s22
  s_lshr_b32 s36, s2, 4
  s_and_b32 s38, s20, 3
  s_lshr_b32 s39, s20, 2
  s_lshl_b32 s32, s37, 2
  s_add_u32 s32, s32, s38
  s_mov_b32 s68, s52
  s_mov_b32 s69, s53
  s_mov_b32 s70, 0x158000
  s_mov_b32 s71, 0x00020000
  v_bfe_u32 v60, v2, 2, 2
  v_lshl_add_u32 v61, v22, 2, v60
  v_lshlrev_b32 v61, 8, v61
  v_bfe_u32 v62, v2, 4, 1
  v_lshl_add_u32 v61, v62, 5, v61
  v_and_b32 v62, 3, v2
  v_lshl_add_u32 v61, v62, 3, v61
  v_xor_b32 v62, 0, v60
  v_lshl_add_u32 v56, v62, 6, v61
  v_xor_b32 v62, 1, v60
  v_lshl_add_u32 v57, v62, 6, v61
  v_xor_b32 v62, 2, v60
  v_lshl_add_u32 v58, v62, 6, v61
  v_xor_b32 v62, 3, v60
  v_lshl_add_u32 v59, v62, 6, v61
  v_mov_b32 v62, 43691
  v_mov_b32 v63, 2752
  v_add_u32 v60, 0, v2
  v_mul_lo_u32 v61, v60, v62
  v_lshrrev_b32 v61, 19, v61
  v_mul_u32_u24 v10, 12, v61
  v_sub_u32 v60, v60, v10
  v_mul_lo_u32 v61, v61, v63
  v_lshl_add_u32 v7, v60, 4, v61
  v_add_u32 v60, 64, v2
  v_mul_lo_u32 v61, v60, v62
  v_lshrrev_b32 v61, 19, v61
  v_mul_u32_u24 v10, 12, v61
  v_sub_u32 v60, v60, v10
  v_mul_lo_u32 v61, v61, v63
  v_lshl_add_u32 v8, v60, 4, v61
  v_add_u32 v60, 128, v2
  v_mul_lo_u32 v61, v60, v62
  v_lshrrev_b32 v61, 19, v61
  v_mul_u32_u24 v10, 12, v61
  v_sub_u32 v60, v60, v10
  v_mul_lo_u32 v61, v61, v63
  v_lshl_add_u32 v9, v60, 4, v61
  s_lshl_b32 s4, s32, 15
  s_lshl_b32 s23, s39, 14
  s_add_u32 s4, s4, s23
  s_lshl_b32 s5, s32, 8
  v_lshlrev_b32 v62, 16, v22
  v_lshl_add_u32 v62, v21, 3, v62
  s_lshl_b32 s22, s37, 1
  v_add_u32 v61, s22, v2
  v_min_u32 v61, 31, v61
  v_lshlrev_b32 v61, 2, v61
  s_waitcnt vmcnt(28)
  s_barrier
  ds_read_b64_tr_b16 v[24:25], v56 offset:0
  ds_read_b64_tr_b16 v[26:27], v56 offset:2048
  ds_read_b64_tr_b16 v[28:29], v57 offset:0
  ds_read_b64_tr_b16 v[30:31], v57 offset:2048
  ds_read_b64_tr_b16 v[32:33], v58 offset:0
  ds_read_b64_tr_b16 v[34:35], v58 offset:2048
  ds_read_b64_tr_b16 v[36:37], v59 offset:0
  ds_read_b64_tr_b16 v[38:39], v59 offset:2048
  ds_read_b64_tr_b16 v[40:41], v56 offset:4096
  ds_read_b64_tr_b16 v[42:43], v56 offset:6144
  ds_read_b64_tr_b16 v[44:45], v57 offset:4096
  ds_read_b64_tr_b16 v[46:47], v57 offset:6144
  s_add_u32 m0, s42, 131072
  s_add_u32 s22, s45, 3145728
  buffer_load_dwordx4 v5, s[64:67], s22 offen lds
  s_add_u32 m0, s42, 139264
  s_add_u32 s22, s45, 3407872
  buffer_load_dwordx4 v5, s[64:67], s22 offen lds
  s_add_u32 m0, s42, 147456
  s_add_u32 s22, s45, 3670016
  buffer_load_dwordx4 v5, s[64:67], s22 offen lds
  s_add_u32 m0, s42, 155648
  s_add_u32 s22, s45, 3932160
  buffer_load_dwordx4 v5, s[64:67], s22 offen lds
  s_waitcnt vmcnt(32) lgkmcnt(10)
  v_mfma_f32_32x32x16_bf16 v[64:79], v[24:27], v[192:195], 0
  ds_read_b64_tr_b16 v[48:49], v58 offset:4096
  ds_read_b64_tr_b16 v[50:51], v58 offset:6144
  s_waitcnt lgkmcnt(10)
  v_mfma_f32_32x32x16_bf16 v[80:95], v[28:31], v[192:195], 0
  ds_read_b64_tr_b16 v[52:53], v59 offset:4096
  ds_read_b64_tr_b16 v[54:55], v59 offset:6144
  s_waitcnt lgkmcnt(10)
  v_mfma_f32_32x32x16_bf16 v[96:111], v[32:35], v[192:195], 0
  ds_read_b64_tr_b16 v[24:25], v56 offset:8192
  ds_read_b64_tr_b16 v[26:27], v56 offset:10240
  s_waitcnt lgkmcnt(10)
  v_mfma_f32_32x32x16_bf16 v[112:127], v[36:39], v[192:195], 0
  ds_read_b64_tr_b16 v[28:29], v57 offset:8192
  ds_read_b64_tr_b16 v[30:31], v57 offset:10240
  s_add_u32 s23, s41, 16384
  buffer_load_dwordx4 v[192:195], v20, s[76:79], s23 offen sc1
  s_waitcnt vmcnt(32) lgkmcnt(10)
  v_mfma_f32_32x32x16_bf16 v[64:79], v[40:43], v[196:199], v[64:79]
  ds_read_b64_tr_b16 v[32:33], v58 offset:8192
  ds_read_b64_tr_b16 v[34:35], v58 offset:10240
  s_waitcnt lgkmcnt(10)
  v_mfma_f32_32x32x16_bf16 v[80:95], v[44:47], v[196:199], v[80:95]
  ds_read_b64_tr_b16 v[36:37], v59 offset:8192
  ds_read_b64_tr_b16 v[38:39], v59 offset:10240
  s_waitcnt lgkmcnt(10)
  v_mfma_f32_32x32x16_bf16 v[96:111], v[48:51], v[196:199], v[96:111]
  ds_read_b64_tr_b16 v[40:41], v56 offset:12288
  ds_read_b64_tr_b16 v[42:43], v56 offset:14336
  s_waitcnt lgkmcnt(10)
  v_mfma_f32_32x32x16_bf16 v[112:127], v[52:55], v[196:199], v[112:127]
  ds_read_b64_tr_b16 v[44:45], v57 offset:12288
  ds_read_b64_tr_b16 v[46:47], v57 offset:14336
  s_add_u32 s23, s41, 16384
  buffer_load_dwordx4 v[196:199], v20, s[76:79], s23 offen offset:1024 sc1
  s_waitcnt vmcnt(32) lgkmcnt(10)
  v_mfma_f32_32x32x16_bf16 v[64:79], v[24:27], v[200:203], v[64:79]
  ds_read_b64_tr_b16 v[48:49], v58 offset:12288
  ds_read_b64_tr_b16 v[50:51], v58 offset:14336
  s_waitcnt lgkmcnt(10)
  v_mfma_f32_32x32x16_bf16 v[80:95], v[28:31], v[200:203], v[80:95]
  ds_read_b64_tr_b16 v[52:53], v59 offset:12288
  ds_read_b64_tr_b16 v[54:55], v59 offset:14336
  s_waitcnt lgkmcnt(10)
  v_mfma_f32_32x32x16_bf16 v[96:111], v[32:35], v[200:203], v[96:111]
  ds_read_b64_tr_b16 v[24:25], v56 offset:16384
  ds_read_b64_tr_b16 v[26:27], v56 offset:18432
  s_waitcnt lgkmcnt(10)
  v_mfma_f32_32x32x16_bf16 v[112:127], v[36:39], v[200:203], v[112:127]
  ds_read_b64_tr_b16 v[28:29], v57 offset:16384
  ds_read_b64_tr_b16 v[30:31], v57 offset:18432
  s_add_u32 s22, s27, 16384
  buffer_store_dwordx4 v[144:147], v20, s[16:19], s22 offen sc1
  s_add_u32 s23, s41, 16384
  buffer_load_dwordx4 v[200:203], v20, s[76:79], s23 offen offset:2048 sc1
  s_waitcnt vmcnt(33) lgkmcnt(10)
  v_mfma_f32_32x32x16_bf16 v[64:79], v[40:43], v[204:207], v[64:79]
  ds_read_b64_tr_b16 v[32:33], v58 offset:16384
  ds_read_b64_tr_b16 v[34:35], v58 offset:18432
  s_waitcnt lgkmcnt(10)
  v_mfma_f32_32x32x16_bf16 v[80:95], v[44:47], v[204:207], v[80:95]
  ds_read_b64_tr_b16 v[36:37], v59 offset:16384
  ds_read_b64_tr_b16 v[38:39], v59 offset:18432
  s_waitcnt lgkmcnt(10)
  v_mfma_f32_32x32x16_bf16 v[96:111], v[48:51], v[204:207], v[96:111]
  ds_read_b64_tr_b16 v[40:41], v56 offset:20480
  ds_read_b64_tr_b16 v[42:43], v56 offset:22528
  s_waitcnt lgkmcnt(10)
  v_mfma_f32_32x32x16_bf16 v[112:127], v[52:55], v[204:207], v[112:127]
  ds_read_b64_tr_b16 v[44:45], v57 offset:20480
  ds_read_b64_tr_b16 v[46:47], v57 offset:22528
  s_add_u32 s23, s41, 16384
  buffer_load_dwordx4 v[204:207], v20, s[76:79], s23 offen offset:3072 sc1
  s_waitcnt vmcnt(32) lgkmcnt(10)
  v_mfma_f32_32x32x16_bf16 v[64:79], v[24:27], v[208:211], v[64:79]
  ds_read_b64_tr_b16 v[48:49], v58 offset:20480
  ds_read_b64_tr_b16 v[50:51], v58 offset:22528
  s_waitcnt lgkmcnt(10)
  v_mfma_f32_32x32x16_bf16 v[80:95], v[28:31], v[208:211], v[80:95]
  ds_read_b64_tr_b16 v[52:53], v59 offset:20480
  ds_read_b64_tr_b16 v[54:55], v59 offset:22528
  s_waitcnt lgkmcnt(10)
  v_mfma_f32_32x32x16_bf16 v[96:111], v[32:35], v[208:211], v[96:111]
  ds_read_b64_tr_b16 v[24:25], v56 offset:24576
  ds_read_b64_tr_b16 v[26:27], v56 offset:26624
  s_waitcnt lgkmcnt(10)
  v_mfma_f32_32x32x16_bf16 v[112:127], v[36:39], v[208:211], v[112:127]
  ds_read_b64_tr_b16 v[28:29], v57 offset:24576
  ds_read_b64_tr_b16 v[30:31], v57 offset:26624
  s_add_u32 s22, s27, 17408
  buffer_store_dwordx4 v[148:151], v20, s[16:19], s22 offen sc1
  s_add_u32 s23, s41, 20480
  buffer_load_dwordx4 v[208:211], v20, s[76:79], s23 offen sc1
  s_waitcnt vmcnt(33) lgkmcnt(10)
  v_mfma_f32_32x32x16_bf16 v[64:79], v[40:43], v[212:215], v[64:79]
  ds_read_b64_tr_b16 v[32:33], v58 offset:24576
  ds_read_b64_tr_b16 v[34:35], v58 offset:26624
  s_waitcnt lgkmcnt(10)
  v_mfma_f32_32x32x16_bf16 v[80:95], v[44:47], v[212:215], v[80:95]
  ds_read_b64_tr_b16 v[36:37], v59 offset:24576
  ds_read_b64_tr_b16 v[38:39], v59 offset:26624
  s_waitcnt lgkmcnt(10)
  v_mfma_f32_32x32x16_bf16 v[96:111], v[48:51], v[212:215], v[96:111]
  ds_read_b64_tr_b16 v[40:41], v56 offset:28672
  ds_read_b64_tr_b16 v[42:43], v56 offset:30720
  s_waitcnt lgkmcnt(10)
  v_mfma_f32_32x32x16_bf16 v[112:127], v[52:55], v[212:215], v[112:127]
  ds_read_b64_tr_b16 v[44:45], v57 offset:28672
  ds_read_b64_tr_b16 v[46:47], v57 offset:30720
  s_add_u32 s23, s41, 20480
  buffer_load_dwordx4 v[212:215], v20, s[76:79], s23 offen offset:1024 sc1
  s_waitcnt vmcnt(33) lgkmcnt(10)
  v_mfma_f32_32x32x16_bf16 v[64:79], v[24:27], v[216:219], v[64:79]
  ds_read_b64_tr_b16 v[48:49], v58 offset:28672
  ds_read_b64_tr_b16 v[50:51], v58 offset:30720
  s_waitcnt lgkmcnt(10)
  v_mfma_f32_32x32x16_bf16 v[80:95], v[28:31], v[216:219], v[80:95]
  ds_read_b64_tr_b16 v[52:53], v59 offset:28672
  ds_read_b64_tr_b16 v[54:55], v59 offset:30720
  s_waitcnt lgkmcnt(10)
  v_mfma_f32_32x32x16_bf16 v[96:111], v[32:35], v[216:219], v[96:111]
  s_waitcnt lgkmcnt(8)
  v_mfma_f32_32x32x16_bf16 v[112:127], v[36:39], v[216:219], v[112:127]
  s_add_u32 s22, s27, 18432
  buffer_store_dwordx4 v[152:155], v20, s[16:19], s22 offen sc1
  s_add_u32 s23, s41, 20480
  buffer_load_dwordx4 v[216:219], v20, s[76:79], s23 offen offset:2048 sc1
  s_waitcnt vmcnt(34) lgkmcnt(6)
  v_mfma_f32_32x32x16_bf16 v[64:79], v[40:43], v[220:223], v[64:79]
  s_waitcnt lgkmcnt(4)
  v_mfma_f32_32x32x16_bf16 v[80:95], v[44:47], v[220:223], v[80:95]
  s_waitcnt lgkmcnt(2)
  v_mfma_f32_32x32x16_bf16 v[96:111], v[48:51], v[220:223], v[96:111]
  s_waitcnt lgkmcnt(0)
  v_mfma_f32_32x32x16_bf16 v[112:127], v[52:55], v[220:223], v[112:127]
  s_add_u32 s23, s41, 20480
  buffer_load_dwordx4 v[220:223], v20, s[76:79], s23 offen offset:3072 sc1
  s_waitcnt vmcnt(11)
  s_barrier
  v_add_u32 v56, 0x10000, v56
  v_add_u32 v57, 0x10000, v57
  v_add_u32 v58, 0x10000, v58
  v_add_u32 v59, 0x10000, v59
  ds_read_b64_tr_b16 v[24:25], v56 offset:0
  ds_read_b64_tr_b16 v[26:27], v56 offset:2048
  ds_read_b64_tr_b16 v[28:29], v57 offset:0
  ds_read_b64_tr_b16 v[30:31], v57 offset:2048
  ds_read_b64_tr_b16 v[32:33], v58 offset:0
  ds_read_b64_tr_b16 v[34:35], v58 offset:2048
  ds_read_b64_tr_b16 v[36:37], v59 offset:0
  ds_read_b64_tr_b16 v[38:39], v59 offset:2048
  ds_read_b64_tr_b16 v[40:41], v56 offset:4096
  ds_read_b64_tr_b16 v[42:43], v56 offset:6144
  ds_read_b64_tr_b16 v[44:45], v57 offset:4096
  ds_read_b64_tr_b16 v[46:47], v57 offset:6144
  s_cmp_lg_u32 s20, 0
  s_cbranch_scc1 main_kernel_sig_7
  s_lshl_b32 s22, s28, 2
  s_add_u32 s22, s22, 128
  v_mov_b32 v10, 0
  v_mov_b32 v11, 1
  s_mov_b64 exec, 1
  buffer_atomic_add v11, v10, s[80:83], s22 offen
  s_mov_b64 exec, -1
main_kernel_sig_7:
  s_mul_i32 s22, s20, 88064
  s_mul_i32 s23, s36, 192
  s_add_u32 s22, s22, s23
  s_mul_i32 s23, s20, 6144
  s_add_u32 m0, s23, 0
  s_nop 0
  buffer_load_dwordx4 v7, s[68:71], s22 offen lds
  s_add_u32 m0, m0, 1024
  s_nop 0
  buffer_load_dwordx4 v8, s[68:71], s22 offen lds
  s_add_u32 m0, m0, 1024
  s_nop 0
  buffer_load_dwordx4 v9, s[68:71], s22 offen lds
  s_add_u32 m0, m0, 1024
  s_add_u32 s22, s22, 44032
  s_nop 0
  buffer_load_dwordx4 v7, s[68:71], s22 offen lds
  s_add_u32 m0, m0, 1024
  s_nop 0
  buffer_load_dwordx4 v8, s[68:71], s22 offen lds
  s_add_u32 m0, m0, 1024
  s_nop 0
  buffer_load_dwordx4 v9, s[68:71], s22 offen lds
  s_waitcnt vmcnt(34) lgkmcnt(10)
  v_mfma_f32_32x32x16_bf16 v[64:79], v[24:27], v[224:227], v[64:79]
  ds_read_b64_tr_b16 v[48:49], v58 offset:4096
  ds_read_b64_tr_b16 v[50:51], v58 offset:6144
  s_waitcnt lgkmcnt(10)
  v_mfma_f32_32x32x16_bf16 v[80:95], v[28:31], v[224:227], v[80:95]
  ds_read_b64_tr_b16 v[52:53], v59 offset:4096
  ds_read_b64_tr_b16 v[54:55], v59 offset:6144
  s_waitcnt lgkmcnt(10)
  v_mfma_f32_32x32x16_bf16 v[96:111], v[32:35], v[224:227], v[96:111]
  ds_read_b64_tr_b16 v[24:25], v56 offset:8192
  ds_read_b64_tr_b16 v[26:27], v56 offset:10240
  s_waitcnt lgkmcnt(10)
  v_mfma_f32_32x32x16_bf16 v[112:127], v[36:39], v[224:227], v[112:127]
  ds_read_b64_tr_b16 v[28:29], v57 offset:8192
  ds_read_b64_tr_b16 v[30:31], v57 offset:10240
  s_add_u32 s22, s27, 19456
  buffer_store_dwordx4 v[156:159], v20, s[16:19], s22 offen sc1
  s_add_u32 s23, s41, 24576
  buffer_load_dwordx4 v[224:227], v20, s[76:79], s23 offen sc1
  s_waitcnt vmcnt(35) lgkmcnt(10)
  v_mfma_f32_32x32x16_bf16 v[64:79], v[40:43], v[228:231], v[64:79]
  ds_read_b64_tr_b16 v[32:33], v58 offset:8192
  ds_read_b64_tr_b16 v[34:35], v58 offset:10240
  s_waitcnt lgkmcnt(10)
  v_mfma_f32_32x32x16_bf16 v[80:95], v[44:47], v[228:231], v[80:95]
  ds_read_b64_tr_b16 v[36:37], v59 offset:8192
  ds_read_b64_tr_b16 v[38:39], v59 offset:10240
  s_waitcnt lgkmcnt(10)
  v_mfma_f32_32x32x16_bf16 v[96:111], v[48:51], v[228:231], v[96:111]
  ds_read_b64_tr_b16 v[40:41], v56 offset:12288
  ds_read_b64_tr_b16 v[42:43], v56 offset:14336
  s_waitcnt lgkmcnt(10)
  v_mfma_f32_32x32x16_bf16 v[112:127], v[52:55], v[228:231], v[112:127]
  ds_read_b64_tr_b16 v[44:45], v57 offset:12288
  ds_read_b64_tr_b16 v[46:47], v57 offset:14336
  s_add_u32 s23, s41, 24576
  buffer_load_dwordx4 v[228:231], v20, s[76:79], s23 offen offset:1024 sc1
  s_waitcnt vmcnt(35) lgkmcnt(10)
  v_mfma_f32_32x32x16_bf16 v[64:79], v[24:27], v[232:235], v[64:79]
  ds_read_b64_tr_b16 v[48:49], v58 offset:12288
  ds_read_b64_tr_b16 v[50:51], v58 offset:14336
  s_waitcnt lgkmcnt(10)
  v_mfma_f32_32x32x16_bf16 v[80:95], v[28:31], v[232:235], v[80:95]
  ds_read_b64_tr_b16 v[52:53], v59 offset:12288
  ds_read_b64_tr_b16 v[54:55], v59 offset:14336
  s_waitcnt lgkmcnt(10)
  v_mfma_f32_32x32x16_bf16 v[96:111], v[32:35], v[232:235], v[96:111]
  ds_read_b64_tr_b16 v[24:25], v56 offset:16384
  ds_read_b64_tr_b16 v[26:27], v56 offset:18432
  s_waitcnt lgkmcnt(10)
  v_mfma_f32_32x32x16_bf16 v[112:127], v[36:39], v[232:235], v[112:127]
  ds_read_b64_tr_b16 v[28:29], v57 offset:16384
  ds_read_b64_tr_b16 v[30:31], v57 offset:18432
  s_add_u32 s23, s41, 24576
  buffer_load_dwordx4 v[232:235], v20, s[76:79], s23 offen offset:2048 sc1
  s_waitcnt vmcnt(35) lgkmcnt(10)
  v_mfma_f32_32x32x16_bf16 v[64:79], v[40:43], v[236:239], v[64:79]
  ds_read_b64_tr_b16 v[32:33], v58 offset:16384
  ds_read_b64_tr_b16 v[34:35], v58 offset:18432
  s_waitcnt lgkmcnt(10)
  v_mfma_f32_32x32x16_bf16 v[80:95], v[44:47], v[236:239], v[80:95]
  ds_read_b64_tr_b16 v[36:37], v59 offset:16384
  ds_read_b64_tr_b16 v[38:39], v59 offset:18432
  s_waitcnt lgkmcnt(10)
  v_mfma_f32_32x32x16_bf16 v[96:111], v[48:51], v[236:239], v[96:111]
  ds_read_b64_tr_b16 v[40:41], v56 offset:20480
  ds_read_b64_tr_b16 v[42:43], v56 offset:22528
  s_waitcnt lgkmcnt(10)
  v_mfma_f32_32x32x16_bf16 v[112:127], v[52:55], v[236:239], v[112:127]
  ds_read_b64_tr_b16 v[44:45], v57 offset:20480
  ds_read_b64_tr_b16 v[46:47], v57 offset:22528
  s_add_u32 s22, s27, 32768
  buffer_store_dwordx4 v[160:163], v20, s[16:19], s22 offen sc1
  s_add_u32 s23, s41, 24576
  buffer_load_dwordx4 v[236:239], v20, s[76:79], s23 offen offset:3072 sc1
  s_waitcnt vmcnt(31) lgkmcnt(10)
  v_mfma_f32_32x32x16_bf16 v[64:79], v[24:27], v[240:243], v[64:79]
  ds_read_b64_tr_b16 v[48:49], v58 offset:20480
  ds_read_b64_tr_b16 v[50:51], v58 offset:22528
  s_waitcnt lgkmcnt(10)
  v_mfma_f32_32x32x16_bf16 v[80:95], v[28:31], v[240:243], v[80:95]
  ds_read_b64_tr_b16 v[52:53], v59 offset:20480
  ds_read_b64_tr_b16 v[54:55], v59 offset:22528
  s_waitcnt lgkmcnt(10)
  v_mfma_f32_32x32x16_bf16 v[96:111], v[32:35], v[240:243], v[96:111]
  ds_read_b64_tr_b16 v[24:25], v56 offset:24576
  ds_read_b64_tr_b16 v[26:27], v56 offset:26624
  s_waitcnt lgkmcnt(10)
  v_mfma_f32_32x32x16_bf16 v[112:127], v[36:39], v[240:243], v[112:127]
  ds_read_b64_tr_b16 v[28:29], v57 offset:24576
  ds_read_b64_tr_b16 v[30:31], v57 offset:26624
  s_add_u32 s23, s41, 28672
  buffer_load_dwordx4 v[240:243], v20, s[76:79], s23 offen sc1
  s_waitcnt vmcnt(31) lgkmcnt(10)
  v_mfma_f32_32x32x16_bf16 v[64:79], v[40:43], v[244:247], v[64:79]
  ds_read_b64_tr_b16 v[32:33], v58 offset:24576
  ds_read_b64_tr_b16 v[34:35], v58 offset:26624
  s_waitcnt lgkmcnt(10)
  v_mfma_f32_32x32x16_bf16 v[80:95], v[44:47], v[244:247], v[80:95]
  ds_read_b64_tr_b16 v[36:37], v59 offset:24576
  ds_read_b64_tr_b16 v[38:39], v59 offset:26624
  s_waitcnt lgkmcnt(10)
  v_mfma_f32_32x32x16_bf16 v[96:111], v[48:51], v[244:247], v[96:111]
  ds_read_b64_tr_b16 v[40:41], v56 offset:28672
  ds_read_b64_tr_b16 v[42:43], v56 offset:30720
  s_waitcnt lgkmcnt(10)
  v_mfma_f32_32x32x16_bf16 v[112:127], v[52:55], v[244:247], v[112:127]
  ds_read_b64_tr_b16 v[44:45], v57 offset:28672
  ds_read_b64_tr_b16 v[46:47], v57 offset:30720
  s_add_u32 s22, s27, 33792
  buffer_store_dwordx4 v[164:167], v20, s[16:19], s22 offen sc1
  s_add_u32 s23, s41, 28672
  buffer_load_dwordx4 v[244:247], v20, s[76:79], s23 offen offset:1024 sc1
  s_waitcnt vmcnt(32) lgkmcnt(10)
  v_mfma_f32_32x32x16_bf16 v[64:79], v[24:27], v[248:251], v[64:79]
  ds_read_b64_tr_b16 v[48:49], v58 offset:28672
  ds_read_b64_tr_b16 v[50:51], v58 offset:30720
  s_waitcnt lgkmcnt(10)
  v_mfma_f32_32x32x16_bf16 v[80:95], v[28:31], v[248:251], v[80:95]
  ds_read_b64_tr_b16 v[52:53], v59 offset:28672
  ds_read_b64_tr_b16 v[54:55], v59 offset:30720
  s_waitcnt lgkmcnt(10)
  v_mfma_f32_32x32x16_bf16 v[96:111], v[32:35], v[248:251], v[96:111]
  s_waitcnt lgkmcnt(8)
  v_mfma_f32_32x32x16_bf16 v[112:127], v[36:39], v[248:251], v[112:127]
  s_add_u32 s23, s41, 28672
  buffer_load_dwordx4 v[248:251], v20, s[76:79], s23 offen offset:2048 sc1
  s_waitcnt vmcnt(32) lgkmcnt(6)
  v_mfma_f32_32x32x16_bf16 v[64:79], v[40:43], v[252:255], v[64:79]
  s_waitcnt lgkmcnt(4)
  v_mfma_f32_32x32x16_bf16 v[80:95], v[44:47], v[252:255], v[80:95]
  s_waitcnt lgkmcnt(2)
  v_mfma_f32_32x32x16_bf16 v[96:111], v[48:51], v[252:255], v[96:111]
  s_waitcnt lgkmcnt(0)
  v_mfma_f32_32x32x16_bf16 v[112:127], v[52:55], v[252:255], v[112:127]
  s_add_u32 s22, s27, 34816
  buffer_store_dwordx4 v[168:171], v20, s[16:19], s22 offen sc1
  s_add_u32 s23, s41, 28672
  buffer_load_dwordx4 v[252:255], v20, s[76:79], s23 offen offset:3072 sc1
  s_waitcnt vmcnt(28)
  s_barrier
  v_add_u32 v56, 0x8000, v56
  v_add_u32 v57, 0x8000, v57
  v_add_u32 v58, 0x8000, v58
  v_add_u32 v59, 0x8000, v59
  ds_read_b64_tr_b16 v[24:25], v56 offset:0
  ds_read_b64_tr_b16 v[26:27], v56 offset:2048
  ds_read_b64_tr_b16 v[28:29], v57 offset:0
  ds_read_b64_tr_b16 v[30:31], v57 offset:2048
  ds_read_b64_tr_b16 v[32:33], v58 offset:0
  ds_read_b64_tr_b16 v[34:35], v58 offset:2048
  ds_read_b64_tr_b16 v[36:37], v59 offset:0
  ds_read_b64_tr_b16 v[38:39], v59 offset:2048
  ds_read_b64_tr_b16 v[40:41], v56 offset:4096
  ds_read_b64_tr_b16 v[42:43], v56 offset:6144
  ds_read_b64_tr_b16 v[44:45], v57 offset:4096
  ds_read_b64_tr_b16 v[46:47], v57 offset:6144
  s_mul_i32 s22, s20, 88064
  s_mul_i32 s23, s36, 192
  s_add_u32 s22, s22, s23
  s_add_u32 s22, s22, 704512
  s_mul_i32 s23, s20, 6144
  s_add_u32 m0, s23, 49152
  s_nop 0
  buffer_load_dwordx4 v7, s[68:71], s22 offen lds
  s_add_u32 m0, m0, 1024
  s_nop 0
  buffer_load_dwordx4 v8, s[68:71], s22 offen lds
  s_add_u32 m0, m0, 1024
  s_nop 0
  buffer_load_dwordx4 v9, s[68:71], s22 offen lds
  s_add_u32 m0, m0, 1024
  s_add_u32 s22, s22, 44032
  s_nop 0
  buffer_load_dwordx4 v7, s[68:71], s22 offen lds
  s_add_u32 m0, m0, 1024
  s_nop 0
  buffer_load_dwordx4 v8, s[68:71], s22 offen lds
  s_add_u32 m0, m0, 1024
  s_nop 0
  buffer_load_dwordx4 v9, s[68:71], s22 offen lds
  buffer_load_dword v60, v61, s[80:83], 0 offen offset:128 sc1
  s_waitcnt vmcnt(35) lgkmcnt(10)
  v_mfma_f32_32x32x16_bf16 v[64:79], v[24:27], v[192:195], v[64:79]
  ds_read_b64_tr_b16 v[48:49], v58 offset:4096
  ds_read_b64_tr_b16 v[50:51], v58 offset:6144
  s_waitcnt lgkmcnt(10)
  v_mfma_f32_32x32x16_bf16 v[80:95], v[28:31], v[192:195], v[80:95]
  ds_read_b64_tr_b16 v[52:53], v59 offset:4096
  ds_read_b64_tr_b16 v[54:55], v59 offset:6144
  s_waitcnt lgkmcnt(10)
  v_mfma_f32_32x32x16_bf16 v[96:111], v[32:35], v[192:195], v[96:111]
  ds_read_b64_tr_b16 v[24:25], v56 offset:8192
  ds_read_b64_tr_b16 v[26:27], v56 offset:10240
  s_waitcnt lgkmcnt(10)
  v_mfma_f32_32x32x16_bf16 v[112:127], v[36:39], v[192:195], v[112:127]
  ds_read_b64_tr_b16 v[28:29], v57 offset:8192
  ds_read_b64_tr_b16 v[30:31], v57 offset:10240
  s_waitcnt vmcnt(34) lgkmcnt(10)
  v_mfma_f32_32x32x16_bf16 v[64:79], v[40:43], v[196:199], v[64:79]
  ds_read_b64_tr_b16 v[32:33], v58 offset:8192
  ds_read_b64_tr_b16 v[34:35], v58 offset:10240
  s_waitcnt lgkmcnt(10)
  v_mfma_f32_32x32x16_bf16 v[80:95], v[44:47], v[196:199], v[80:95]
  ds_read_b64_tr_b16 v[36:37], v59 offset:8192
  ds_read_b64_tr_b16 v[38:39], v59 offset:10240
  s_waitcnt lgkmcnt(10)
  v_mfma_f32_32x32x16_bf16 v[96:111], v[48:51], v[196:199], v[96:111]
  ds_read_b64_tr_b16 v[40:41], v56 offset:12288
  ds_read_b64_tr_b16 v[42:43], v56 offset:14336
  s_waitcnt lgkmcnt(10)
  v_mfma_f32_32x32x16_bf16 v[112:127], v[52:55], v[196:199], v[112:127]
  ds_read_b64_tr_b16 v[44:45], v57 offset:12288
  ds_read_b64_tr_b16 v[46:47], v57 offset:14336
  s_add_u32 s22, s27, 35840
  buffer_store_dwordx4 v[172:175], v20, s[16:19], s22 offen sc1
  s_waitcnt vmcnt(33) lgkmcnt(10)
  v_mfma_f32_32x32x16_bf16 v[64:79], v[24:27], v[200:203], v[64:79]
  ds_read_b64_tr_b16 v[48:49], v58 offset:12288
  ds_read_b64_tr_b16 v[50:51], v58 offset:14336
  s_waitcnt lgkmcnt(10)
  v_mfma_f32_32x32x16_bf16 v[80:95], v[28:31], v[200:203], v[80:95]
  ds_read_b64_tr_b16 v[52:53], v59 offset:12288
  ds_read_b64_tr_b16 v[54:55], v59 offset:14336
  s_waitcnt lgkmcnt(10)
  v_mfma_f32_32x32x16_bf16 v[96:111], v[32:35], v[200:203], v[96:111]
  ds_read_b64_tr_b16 v[24:25], v56 offset:16384
  ds_read_b64_tr_b16 v[26:27], v56 offset:18432
  s_waitcnt lgkmcnt(10)
  v_mfma_f32_32x32x16_bf16 v[112:127], v[36:39], v[200:203], v[112:127]
  ds_read_b64_tr_b16 v[28:29], v57 offset:16384
  ds_read_b64_tr_b16 v[30:31], v57 offset:18432
  s_waitcnt vmcnt(32) lgkmcnt(10)
  v_mfma_f32_32x32x16_bf16 v[64:79], v[40:43], v[204:207], v[64:79]
  ds_read_b64_tr_b16 v[32:33], v58 offset:16384
  ds_read_b64_tr_b16 v[34:35], v58 offset:18432
  s_waitcnt lgkmcnt(10)
  v_mfma_f32_32x32x16_bf16 v[80:95], v[44:47], v[204:207], v[80:95]
  ds_read_b64_tr_b16 v[36:37], v59 offset:16384
  ds_read_b64_tr_b16 v[38:39], v59 offset:18432
  s_waitcnt lgkmcnt(10)
  v_mfma_f32_32x32x16_bf16 v[96:111], v[48:51], v[204:207], v[96:111]
  ds_read_b64_tr_b16 v[40:41], v56 offset:20480
  ds_read_b64_tr_b16 v[42:43], v56 offset:22528
  s_waitcnt lgkmcnt(10)
  v_mfma_f32_32x32x16_bf16 v[112:127], v[52:55], v[204:207], v[112:127]
  ds_read_b64_tr_b16 v[44:45], v57 offset:20480
  ds_read_b64_tr_b16 v[46:47], v57 offset:22528
  s_add_u32 s22, s27, 49152
  buffer_store_dwordx4 v[176:179], v20, s[16:19], s22 offen sc1
  s_waitcnt vmcnt(31) lgkmcnt(10)
  v_mfma_f32_32x32x16_bf16 v[64:79], v[24:27], v[208:211], v[64:79]
  ds_read_b64_tr_b16 v[48:49], v58 offset:20480
  ds_read_b64_tr_b16 v[50:51], v58 offset:22528
  s_waitcnt lgkmcnt(10)
  v_mfma_f32_32x32x16_bf16 v[80:95], v[28:31], v[208:211], v[80:95]
  ds_read_b64_tr_b16 v[52:53], v59 offset:20480
  ds_read_b64_tr_b16 v[54:55], v59 offset:22528
  s_waitcnt lgkmcnt(10)
  v_mfma_f32_32x32x16_bf16 v[96:111], v[32:35], v[208:211], v[96:111]
  ds_read_b64_tr_b16 v[24:25], v56 offset:24576
  ds_read_b64_tr_b16 v[26:27], v56 offset:26624
  s_waitcnt lgkmcnt(10)
  v_mfma_f32_32x32x16_bf16 v[112:127], v[36:39], v[208:211], v[112:127]
  ds_read_b64_tr_b16 v[28:29], v57 offset:24576
  ds_read_b64_tr_b16 v[30:31], v57 offset:26624
  s_waitcnt vmcnt(30) lgkmcnt(10)
  v_mfma_f32_32x32x16_bf16 v[64:79], v[40:43], v[212:215], v[64:79]
  ds_read_b64_tr_b16 v[32:33], v58 offset:24576
  ds_read_b64_tr_b16 v[34:35], v58 offset:26624
  s_waitcnt lgkmcnt(10)
  v_mfma_f32_32x32x16_bf16 v[80:95], v[44:47], v[212:215], v[80:95]
  ds_read_b64_tr_b16 v[36:37], v59 offset:24576
  ds_read_b64_tr_b16 v[38:39], v59 offset:26624
  s_waitcnt lgkmcnt(10)
  v_mfma_f32_32x32x16_bf16 v[96:111], v[48:51], v[212:215], v[96:111]
  ds_read_b64_tr_b16 v[40:41], v56 offset:28672
  ds_read_b64_tr_b16 v[42:43], v56 offset:30720
  s_waitcnt lgkmcnt(10)
  v_mfma_f32_32x32x16_bf16 v[112:127], v[52:55], v[212:215], v[112:127]
  ds_read_b64_tr_b16 v[44:45], v57 offset:28672
  ds_read_b64_tr_b16 v[46:47], v57 offset:30720
  s_add_u32 s22, s27, 50176
  buffer_store_dwordx4 v[180:183], v20, s[16:19], s22 offen sc1
  s_waitcnt vmcnt(29) lgkmcnt(10)
  v_mfma_f32_32x32x16_bf16 v[64:79], v[24:27], v[216:219], v[64:79]
  ds_read_b64_tr_b16 v[48:49], v58 offset:28672
  ds_read_b64_tr_b16 v[50:51], v58 offset:30720
  s_waitcnt lgkmcnt(10)
  v_mfma_f32_32x32x16_bf16 v[80:95], v[28:31], v[216:219], v[80:95]
  ds_read_b64_tr_b16 v[52:53], v59 offset:28672
  ds_read_b64_tr_b16 v[54:55], v59 offset:30720
  s_waitcnt lgkmcnt(10)
  v_mfma_f32_32x32x16_bf16 v[96:111], v[32:35], v[216:219], v[96:111]
  s_waitcnt lgkmcnt(8)
  v_mfma_f32_32x32x16_bf16 v[112:127], v[36:39], v[216:219], v[112:127]
  s_waitcnt vmcnt(28) lgkmcnt(6)
  v_mfma_f32_32x32x16_bf16 v[64:79], v[40:43], v[220:223], v[64:79]
  s_waitcnt lgkmcnt(4)
  v_mfma_f32_32x32x16_bf16 v[80:95], v[44:47], v[220:223], v[80:95]
  s_waitcnt lgkmcnt(2)
  v_mfma_f32_32x32x16_bf16 v[96:111], v[48:51], v[220:223], v[96:111]
  s_waitcnt lgkmcnt(0)
  v_mfma_f32_32x32x16_bf16 v[112:127], v[52:55], v[220:223], v[112:127]
  s_add_u32 s22, s27, 51200
  buffer_store_dwordx4 v[184:187], v20, s[16:19], s22 offen sc1
  s_waitcnt vmcnt(4)
  s_barrier
  v_add_u32 v56, 0x8000, v56
  v_add_u32 v57, 0x8000, v57
  v_add_u32 v58, 0x8000, v58
  v_add_u32 v59, 0x8000, v59
  ds_read_b64_tr_b16 v[24:25], v56 offset:0
  ds_read_b64_tr_b16 v[26:27], v56 offset:2048
  ds_read_b64_tr_b16 v[28:29], v57 offset:0
  ds_read_b64_tr_b16 v[30:31], v57 offset:2048
  ds_read_b64_tr_b16 v[32:33], v58 offset:0
  ds_read_b64_tr_b16 v[34:35], v58 offset:2048
  ds_read_b64_tr_b16 v[36:37], v59 offset:0
  ds_read_b64_tr_b16 v[38:39], v59 offset:2048
  ds_read_b64_tr_b16 v[40:41], v56 offset:4096
  ds_read_b64_tr_b16 v[42:43], v56 offset:6144
  ds_read_b64_tr_b16 v[44:45], v57 offset:4096
  ds_read_b64_tr_b16 v[46:47], v57 offset:6144
  s_mov_b32 s35, 65536
main_kernel_spin_9:
  v_and_b32 v60, 15, v60
  v_cmp_gt_u32 vcc, 8, v60
  s_nop 1
  s_and_b32 s22, vcc_lo, 3
  s_cbranch_scc0 main_kernel_ok_8
  s_sub_u32 s35, s35, 1
  s_cbranch_scc1 main_kernel_ok_8
  s_sleep 8
  buffer_load_dword v60, v61, s[80:83], 0 offen offset:128 sc1
  s_waitcnt vmcnt(0)
  s_branch main_kernel_spin_9
main_kernel_ok_8:
  s_add_u32 s23, s5, 0
  buffer_load_dwordx2 v[12:13], v62, s[88:91], s23 offen sc1
  s_add_u32 s23, s5, 16384
  buffer_load_dwordx2 v[14:15], v62, s[88:91], s23 offen sc1
  s_add_u32 s23, s5, 32768
  buffer_load_dwordx2 v[16:17], v62, s[88:91], s23 offen sc1
  s_add_u32 s23, s5, 49152
  buffer_load_dwordx2 v[18:19], v62, s[88:91], s23 offen sc1
  s_waitcnt vmcnt(25) lgkmcnt(10)
  v_mfma_f32_32x32x16_bf16 v[64:79], v[24:27], v[224:227], v[64:79]
  ds_read_b64_tr_b16 v[48:49], v58 offset:4096
  ds_read_b64_tr_b16 v[50:51], v58 offset:6144
  s_waitcnt lgkmcnt(10)
  v_mfma_f32_32x32x16_bf16 v[80:95], v[28:31], v[224:227], v[80:95]
  ds_read_b64_tr_b16 v[52:53], v59 offset:4096
  ds_read_b64_tr_b16 v[54:55], v59 offset:6144
  s_waitcnt lgkmcnt(10)
  v_mfma_f32_32x32x16_bf16 v[96:111], v[32:35], v[224:227], v[96:111]
  ds_read_b64_tr_b16 v[24:25], v56 offset:8192
  ds_read_b64_tr_b16 v[26:27], v56 offset:10240
  s_waitcnt lgkmcnt(10)
  v_mfma_f32_32x32x16_bf16 v[112:127], v[36:39], v[224:227], v[112:127]
  ds_read_b64_tr_b16 v[28:29], v57 offset:8192
  ds_read_b64_tr_b16 v[30:31], v57 offset:10240
  s_add_u32 s22, s27, 52224
  buffer_store_dwordx4 v[188:191], v20, s[16:19], s22 offen sc1
  s_add_u32 s23, s4, 0
  buffer_load_dwordx4 v[192:195], v20, s[84:87], s23 offen sc1
  s_add_u32 s23, s4, 0
  buffer_load_dwordx4 v[196:199], v20, s[84:87], s23 offen offset:1024 sc1
  s_waitcnt vmcnt(27) lgkmcnt(10)
  v_mfma_f32_32x32x16_bf16 v[64:79], v[40:43], v[228:231], v[64:79]
  ds_read_b64_tr_b16 v[32:33], v58 offset:8192
  ds_read_b64_tr_b16 v[34:35], v58 offset:10240
  s_waitcnt lgkmcnt(10)
  v_mfma_f32_32x32x16_bf16 v[80:95], v[44:47], v[228:231], v[80:95]
  ds_read_b64_tr_b16 v[36:37], v59 offset:8192
  ds_read_b64_tr_b16 v[38:39], v59 offset:10240
  s_waitcnt lgkmcnt(10)
  v_mfma_f32_32x32x16_bf16 v[96:111], v[48:51], v[228:231], v[96:111]
  ds_read_b64_tr_b16 v[40:41], v56 offset:12288
  ds_read_b64_tr_b16 v[42:43], v56 offset:14336
  s_waitcnt lgkmcnt(10)
  v_mfma_f32_32x32x16_bf16 v[112:127], v[52:55], v[228:231], v[112:127]
  ds_read_b64_tr_b16 v[44:45], v57 offset:12288
  ds_read_b64_tr_b16 v[46:47], v57 offset:14336
  s_add_u32 s23, s4, 0
  buffer_load_dwordx4 v[200:203], v20, s[84:87], s23 offen offset:2048 sc1
  s_add_u32 s23, s4, 0
  buffer_load_dwordx4 v[204:207], v20, s[84:87], s23 offen offset:3072 sc1
  s_waitcnt vmcnt(28) lgkmcnt(10)
  v_mfma_f32_32x32x16_bf16 v[64:79], v[24:27], v[232:235], v[64:79]
  ds_read_b64_tr_b16 v[48:49], v58 offset:12288
  ds_read_b64_tr_b16 v[50:51], v58 offset:14336
  s_waitcnt lgkmcnt(10)
  v_mfma_f32_32x32x16_bf16 v[80:95], v[28:31], v[232:235], v[80:95]
  ds_read_b64_tr_b16 v[52:53], v59 offset:12288
  ds_read_b64_tr_b16 v[54:55], v59 offset:14336
  s_waitcnt lgkmcnt(10)
  v_mfma_f32_32x32x16_bf16 v[96:111], v[32:35], v[232:235], v[96:111]
  ds_read_b64_tr_b16 v[24:25], v56 offset:16384
  ds_read_b64_tr_b16 v[26:27], v56 offset:18432
  s_waitcnt lgkmcnt(10)
  v_mfma_f32_32x32x16_bf16 v[112:127], v[36:39], v[232:235], v[112:127]
  ds_read_b64_tr_b16 v[28:29], v57 offset:16384
  ds_read_b64_tr_b16 v[30:31], v57 offset:18432
  s_add_u32 s23, s4, 4096
  buffer_load_dwordx4 v[208:211], v20, s[84:87], s23 offen sc1
  s_add_u32 s23, s4, 4096
  buffer_load_dwordx4 v[212:215], v20, s[84:87], s23 offen offset:1024 sc1
  s_waitcnt vmcnt(28) lgkmcnt(10)
  v_mfma_f32_32x32x16_bf16 v[64:79], v[40:43], v[236:239], v[64:79]
  ds_read_b64_tr_b16 v[32:33], v58 offset:16384
  ds_read_b64_tr_b16 v[34:35], v58 offset:18432
  s_waitcnt lgkmcnt(10)
  v_mfma_f32_32x32x16_bf16 v[80:95], v[44:47], v[236:239], v[80:95]
  ds_read_b64_tr_b16 v[36:37], v59 offset:16384
  ds_read_b64_tr_b16 v[38:39], v59 offset:18432
  s_waitcnt lgkmcnt(10)
  v_mfma_f32_32x32x16_bf16 v[96:111], v[48:51], v[236:239], v[96:111]
  ds_read_b64_tr_b16 v[40:41], v56 offset:20480
  ds_read_b64_tr_b16 v[42:43], v56 offset:22528
  s_waitcnt lgkmcnt(10)
  v_mfma_f32_32x32x16_bf16 v[112:127], v[52:55], v[236:239], v[112:127]
  ds_read_b64_tr_b16 v[44:45], v57 offset:20480
  ds_read_b64_tr_b16 v[46:47], v57 offset:22528
  s_add_u32 s23, s4, 4096
  buffer_load_dwordx4 v[216:219], v20, s[84:87], s23 offen offset:2048 sc1
  s_add_u32 s23, s4, 4096
  buffer_load_dwordx4 v[220:223], v20, s[84:87], s23 offen offset:3072 sc1
  s_waitcnt vmcnt(29) lgkmcnt(10)
  v_mfma_f32_32x32x16_bf16 v[64:79], v[24:27], v[240:243], v[64:79]
  ds_read_b64_tr_b16 v[48:49], v58 offset:20480
  ds_read_b64_tr_b16 v[50:51], v58 offset:22528
  s_waitcnt lgkmcnt(10)
  v_mfma_f32_32x32x16_bf16 v[80:95], v[28:31], v[240:243], v[80:95]
  ds_read_b64_tr_b16 v[52:53], v59 offset:20480
  ds_read_b64_tr_b16 v[54:55], v59 offset:22528
  s_waitcnt lgkmcnt(10)
  v_mfma_f32_32x32x16_bf16 v[96:111], v[32:35], v[240:243], v[96:111]
  ds_read_b64_tr_b16 v[24:25], v56 offset:24576
  ds_read_b64_tr_b16 v[26:27], v56 offset:26624
  s_waitcnt lgkmcnt(10)
  v_mfma_f32_32x32x16_bf16 v[112:127], v[36:39], v[240:243], v[112:127]
  ds_read_b64_tr_b16 v[28:29], v57 offset:24576
  ds_read_b64_tr_b16 v[30:31], v57 offset:26624
  s_add_u32 s23, s4, 8192
  buffer_load_dwordx4 v[224:227], v20, s[84:87], s23 offen sc1
  s_add_u32 s23, s4, 8192
  buffer_load_dwordx4 v[228:231], v20, s[84:87], s23 offen offset:1024 sc1
  s_waitcnt vmcnt(29) lgkmcnt(10)
  v_mfma_f32_32x32x16_bf16 v[64:79], v[40:43], v[244:247], v[64:79]
  ds_read_b64_tr_b16 v[32:33], v58 offset:24576
  ds_read_b64_tr_b16 v[34:35], v58 offset:26624
  s_waitcnt lgkmcnt(10)
  v_mfma_f32_32x32x16_bf16 v[80:95], v[44:47], v[244:247], v[80:95]
  ds_read_b64_tr_b16 v[36:37], v59 offset:24576
  ds_read_b64_tr_b16 v[38:39], v59 offset:26624
  s_waitcnt lgkmcnt(10)
  v_mfma_f32_32x32x16_bf16 v[96:111], v[48:51], v[244:247], v[96:111]
  ds_read_b64_tr_b16 v[40:41], v56 offset:28672
  ds_read_b64_tr_b16 v[42:43], v56 offset:30720
  s_waitcnt lgkmcnt(10)
  v_mfma_f32_32x32x16_bf16 v[112:127], v[52:55], v[244:247], v[112:127]
  ds_read_b64_tr_b16 v[44:45], v57 offset:28672
  ds_read_b64_tr_b16 v[46:47], v57 offset:30720
  s_add_u32 s23, s4, 8192
  buffer_load_dwordx4 v[232:235], v20, s[84:87], s23 offen offset:2048 sc1
  s_add_u32 s23, s4, 8192
  buffer_load_dwordx4 v[236:239], v20, s[84:87], s23 offen offset:3072 sc1
  s_waitcnt vmcnt(30) lgkmcnt(10)
  v_mfma_f32_32x32x16_bf16 v[64:79], v[24:27], v[248:251], v[64:79]
  ds_read_b64_tr_b16 v[48:49], v58 offset:28672
  ds_read_b64_tr_b16 v[50:51], v58 offset:30720
  s_waitcnt lgkmcnt(10)
  v_mfma_f32_32x32x16_bf16 v[80:95], v[28:31], v[248:251], v[80:95]
  ds_read_b64_tr_b16 v[52:53], v59 offset:28672
  ds_read_b64_tr_b16 v[54:55], v59 offset:30720
  s_waitcnt lgkmcnt(10)
  v_mfma_f32_32x32x16_bf16 v[96:111], v[32:35], v[248:251], v[96:111]
  s_waitcnt lgkmcnt(8)
  v_mfma_f32_32x32x16_bf16 v[112:127], v[36:39], v[248:251], v[112:127]
  s_add_u32 s23, s4, 12288
  buffer_load_dwordx4 v[240:243], v20, s[84:87], s23 offen sc1
  s_add_u32 s23, s4, 12288
  buffer_load_dwordx4 v[244:247], v20, s[84:87], s23 offen offset:1024 sc1
  s_waitcnt vmcnt(30) lgkmcnt(6)
  v_mfma_f32_32x32x16_bf16 v[64:79], v[40:43], v[252:255], v[64:79]
  s_waitcnt lgkmcnt(4)
  v_mfma_f32_32x32x16_bf16 v[80:95], v[44:47], v[252:255], v[80:95]
  s_waitcnt lgkmcnt(2)
  v_mfma_f32_32x32x16_bf16 v[96:111], v[48:51], v[252:255], v[96:111]
  s_waitcnt lgkmcnt(0)
  v_mfma_f32_32x32x16_bf16 v[112:127], v[52:55], v[252:255], v[112:127]
  s_add_u32 s23, s4, 12288
  buffer_load_dwordx4 v[248:251], v20, s[84:87], s23 offen offset:2048 sc1
  s_add_u32 s23, s4, 12288
  buffer_load_dwordx4 v[252:255], v20, s[84:87], s23 offen offset:3072 sc1
  s_mov_b32 s22, 0x3e0293ee
  s_cmp_eq_u32 s38, 3
  s_cselect_b32 s4, 0, s38
  s_add_u32 s5, s4, 1
  s_cmp_eq_u32 s5, 3
  s_cselect_b32 s5, 0, s5
  s_add_u32 s6, s5, 1
  s_cmp_eq_u32 s6, 3
  s_cselect_b32 s6, 0, s6
  v_bfe_u32 v60, v2, 2, 2
  v_lshl_add_u32 v60, v22, 2, v60
  v_mul_u32_u24 v60, 192, v60
  v_bfe_u32 v61, v2, 4, 1
  v_lshl_add_u32 v60, v61, 5, v60
  v_and_b32 v61, 3, v2
  v_lshl_add_u32 v60, v61, 3, v60
  s_mul_i32 s23, s39, 49152
  v_add_u32 v60, s23, v60
  s_lshl_b32 s23, s4, 6
  v_add_u32 v56, s23, v60
  s_lshl_b32 s23, s5, 6
  v_add_u32 v57, s23, v60
  s_lshl_b32 s23, s6, 6
  v_add_u32 v58, s23, v60
  v_mov_b32 v62, s22
  s_nop 7
  v_pk_mul_f32 v[64:65], v[64:65], v[62:63] op_sel_hi:[1,0]
  v_pk_mul_f32 v[66:67], v[66:67], v[62:63] op_sel_hi:[1,0]
  v_pk_mul_f32 v[68:69], v[68:69], v[62:63] op_sel_hi:[1,0]
  v_pk_mul_f32 v[70:71], v[70:71], v[62:63] op_sel_hi:[1,0]
  v_cvt_pk_bf16_f32 v128, v64, v65
  v_cvt_pk_bf16_f32 v129, v66, v67
  v_cvt_pk_bf16_f32 v130, v68, v69
  v_cvt_pk_bf16_f32 v131, v70, v71
  v_pk_mul_f32 v[72:73], v[72:73], v[62:63] op_sel_hi:[1,0]
  v_pk_mul_f32 v[74:75], v[74:75], v[62:63] op_sel_hi:[1,0]
  v_pk_mul_f32 v[76:77], v[76:77], v[62:63] op_sel_hi:[1,0]
  v_pk_mul_f32 v[78:79], v[78:79], v[62:63] op_sel_hi:[1,0]
  v_cvt_pk_bf16_f32 v132, v72, v73
  v_cvt_pk_bf16_f32 v133, v74, v75
  v_cvt_pk_bf16_f32 v134, v76, v77
  v_cvt_pk_bf16_f32 v135, v78, v79
  v_pk_mul_f32 v[80:81], v[80:81], v[62:63] op_sel_hi:[1,0]
  v_pk_mul_f32 v[82:83], v[82:83], v[62:63] op_sel_hi:[1,0]
  v_pk_mul_f32 v[84:85], v[84:85], v[62:63] op_sel_hi:[1,0]
  v_pk_mul_f32 v[86:87], v[86:87], v[62:63] op_sel_hi:[1,0]
  v_cvt_pk_bf16_f32 v136, v80, v81
  v_cvt_pk_bf16_f32 v137, v82, v83
  v_cvt_pk_bf16_f32 v138, v84, v85
  v_cvt_pk_bf16_f32 v139, v86, v87
  v_pk_mul_f32 v[88:89], v[88:89], v[62:63] op_sel_hi:[1,0]
  v_pk_mul_f32 v[90:91], v[90:91], v[62:63] op_sel_hi:[1,0]
  v_pk_mul_f32 v[92:93], v[92:93], v[62:63] op_sel_hi:[1,0]
  v_pk_mul_f32 v[94:95], v[94:95], v[62:63] op_sel_hi:[1,0]
  v_cvt_pk_bf16_f32 v140, v88, v89
  v_cvt_pk_bf16_f32 v141, v90, v91
  v_cvt_pk_bf16_f32 v142, v92, v93
  v_cvt_pk_bf16_f32 v143, v94, v95
  v_pk_mul_f32 v[96:97], v[96:97], v[62:63] op_sel_hi:[1,0]
  v_pk_mul_f32 v[98:99], v[98:99], v[62:63] op_sel_hi:[1,0]
  v_pk_mul_f32 v[100:101], v[100:101], v[62:63] op_sel_hi:[1,0]
  v_pk_mul_f32 v[102:103], v[102:103], v[62:63] op_sel_hi:[1,0]
  v_cvt_pk_bf16_f32 v144, v96, v97
  v_cvt_pk_bf16_f32 v145, v98, v99
  v_cvt_pk_bf16_f32 v146, v100, v101
  v_cvt_pk_bf16_f32 v147, v102, v103
  v_pk_mul_f32 v[104:105], v[104:105], v[62:63] op_sel_hi:[1,0]
  v_pk_mul_f32 v[106:107], v[106:107], v[62:63] op_sel_hi:[1,0]
  v_pk_mul_f32 v[108:109], v[108:109], v[62:63] op_sel_hi:[1,0]
  v_pk_mul_f32 v[110:111], v[110:111], v[62:63] op_sel_hi:[1,0]
  v_cvt_pk_bf16_f32 v148, v104, v105
  v_cvt_pk_bf16_f32 v149, v106, v107
  v_cvt_pk_bf16_f32 v150, v108, v109
  v_cvt_pk_bf16_f32 v151, v110, v111
  v_pk_mul_f32 v[112:113], v[112:113], v[62:63] op_sel_hi:[1,0]
  v_pk_mul_f32 v[114:115], v[114:115], v[62:63] op_sel_hi:[1,0]
  v_pk_mul_f32 v[116:117], v[116:117], v[62:63] op_sel_hi:[1,0]
  v_pk_mul_f32 v[118:119], v[118:119], v[62:63] op_sel_hi:[1,0]
  v_cvt_pk_bf16_f32 v152, v112, v113
  v_cvt_pk_bf16_f32 v153, v114, v115
  v_cvt_pk_bf16_f32 v154, v116, v117
  v_cvt_pk_bf16_f32 v155, v118, v119
  v_pk_mul_f32 v[120:121], v[120:121], v[62:63] op_sel_hi:[1,0]
  v_pk_mul_f32 v[122:123], v[122:123], v[62:63] op_sel_hi:[1,0]
  v_pk_mul_f32 v[124:125], v[124:125], v[62:63] op_sel_hi:[1,0]
  v_pk_mul_f32 v[126:127], v[126:127], v[62:63] op_sel_hi:[1,0]
  v_cvt_pk_bf16_f32 v156, v120, v121
  v_cvt_pk_bf16_f32 v157, v122, v123
  v_cvt_pk_bf16_f32 v158, v124, v125
  v_cvt_pk_bf16_f32 v159, v126, v127
  v_and_b32 v25, 15, v2
  v_bfe_u32 v26, v2, 4, 1
  v_cmp_eq_u32 vcc, v25, v26
  v_mov_b32 v27, 0x3f803f80
  v_cndmask_b32 v24, 0, v27, vcc
  v_mov_b32 v25, v24
  v_mov_b32 v26, v24
  v_mov_b32 v27, v24
  v_mov_b32 v28, 0xc0135761
  v_mov_b32 v29, 0xbdd2d3e8
  s_mul_i32 s22, s20, 6144
  s_add_u32 s22, s22, 98304
  v_add_u32 v30, s22, v20
  s_xor_b32 s22, s20, 4
  s_mul_i32 s22, s22, 6144
  s_add_u32 s22, s22, 98304
  v_add_u32 v31, s22, v20
  s_waitcnt vmcnt(15)
  s_barrier
  s_cmp_lg_u32 s20, 0
  s_cbranch_scc1 main_kernel_sig_10
  s_lshl_b32 s22, s43, 2
  s_lshl_b32 s7, 0x100, s44
  v_mov_b32 v10, 0
  v_mov_b32 v11, s7
  s_mov_b64 exec, 1
  buffer_atomic_add v11, v10, s[80:83], s22 offen
  s_mov_b64 exec, -1
main_kernel_sig_10:
  ds_read_b64_tr_b16 v[160:161], v56 offset:0
  ds_read_b64_tr_b16 v[162:163], v56 offset:1536
  ds_read_b64_tr_b16 v[164:165], v57 offset:0
  ds_read_b64_tr_b16 v[166:167], v57 offset:1536
  ds_read_b64_tr_b16 v[168:169], v58 offset:0
  ds_read_b64_tr_b16 v[170:171], v58 offset:1536
  ds_read_b64_tr_b16 v[172:173], v56 offset:3072
  ds_read_b64_tr_b16 v[174:175], v56 offset:4608
  ds_read_b64_tr_b16 v[176:177], v57 offset:3072
  ds_read_b64_tr_b16 v[178:179], v57 offset:4608
  ds_read_b64_tr_b16 v[180:181], v58 offset:3072
  ds_read_b64_tr_b16 v[182:183], v58 offset:4608
  s_waitcnt vmcnt(15) lgkmcnt(10)
  v_mfma_f32_32x32x16_bf16 v[64:79], v[160:163], v[192:195], 0
  v_mfma_f32_16x16x32_bf16 v[112:115], v[160:163], v[24:27], 0
  ds_read_b64_tr_b16 v[184:185], v56 offset:6144
  ds_read_b64_tr_b16 v[186:187], v56 offset:7680
  s_waitcnt lgkmcnt(10)
  v_mfma_f32_32x32x16_bf16 v[80:95], v[164:167], v[192:195], 0
  ds_read_b64_tr_b16 v[188:189], v57 offset:6144
  ds_read_b64_tr_b16 v[190:191], v57 offset:7680
  s_waitcnt lgkmcnt(10)
  v_mfma_f32_32x32x16_bf16 v[96:111], v[168:171], v[192:195], 0
  ds_read_b64_tr_b16 v[160:161], v58 offset:6144
  ds_read_b64_tr_b16 v[162:163], v58 offset:7680
  s_waitcnt vmcnt(14) lgkmcnt(10)
  v_mfma_f32_32x32x16_bf16 v[64:79], v[172:175], v[196:199], v[64:79]
  v_mfma_f32_16x16x32_bf16 v[112:115], v[172:175], v[24:27], v[112:115]
  ds_read_b64_tr_b16 v[164:165], v56 offset:9216
  ds_read_b64_tr_b16 v[166:167], v56 offset:10752
  s_waitcnt lgkmcnt(10)
  v_mfma_f32_32x32x16_bf16 v[80:95], v[176:179], v[196:199], v[80:95]
  ds_read_b64_tr_b16 v[168:169], v57 offset:9216
  ds_read_b64_tr_b16 v[170:171], v57 offset:10752
  s_waitcnt lgkmcnt(10)
  v_mfma_f32_32x32x16_bf16 v[96:111], v[180:183], v[196:199], v[96:111]
  ds_read_b64_tr_b16 v[172:173], v58 offset:9216
  ds_read_b64_tr_b16 v[174:175], v58 offset:10752
  s_waitcnt vmcnt(13) lgkmcnt(10)
  v_mfma_f32_32x32x16_bf16 v[64:79], v[184:187], v[200:203], v[64:79]
  v_mfma_f32_16x16x32_bf16 v[112:115], v[184:187], v[24:27], v[112:115]
  ds_read_b64_tr_b16 v[176:177], v56 offset:12288
  ds_read_b64_tr_b16 v[178:179], v56 offset:13824
  s_waitcnt lgkmcnt(10)
  v_mfma_f32_32x32x16_bf16 v[80:95], v[188:191], v[200:203], v[80:95]
  ds_read_b64_tr_b16 v[180:181], v57 offset:12288
  ds_read_b64_tr_b16 v[182:183], v57 offset:13824
  v_add_f32 v36, v12, v14
  v_add_f32 v37, v13, v15
  s_waitcnt lgkmcnt(10)
  v_mfma_f32_32x32x16_bf16 v[96:111], v[160:163], v[200:203], v[96:111]
  ds_read_b64_tr_b16 v[184:185], v58 offset:12288
  ds_read_b64_tr_b16 v[186:187], v58 offset:13824
  v_add_f32 v36, v36, v16
  v_add_f32 v37, v37, v17
  s_waitcnt vmcnt(12) lgkmcnt(10)
  v_mfma_f32_32x32x16_bf16 v[64:79], v[164:167], v[204:207], v[64:79]
  v_mfma_f32_16x16x32_bf16 v[112:115], v[164:167], v[24:27], v[112:115]
  ds_read_b64_tr_b16 v[188:189], v56 offset:15360
  ds_read_b64_tr_b16 v[190:191], v56 offset:16896
  s_waitcnt lgkmcnt(10)
  v_mfma_f32_32x32x16_bf16 v[80:95], v[168:171], v[204:207], v[80:95]
  ds_read_b64_tr_b16 v[160:161], v57 offset:15360
  ds_read_b64_tr_b16 v[162:163], v57 offset:16896
  v_add_f32 v36, v36, v18
  v_add_f32 v37, v37, v19
  s_waitcnt lgkmcnt(10)
  v_mfma_f32_32x32x16_bf16 v[96:111], v[172:175], v[204:207], v[96:111]
  ds_read_b64_tr_b16 v[164:165], v58 offset:15360
  ds_read_b64_tr_b16 v[166:167], v58 offset:16896
  v_mov_b32 v38, v36
  s_nop 1
  v_permlane32_swap_b32 v36, v38
  s_nop 1
  v_add_f32 v36, v36, v38
  s_waitcnt vmcnt(11) lgkmcnt(10)
  v_mfma_f32_32x32x16_bf16 v[64:79], v[176:179], v[208:211], v[64:79]
  v_mfma_f32_16x16x32_bf16 v[112:115], v[176:179], v[24:27], v[112:115]
  ds_read_b64_tr_b16 v[168:169], v56 offset:18432
  ds_read_b64_tr_b16 v[170:171], v56 offset:19968
  s_waitcnt lgkmcnt(10)
  v_mfma_f32_32x32x16_bf16 v[80:95], v[180:183], v[208:211], v[80:95]
  ds_read_b64_tr_b16 v[172:173], v57 offset:18432
  ds_read_b64_tr_b16 v[174:175], v57 offset:19968
  v_mov_b32 v38, v37
  s_nop 1
  v_permlane32_swap_b32 v37, v38
  s_nop 1
  v_add_f32 v37, v37, v38
  s_waitcnt lgkmcnt(10)
  v_mfma_f32_32x32x16_bf16 v[96:111], v[184:187], v[208:211], v[96:111]
  ds_read_b64_tr_b16 v[176:177], v58 offset:18432
  ds_read_b64_tr_b16 v[178:179], v58 offset:19968
  v_mul_f32 v39, 0x3b000000, v36
  v_mul_f32 v40, 0x3b000000, v37
  s_waitcnt vmcnt(10) lgkmcnt(10)
  v_mfma_f32_32x32x16_bf16 v[64:79], v[188:191], v[212:215], v[64:79]
  v_mfma_f32_16x16x32_bf16 v[112:115], v[188:191], v[24:27], v[112:115]
  ds_read_b64_tr_b16 v[180:181], v56 offset:21504
  ds_read_b64_tr_b16 v[182:183], v56 offset:23040
  s_waitcnt lgkmcnt(10)
  v_mfma_f32_32x32x16_bf16 v[80:95], v[160:163], v[212:215], v[80:95]
  ds_read_b64_tr_b16 v[184:185], v57 offset:21504
  ds_read_b64_tr_b16 v[186:187], v57 offset:23040
  v_fma_f32 v40, -v39, v39, v40
  v_max_f32 v40, 0, v40
  v_add_f32 v40, 0x3727c5ac, v40
  v_rsq_f32 v40, v40
  s_waitcnt lgkmcnt(10)
  v_mfma_f32_32x32x16_bf16 v[96:111], v[164:167], v[212:215], v[96:111]
  ds_read_b64_tr_b16 v[188:189], v58 offset:21504
  ds_read_b64_tr_b16 v[190:191], v58 offset:23040
  s_mul_i32 s22, s39, 384
  s_lshl_b32 s23, s4, 7
  s_add_u32 s22, s22, s23
  s_add_u32 s22, s22, 147456
  v_lshlrev_b32 v41, 4, v22
  v_lshlrev_b32 v42, 6, v2
  v_and_b32 v42, 64, v42
  v_and_b32 v43, 48, v2
  v_add_u32 v42, v42, v43
  v_add_u32 v42, s22, v42
  s_waitcnt vmcnt(9) lgkmcnt(10)
  v_mfma_f32_32x32x16_bf16 v[64:79], v[168:171], v[216:219], v[64:79]
  v_mfma_f32_16x16x32_bf16 v[112:115], v[168:171], v[24:27], v[112:115]
  ds_read_b64_tr_b16 v[160:161], v56 offset:24576
  ds_read_b64_tr_b16 v[162:163], v56 offset:26112
  s_waitcnt lgkmcnt(10)
  v_mfma_f32_32x32x16_bf16 v[80:95], v[172:175], v[216:219], v[80:95]
  ds_read_b64_tr_b16 v[164:165], v57 offset:24576
  ds_read_b64_tr_b16 v[166:167], v57 offset:26112
  s_waitcnt lgkmcnt(10)
  v_mfma_f32_32x32x16_bf16 v[96:111], v[176:179], v[216:219], v[96:111]
  ds_read_b64_tr_b16 v[168:169], v58 offset:24576
  ds_read_b64_tr_b16 v[170:171], v58 offset:26112
  s_waitcnt vmcnt(8) lgkmcnt(10)
  v_mfma_f32_32x32x16_bf16 v[64:79], v[180:183], v[220:223], v[64:79]
  v_mfma_f32_16x16x32_bf16 v[112:115], v[180:183], v[24:27], v[112:115]
  ds_read_b64_tr_b16 v[172:173], v56 offset:27648
  ds_read_b64_tr_b16 v[174:175], v56 offset:29184
  s_waitcnt lgkmcnt(10)
  v_mfma_f32_32x32x16_bf16 v[80:95], v[184:187], v[220:223], v[80:95]
  ds_read_b64_tr_b16 v[176:177], v57 offset:27648
  ds_read_b64_tr_b16 v[178:179], v57 offset:29184
  s_waitcnt lgkmcnt(10)
  v_mfma_f32_32x32x16_bf16 v[96:111], v[188:191], v[220:223], v[96:111]
  ds_read_b64_tr_b16 v[180:181], v58 offset:27648
  ds_read_b64_tr_b16 v[182:183], v58 offset:29184
  s_waitcnt vmcnt(7) lgkmcnt(10)
  v_mfma_f32_32x32x16_bf16 v[64:79], v[160:163], v[224:227], v[64:79]
  v_mfma_f32_16x16x32_bf16 v[112:115], v[160:163], v[24:27], v[112:115]
  ds_read_b64_tr_b16 v[184:185], v56 offset:30720
  ds_read_b64_tr_b16 v[186:187], v56 offset:32256
  s_waitcnt lgkmcnt(10)
  v_mfma_f32_32x32x16_bf16 v[80:95], v[164:167], v[224:227], v[80:95]
  ds_read_b64_tr_b16 v[188:189], v57 offset:30720
  ds_read_b64_tr_b16 v[190:191], v57 offset:32256
  s_waitcnt lgkmcnt(10)
  v_mfma_f32_32x32x16_bf16 v[96:111], v[168:171], v[224:227], v[96:111]
  ds_read_b64_tr_b16 v[160:161], v58 offset:30720
  ds_read_b64_tr_b16 v[162:163], v58 offset:32256
  s_waitcnt vmcnt(6) lgkmcnt(10)
  v_mfma_f32_32x32x16_bf16 v[64:79], v[172:175], v[228:231], v[64:79]
  v_mfma_f32_16x16x32_bf16 v[112:115], v[172:175], v[24:27], v[112:115]
  ds_read_b64_tr_b16 v[164:165], v56 offset:33792
  ds_read_b64_tr_b16 v[166:167], v56 offset:35328
  s_waitcnt lgkmcnt(10)
  v_mfma_f32_32x32x16_bf16 v[80:95], v[176:179], v[228:231], v[80:95]
  ds_read_b64_tr_b16 v[168:169], v57 offset:33792
  ds_read_b64_tr_b16 v[170:171], v57 offset:35328
  s_waitcnt lgkmcnt(10)
  v_mfma_f32_32x32x16_bf16 v[96:111], v[180:183], v[228:231], v[96:111]
  ds_read_b64_tr_b16 v[172:173], v58 offset:33792
  ds_read_b64_tr_b16 v[174:175], v58 offset:35328
  s_waitcnt vmcnt(5) lgkmcnt(10)
  v_mfma_f32_32x32x16_bf16 v[64:79], v[184:187], v[232:235], v[64:79]
  v_mfma_f32_16x16x32_bf16 v[112:115], v[184:187], v[24:27], v[112:115]
  ds_read_b64_tr_b16 v[176:177], v56 offset:36864
  ds_read_b64_tr_b16 v[178:179], v56 offset:38400
  s_waitcnt lgkmcnt(10)
  v_mfma_f32_32x32x16_bf16 v[80:95], v[188:191], v[232:235], v[80:95]
  ds_read_b64_tr_b16 v[180:181], v57 offset:36864
  ds_read_b64_tr_b16 v[182:183], v57 offset:38400
  s_waitcnt lgkmcnt(10)
  v_mfma_f32_32x32x16_bf16 v[96:111], v[160:163], v[232:235], v[96:111]
  ds_read_b64_tr_b16 v[184:185], v58 offset:36864
  ds_read_b64_tr_b16 v[186:187], v58 offset:38400
  s_lshl_b32 s22, s43, 2
  v_mov_b32 v35, s22
  buffer_load_dword v34, v35, s[80:83], 0 offen sc1
  s_waitcnt vmcnt(5) lgkmcnt(10)
  v_mfma_f32_32x32x16_bf16 v[64:79], v[164:167], v[236:239], v[64:79]
  v_mfma_f32_16x16x32_bf16 v[112:115], v[164:167], v[24:27], v[112:115]
  ds_read_b64_tr_b16 v[188:189], v56 offset:39936
  ds_read_b64_tr_b16 v[190:191], v56 offset:41472
  s_waitcnt lgkmcnt(10)
  v_mfma_f32_32x32x16_bf16 v[80:95], v[168:171], v[236:239], v[80:95]
  ds_read_b64_tr_b16 v[160:161], v57 offset:39936
  ds_read_b64_tr_b16 v[162:163], v57 offset:41472
  s_waitcnt lgkmcnt(10)
  v_mfma_f32_32x32x16_bf16 v[96:111], v[172:175], v[236:239], v[96:111]
  ds_read_b64_tr_b16 v[164:165], v58 offset:39936
  ds_read_b64_tr_b16 v[166:167], v58 offset:41472
  s_waitcnt vmcnt(4) lgkmcnt(10)
  v_mfma_f32_32x32x16_bf16 v[64:79], v[176:179], v[240:243], v[64:79]
  v_mfma_f32_16x16x32_bf16 v[112:115], v[176:179], v[24:27], v[112:115]
  ds_read_b64_tr_b16 v[168:169], v56 offset:43008
  ds_read_b64_tr_b16 v[170:171], v56 offset:44544
  s_waitcnt lgkmcnt(10)
  v_mfma_f32_32x32x16_bf16 v[80:95], v[180:183], v[240:243], v[80:95]
  ds_read_b64_tr_b16 v[172:173], v57 offset:43008
  ds_read_b64_tr_b16 v[174:175], v57 offset:44544
  s_waitcnt lgkmcnt(10)
  v_mfma_f32_32x32x16_bf16 v[96:111], v[184:187], v[240:243], v[96:111]
  ds_read_b64_tr_b16 v[176:177], v58 offset:43008
  ds_read_b64_tr_b16 v[178:179], v58 offset:44544
  s_waitcnt vmcnt(3) lgkmcnt(10)
  v_mfma_f32_32x32x16_bf16 v[64:79], v[188:191], v[244:247], v[64:79]
  v_mfma_f32_16x16x32_bf16 v[112:115], v[188:191], v[24:27], v[112:115]
  ds_read_b64_tr_b16 v[180:181], v56 offset:46080
  ds_read_b64_tr_b16 v[182:183], v56 offset:47616
  s_waitcnt lgkmcnt(10)
  v_mfma_f32_32x32x16_bf16 v[80:95], v[160:163], v[244:247], v[80:95]
  ds_read_b64_tr_b16 v[184:185], v57 offset:46080
  ds_read_b64_tr_b16 v[186:187], v57 offset:47616
  s_waitcnt lgkmcnt(10)
  v_mfma_f32_32x32x16_bf16 v[96:111], v[164:167], v[244:247], v[96:111]
  ds_read_b64_tr_b16 v[188:189], v58 offset:46080
  ds_read_b64_tr_b16 v[190:191], v58 offset:47616
  s_waitcnt vmcnt(2) lgkmcnt(10)
  v_mfma_f32_32x32x16_bf16 v[64:79], v[168:171], v[248:251], v[64:79]
  v_mfma_f32_16x16x32_bf16 v[112:115], v[168:171], v[24:27], v[112:115]
  s_waitcnt lgkmcnt(8)
  v_mfma_f32_32x32x16_bf16 v[80:95], v[172:175], v[248:251], v[80:95]
  s_waitcnt lgkmcnt(6)
  v_mfma_f32_32x32x16_bf16 v[96:111], v[176:179], v[248:251], v[96:111]
  s_waitcnt vmcnt(1) lgkmcnt(4)
  v_mfma_f32_32x32x16_bf16 v[64:79], v[180:183], v[252:255], v[64:79]
  v_mfma_f32_16x16x32_bf16 v[112:115], v[180:183], v[24:27], v[112:115]
  s_waitcnt lgkmcnt(2)
  v_mfma_f32_32x32x16_bf16 v[80:95], v[184:187], v[252:255], v[80:95]
  s_waitcnt lgkmcnt(0)
  v_mfma_f32_32x32x16_bf16 v[96:111], v[188:191], v[252:255], v[96:111]
  s_nop 15
  s_mov_b32 exec_lo, 0x00030003
  s_mov_b32 exec_hi, 0x00030003
  ds_write_b128 v42, v[112:115]
  s_mov_b64 exec, -1
  s_cmp_eq_u32 s39, 1
  s_cbranch_scc1 main_kernel_k1
  ds_write_b128 v30, v[72:75] offset:0
  ds_write_b128 v30, v[76:79] offset:1024
  ds_write_b128 v30, v[88:91] offset:2048
  ds_write_b128 v30, v[92:95] offset:3072
  ds_write_b128 v30, v[104:107] offset:4096
  ds_write_b128 v30, v[108:111] offset:5120
  s_branch main_kernel_kj
main_kernel_k1:
  ds_write_b128 v30, v[64:67] offset:0
  ds_write_b128 v30, v[68:71] offset:1024
  ds_write_b128 v30, v[80:83] offset:2048
  ds_write_b128 v30, v[84:87] offset:3072
  ds_write_b128 v30, v[96:99] offset:4096
  ds_write_b128 v30, v[100:103] offset:5120
main_kernel_kj:
  s_lshl_b32 s22, s43, 20
  s_add_u32 s8, s58, s22
  s_addc_u32 s9, s59, 0
  s_lshl_b32 s22, s44, 16
  s_sub_u32 s10, 0x100000, s22
  s_mov_b32 s11, 0x00020000
  s_add_u32 s12, s58, 0x2400000
  s_addc_u32 s13, s59, 0
  s_mov_b32 s14, 0x1000000
  s_mov_b32 s15, 0x00020000
  s_and_b32 s60, s20, 3
  s_cmp_ge_u32 s20, 4
  s_cbranch_scc1 main_kernel_nop
  s_waitcnt vmcnt(0)
  s_lshr_b32 s22, s44, 1
  s_sub_u32 s22, 8, s22
  s_lshl_b32 s7, 0x100, s22
  s_sub_u32 s7, s7, 0x100
  s_mov_b32 s35, 65536
main_kernel_spin_12:
  v_and_b32 v34, s7, v34
  v_cmp_ne_u32 vcc, s7, v34
  s_nop 1
  s_and_b32 s22, vcc_lo, 1
  s_cbranch_scc0 main_kernel_ok_11
  s_sub_u32 s35, s35, 1
  s_cbranch_scc1 main_kernel_ok_11
  s_sleep 4
  buffer_load_dword v34, v35, s[80:83], 0 offen sc1
  s_waitcnt vmcnt(0)
  s_branch main_kernel_spin_12
main_kernel_ok_11:
main_kernel_nop:
  s_waitcnt lgkmcnt(0)
  s_barrier
  s_cmp_ge_u32 s20, 4
  s_cbranch_scc1 main_kernel_shd
  s_lshl_b32 s48, s60, 11
  s_add_u32 m0, s48, 0
  s_add_u32 s49, s48, 0
  buffer_load_dwordx4 v20, s[8:11], s49 offen sc1 lds
  buffer_load_dwordx4 v20, s[8:11], s49 offen offset:1024 sc1 lds
  s_add_u32 m0, s48, 16384
  s_add_u32 s49, s48, 16384
  buffer_load_dwordx4 v20, s[8:11], s49 offen sc1 lds
  buffer_load_dwordx4 v20, s[8:11], s49 offen offset:1024 sc1 lds
  s_add_u32 m0, s48, 32768
  s_add_u32 s49, s48, 32768
  buffer_load_dwordx4 v20, s[8:11], s49 offen sc1 lds
  buffer_load_dwordx4 v20, s[8:11], s49 offen offset:1024 sc1 lds
  s_add_u32 m0, s48, 49152
  s_add_u32 s49, s48, 49152
  buffer_load_dwordx4 v20, s[8:11], s49 offen sc1 lds
  buffer_load_dwordx4 v20, s[8:11], s49 offen offset:1024 sc1 lds
  s_branch main_kernel_acq
main_kernel_shd:
  s_lshl_b32 s22, s60, 11
  s_add_u32 m0, s22, 57344
  s_add_u32 s22, s22, 8192
  buffer_load_dwordx4 v20, s[8:11], s22 offen sc1 lds
  buffer_load_dwordx4 v20, s[8:11], s22 offen offset:1024 sc1 lds
  s_and_b32 s22, s60, 1
  s_add_u32 s22, s22, 4
  s_lshl_b32 s47, s22, 14
  s_lshr_b32 s22, s60, 1
  s_lshl_b32 s22, s22, 13
  s_add_u32 s47, s47, s22
  s_add_u32 s48, s60, 4
  s_sub_u32 s23, s60, 1
  s_cmp_lt_u32 s60, 2
  s_cselect_b32 s48, s48, s23
  s_lshl_b32 s48, s48, 14
  s_add_u32 s48, s48, s22
  s_mov_b32 m0, s47
  s_nop 0
  buffer_load_dwordx4 v20, s[8:11], s48 offen sc1 lds
  buffer_load_dwordx4 v20, s[8:11], s48 offen offset:1024 sc1 lds
  buffer_load_dwordx4 v20, s[8:11], s48 offen offset:2048 sc1 lds
  buffer_load_dwordx4 v20, s[8:11], s48 offen offset:3072 sc1 lds
  s_add_u32 s49, s48, 4096
  s_add_u32 m0, s47, 4096
  s_nop 0
  buffer_load_dwordx4 v20, s[8:11], s49 offen sc1 lds
  buffer_load_dwordx4 v20, s[8:11], s49 offen offset:1024 sc1 lds
  buffer_load_dwordx4 v20, s[8:11], s49 offen offset:2048 sc1 lds
  buffer_load_dwordx4 v20, s[8:11], s49 offen offset:3072 sc1 lds
  s_add_u32 s47, s47, 32768
  s_and_b32 s47, s47, 0x1ffff
  s_add_u32 s48, s48, 32768
main_kernel_acq:
  ds_read_b128 v[192:195], v31 offset:0
  ds_read_b128 v[196:199], v31 offset:1024
  ds_read_b128 v[200:203], v31 offset:2048
  ds_read_b128 v[204:207], v31 offset:3072
  ds_read_b128 v[208:211], v31 offset:4096
  ds_read_b128 v[212:215], v31 offset:5120
  s_lshl_b32 s22, s4, 7
  s_lshl_b32 s23, s39, 6
  s_add_u32 s22, s22, s23
  s_add_u32 s22, s22, 147456
  v_add_u32 v42, s22, v41
  ds_read_b128 v[160:163], v42 offset:0
  ds_read_b128 v[164:167], v42 offset:32
  ds_read_b128 v[216:219], v42 offset:384
  ds_read_b128 v[220:223], v42 offset:416
  s_waitcnt lgkmcnt(4)
  s_lshl_b32 s22, s5, 7
  s_lshl_b32 s23, s39, 6
  s_add_u32 s22, s22, s23
  s_add_u32 s22, s22, 147456
  v_add_u32 v42, s22, v41
  ds_read_b128 v[168:171], v42 offset:0
  ds_read_b128 v[172:175], v42 offset:32
  ds_read_b128 v[224:227], v42 offset:384
  ds_read_b128 v[228:231], v42 offset:416
  s_lshl_b32 s22, s6, 7
  s_lshl_b32 s23, s39, 6
  s_add_u32 s22, s22, s23
  s_add_u32 s22, s22, 147456
  v_add_u32 v42, s22, v41
  ds_read_b128 v[176:179], v42 offset:0
  ds_read_b128 v[180:183], v42 offset:32
  ds_read_b128 v[232:235], v42 offset:384
  ds_read_b128 v[236:239], v42 offset:416
  v_mov_b32 v44, 1.0
  s_waitcnt lgkmcnt(0)
  s_cmp_eq_u32 s39, 1
  s_cbranch_scc1 main_kernel_ad1
  v_pk_add_f32 v[192:193], v[64:65], v[192:193]
  v_pk_add_f32 v[194:195], v[66:67], v[194:195]
  v_pk_add_f32 v[196:197], v[68:69], v[196:197]
  v_pk_add_f32 v[198:199], v[70:71], v[198:199]
  v_pk_add_f32 v[200:201], v[80:81], v[200:201]
  v_pk_add_f32 v[202:203], v[82:83], v[202:203]
  v_pk_add_f32 v[204:205], v[84:85], v[204:205]
  v_pk_add_f32 v[206:207], v[86:87], v[206:207]
  v_pk_add_f32 v[208:209], v[96:97], v[208:209]
  v_pk_add_f32 v[210:211], v[98:99], v[210:211]
  v_pk_add_f32 v[212:213], v[100:101], v[212:213]
  v_pk_add_f32 v[214:215], v[102:103], v[214:215]
  s_branch main_kernel_ad2
main_kernel_ad1:
  v_pk_add_f32 v[192:193], v[72:73], v[192:193]
  v_pk_add_f32 v[194:195], v[74:75], v[194:195]
  v_pk_add_f32 v[196:197], v[76:77], v[196:197]
  v_pk_add_f32 v[198:199], v[78:79], v[198:199]
  v_pk_add_f32 v[200:201], v[88:89], v[200:201]
  v_pk_add_f32 v[202:203], v[90:91], v[202:203]
  v_pk_add_f32 v[204:205], v[92:93], v[204:205]
  v_pk_add_f32 v[206:207], v[94:95], v[206:207]
  v_pk_add_f32 v[208:209], v[104:105], v[208:209]
  v_pk_add_f32 v[210:211], v[106:107], v[210:211]
  v_pk_add_f32 v[212:213], v[108:109], v[212:213]
  v_pk_add_f32 v[214:215], v[110:111], v[214:215]
main_kernel_ad2:
  v_pk_add_f32 v[160:161], v[160:161], v[216:217]
  v_pk_add_f32 v[162:163], v[162:163], v[218:219]
  v_pk_add_f32 v[164:165], v[164:165], v[220:221]
  v_pk_add_f32 v[166:167], v[166:167], v[222:223]
  v_pk_add_f32 v[168:169], v[168:169], v[224:225]
  v_pk_add_f32 v[170:171], v[170:171], v[226:227]
  v_pk_add_f32 v[172:173], v[172:173], v[228:229]
  v_pk_add_f32 v[174:175], v[174:175], v[230:231]
  v_pk_add_f32 v[176:177], v[176:177], v[232:233]
  v_pk_add_f32 v[178:179], v[178:179], v[234:235]
  v_pk_add_f32 v[180:181], v[180:181], v[236:237]
  v_pk_add_f32 v[182:183], v[182:183], v[238:239]
  v_pk_fma_f32 v[192:193], v[38:39], v[160:161], v[192:193] op_sel:[1,0,0] op_sel_hi:[1,1,1] neg_lo:[1,0,0] neg_hi:[1,0,0]
  v_pk_fma_f32 v[194:195], v[38:39], v[162:163], v[194:195] op_sel:[1,0,0] op_sel_hi:[1,1,1] neg_lo:[1,0,0] neg_hi:[1,0,0]
  v_pk_fma_f32 v[196:197], v[38:39], v[164:165], v[196:197] op_sel:[1,0,0] op_sel_hi:[1,1,1] neg_lo:[1,0,0] neg_hi:[1,0,0]
  v_pk_fma_f32 v[198:199], v[38:39], v[166:167], v[198:199] op_sel:[1,0,0] op_sel_hi:[1,1,1] neg_lo:[1,0,0] neg_hi:[1,0,0]
  v_pk_fma_f32 v[200:201], v[38:39], v[168:169], v[200:201] op_sel:[1,0,0] op_sel_hi:[1,1,1] neg_lo:[1,0,0] neg_hi:[1,0,0]
  v_pk_fma_f32 v[202:203], v[38:39], v[170:171], v[202:203] op_sel:[1,0,0] op_sel_hi:[1,1,1] neg_lo:[1,0,0] neg_hi:[1,0,0]
  v_pk_fma_f32 v[204:205], v[38:39], v[172:173], v[204:205] op_sel:[1,0,0] op_sel_hi:[1,1,1] neg_lo:[1,0,0] neg_hi:[1,0,0]
  v_pk_fma_f32 v[206:207], v[38:39], v[174:175], v[206:207] op_sel:[1,0,0] op_sel_hi:[1,1,1] neg_lo:[1,0,0] neg_hi:[1,0,0]
  v_pk_fma_f32 v[208:209], v[38:39], v[176:177], v[208:209] op_sel:[1,0,0] op_sel_hi:[1,1,1] neg_lo:[1,0,0] neg_hi:[1,0,0]
  v_pk_fma_f32 v[210:211], v[38:39], v[178:179], v[210:211] op_sel:[1,0,0] op_sel_hi:[1,1,1] neg_lo:[1,0,0] neg_hi:[1,0,0]
  v_pk_fma_f32 v[212:213], v[38:39], v[180:181], v[212:213] op_sel:[1,0,0] op_sel_hi:[1,1,1] neg_lo:[1,0,0] neg_hi:[1,0,0]
  v_pk_fma_f32 v[214:215], v[38:39], v[182:183], v[214:215] op_sel:[1,0,0] op_sel_hi:[1,1,1] neg_lo:[1,0,0] neg_hi:[1,0,0]
  v_pk_mul_f32 v[192:193], v[192:193], v[40:41] op_sel_hi:[1,0]
  v_pk_mul_f32 v[194:195], v[194:195], v[40:41] op_sel_hi:[1,0]
  v_pk_mul_f32 v[196:197], v[196:197], v[40:41] op_sel_hi:[1,0]
  v_pk_mul_f32 v[198:199], v[198:199], v[40:41] op_sel_hi:[1,0]
  v_pk_mul_f32 v[200:201], v[200:201], v[40:41] op_sel_hi:[1,0]
  v_pk_mul_f32 v[202:203], v[202:203], v[40:41] op_sel_hi:[1,0]
  v_pk_mul_f32 v[204:205], v[204:205], v[40:41] op_sel_hi:[1,0]
  v_pk_mul_f32 v[206:207], v[206:207], v[40:41] op_sel_hi:[1,0]
  v_pk_mul_f32 v[208:209], v[208:209], v[40:41] op_sel_hi:[1,0]
  v_pk_mul_f32 v[210:211], v[210:211], v[40:41] op_sel_hi:[1,0]
  v_pk_mul_f32 v[212:213], v[212:213], v[40:41] op_sel_hi:[1,0]
  v_pk_mul_f32 v[214:215], v[214:215], v[40:41] op_sel_hi:[1,0]
  v_pk_mul_f32 v[216:217], v[192:193], v[192:193]
  v_pk_mul_f32 v[218:219], v[194:195], v[194:195]
  v_pk_mul_f32 v[220:221], v[196:197], v[196:197]
  v_pk_mul_f32 v[222:223], v[198:199], v[198:199]
  v_pk_mul_f32 v[224:225], v[200:201], v[200:201]
  v_pk_mul_f32 v[226:227], v[202:203], v[202:203]
  v_pk_mul_f32 v[228:229], v[204:205], v[204:205]
  v_pk_mul_f32 v[230:231], v[206:207], v[206:207]
  v_pk_mul_f32 v[232:233], v[208:209], v[208:209]
  v_pk_mul_f32 v[234:235], v[210:211], v[210:211]
  v_pk_mul_f32 v[236:237], v[212:213], v[212:213]
  v_pk_mul_f32 v[238:239], v[214:215], v[214:215]
  v_pk_fma_f32 v[216:217], v[216:217], v[28:29], v[28:29] op_sel:[0,1,0] op_sel_hi:[1,1,0]
  v_pk_fma_f32 v[218:219], v[218:219], v[28:29], v[28:29] op_sel:[0,1,0] op_sel_hi:[1,1,0]
  v_pk_fma_f32 v[220:221], v[220:221], v[28:29], v[28:29] op_sel:[0,1,0] op_sel_hi:[1,1,0]
  v_pk_fma_f32 v[222:223], v[222:223], v[28:29], v[28:29] op_sel:[0,1,0] op_sel_hi:[1,1,0]
  v_pk_fma_f32 v[224:225], v[224:225], v[28:29], v[28:29] op_sel:[0,1,0] op_sel_hi:[1,1,0]
  v_pk_fma_f32 v[226:227], v[226:227], v[28:29], v[28:29] op_sel:[0,1,0] op_sel_hi:[1,1,0]
  v_pk_fma_f32 v[228:229], v[228:229], v[28:29], v[28:29] op_sel:[0,1,0] op_sel_hi:[1,1,0]
  v_pk_fma_f32 v[230:231], v[230:231], v[28:29], v[28:29] op_sel:[0,1,0] op_sel_hi:[1,1,0]
  v_pk_fma_f32 v[232:233], v[232:233], v[28:29], v[28:29] op_sel:[0,1,0] op_sel_hi:[1,1,0]
  v_pk_fma_f32 v[234:235], v[234:235], v[28:29], v[28:29] op_sel:[0,1,0] op_sel_hi:[1,1,0]
  v_pk_fma_f32 v[236:237], v[236:237], v[28:29], v[28:29] op_sel:[0,1,0] op_sel_hi:[1,1,0]
  v_pk_fma_f32 v[238:239], v[238:239], v[28:29], v[28:29] op_sel:[0,1,0] op_sel_hi:[1,1,0]
  v_pk_mul_f32 v[216:217], v[216:217], v[192:193]
  v_pk_mul_f32 v[218:219], v[218:219], v[194:195]
  v_pk_mul_f32 v[220:221], v[220:221], v[196:197]
  v_pk_mul_f32 v[222:223], v[222:223], v[198:199]
  v_pk_mul_f32 v[224:225], v[224:225], v[200:201]
  v_pk_mul_f32 v[226:227], v[226:227], v[202:203]
  v_pk_mul_f32 v[228:229], v[228:229], v[204:205]
  v_pk_mul_f32 v[230:231], v[230:231], v[206:207]
  v_pk_mul_f32 v[232:233], v[232:233], v[208:209]
  v_pk_mul_f32 v[234:235], v[234:235], v[210:211]
  v_pk_mul_f32 v[236:237], v[236:237], v[212:213]
  v_pk_mul_f32 v[238:239], v[238:239], v[214:215]
  v_exp_f32 v216, v216
  v_exp_f32 v217, v217
  v_exp_f32 v218, v218
  v_exp_f32 v219, v219
  v_exp_f32 v220, v220
  v_exp_f32 v221, v221
  v_exp_f32 v222, v222
  v_exp_f32 v223, v223
  v_exp_f32 v224, v224
  v_exp_f32 v225, v225
  v_exp_f32 v226, v226
  v_exp_f32 v227, v227
  v_exp_f32 v228, v228
  v_exp_f32 v229, v229
  v_exp_f32 v230, v230
  v_exp_f32 v231, v231
  v_exp_f32 v232, v232
  v_exp_f32 v233, v233
  v_exp_f32 v234, v234
  v_exp_f32 v235, v235
  v_exp_f32 v236, v236
  v_exp_f32 v237, v237
  v_exp_f32 v238, v238
  v_exp_f32 v239, v239
  s_nop 0
  v_pk_add_f32 v[216:217], v[216:217], v[44:45] op_sel_hi:[1,0]
  v_pk_add_f32 v[218:219], v[218:219], v[44:45] op_sel_hi:[1,0]
  v_pk_add_f32 v[220:221], v[220:221], v[44:45] op_sel_hi:[1,0]
  v_pk_add_f32 v[222:223], v[222:223], v[44:45] op_sel_hi:[1,0]
  v_pk_add_f32 v[224:225], v[224:225], v[44:45] op_sel_hi:[1,0]
  v_pk_add_f32 v[226:227], v[226:227], v[44:45] op_sel_hi:[1,0]
  v_pk_add_f32 v[228:229], v[228:229], v[44:45] op_sel_hi:[1,0]
  v_pk_add_f32 v[230:231], v[230:231], v[44:45] op_sel_hi:[1,0]
  v_pk_add_f32 v[232:233], v[232:233], v[44:45] op_sel_hi:[1,0]
  v_pk_add_f32 v[234:235], v[234:235], v[44:45] op_sel_hi:[1,0]
  v_pk_add_f32 v[236:237], v[236:237], v[44:45] op_sel_hi:[1,0]
  v_pk_add_f32 v[238:239], v[238:239], v[44:45] op_sel_hi:[1,0]
  v_rcp_f32 v216, v216
  v_rcp_f32 v217, v217
  v_rcp_f32 v218, v218
  v_rcp_f32 v219, v219
  v_rcp_f32 v220, v220
  v_rcp_f32 v221, v221
  v_rcp_f32 v222, v222
  v_rcp_f32 v223, v223
  v_rcp_f32 v224, v224
  v_rcp_f32 v225, v225
  v_rcp_f32 v226, v226
  v_rcp_f32 v227, v227
  v_rcp_f32 v228, v228
  v_rcp_f32 v229, v229
  v_rcp_f32 v230, v230
  v_rcp_f32 v231, v231
  v_rcp_f32 v232, v232
  v_rcp_f32 v233, v233
  v_rcp_f32 v234, v234
  v_rcp_f32 v235, v235
  v_rcp_f32 v236, v236
  v_rcp_f32 v237, v237
  v_rcp_f32 v238, v238
  v_rcp_f32 v239, v239
  s_nop 0
  v_pk_mul_f32 v[192:193], v[192:193], v[216:217]
  v_pk_mul_f32 v[194:195], v[194:195], v[218:219]
  v_pk_mul_f32 v[196:197], v[196:197], v[220:221]
  v_pk_mul_f32 v[198:199], v[198:199], v[222:223]
  v_pk_mul_f32 v[200:201], v[200:201], v[224:225]
  v_pk_mul_f32 v[202:203], v[202:203], v[226:227]
  v_pk_mul_f32 v[204:205], v[204:205], v[228:229]
  v_pk_mul_f32 v[206:207], v[206:207], v[230:231]
  v_pk_mul_f32 v[208:209], v[208:209], v[232:233]
  v_pk_mul_f32 v[210:211], v[210:211], v[234:235]
  v_pk_mul_f32 v[212:213], v[212:213], v[236:237]
  v_pk_mul_f32 v[214:215], v[214:215], v[238:239]
  v_cvt_pk_bf16_f32 v64, v192, v193
  v_cvt_pk_bf16_f32 v65, v194, v195
  v_cvt_pk_bf16_f32 v66, v196, v197
  v_cvt_pk_bf16_f32 v67, v198, v199
  v_cvt_pk_bf16_f32 v68, v200, v201
  v_cvt_pk_bf16_f32 v69, v202, v203
  v_cvt_pk_bf16_f32 v70, v204, v205
  v_cvt_pk_bf16_f32 v71, v206, v207
  v_cvt_pk_bf16_f32 v72, v208, v209
  v_cvt_pk_bf16_f32 v73, v210, v211
  v_cvt_pk_bf16_f32 v74, v212, v213
  v_cvt_pk_bf16_f32 v75, v214, v215
  s_mul_i32 s34, s32, 88064
  s_mul_i32 s23, s36, 6144
  s_add_u32 s34, s34, s23
  s_lshl_b32 s23, s39, 10
  s_add_u32 s34, s34, s23
  s_lshl_b32 s22, s4, 11
  s_add_u32 s22, s22, s34
  s_mul_i32 s23, s36, 3
  s_add_u32 s23, s23, s4
  s_cmp_ge_u32 s23, 43
  s_cselect_b32 s22, 0x40000000, s22
  buffer_store_dwordx4 v[64:67], v20, s[92:95], s22 offen sc1
  s_lshl_b32 s22, s5, 11
  s_add_u32 s22, s22, s34
  s_mul_i32 s23, s36, 3
  s_add_u32 s23, s23, s5
  s_cmp_ge_u32 s23, 43
  s_cselect_b32 s22, 0x40000000, s22
  buffer_store_dwordx4 v[68:71], v20, s[92:95], s22 offen sc1
  s_lshl_b32 s22, s6, 11
  s_add_u32 s22, s22, s34
  s_mul_i32 s23, s36, 3
  s_add_u32 s23, s23, s6
  s_cmp_ge_u32 s23, 43
  s_cselect_b32 s22, 0x40000000, s22
  buffer_store_dwordx4 v[72:75], v20, s[92:95], s22 offen sc1
  s_cmp_ge_u32 s20, 4
  s_cbranch_scc1 main_kernel_w18
  s_waitcnt vmcnt(7)
main_kernel_w18:
  s_barrier
  s_mov_b32 s31, 0x4e800000
  s_lshl_b32 s30, s44, 1
  s_sub_u32 s30, 32, s30
  v_lshlrev_b32 v10, 2, v22
  v_sub_u32 v7, v21, v10
  v_mov_b32 v8, 0xff800000
  s_cmp_ge_u32 s20, 4
  s_cbranch_scc1 main_kernel_short
  s_mov_b32 s46, 0
  v_mov_b32 v14, v20
  ds_read_b128 v[24:27], v14 offset:0
  ds_read_b128 v[28:31], v14 offset:1024
  ds_read_b128 v[32:35], v14 offset:2048
  ds_read_b128 v[36:39], v14 offset:3072
  ds_read_b128 v[40:43], v14 offset:4096
  ds_read_b128 v[44:47], v14 offset:5120
  ds_read_b128 v[48:51], v14 offset:6144
  ds_read_b128 v[52:55], v14 offset:7168
  v_mov_b32 v3, 0
  s_waitcnt lgkmcnt(7)
  v_mfma_f32_32x32x16_bf16 v[160:175], v[24:27], v[128:131], 0
  v_mov_b32 v56, 0
  v_mov_b32 v57, 0
  v_mov_b32 v58, 0
  v_mov_b32 v59, 0
  v_mov_b32 v60, 0
  v_mov_b32 v61, 0
  v_mov_b32 v62, 0
  v_mov_b32 v63, 0
  s_waitcnt lgkmcnt(6)
  v_mfma_f32_32x32x16_bf16 v[160:175], v[28:31], v[132:135], v[160:175]
  v_mov_b32 v64, 0
  v_mov_b32 v65, 0
  v_mov_b32 v66, 0
  v_mov_b32 v67, 0
  v_mov_b32 v68, 0
  v_mov_b32 v69, 0
  v_mov_b32 v70, 0
  v_mov_b32 v71, 0
  s_waitcnt lgkmcnt(5)
  v_mfma_f32_32x32x16_bf16 v[160:175], v[32:35], v[136:139], v[160:175]
  v_mov_b32 v72, 0
  v_mov_b32 v73, 0
  v_mov_b32 v74, 0
  v_mov_b32 v75, 0
  v_mov_b32 v76, 0
  v_mov_b32 v77, 0
  v_mov_b32 v78, 0
  v_mov_b32 v79, 0
  s_waitcnt lgkmcnt(4)
  v_mfma_f32_32x32x16_bf16 v[160:175], v[36:39], v[140:143], v[160:175]
  v_mov_b32 v80, 0
  v_mov_b32 v81, 0
  v_mov_b32 v82, 0
  v_mov_b32 v83, 0
  v_mov_b32 v84, 0
  v_mov_b32 v85, 0
  v_mov_b32 v86, 0
  v_mov_b32 v87, 0
  s_waitcnt lgkmcnt(3)
  v_mfma_f32_32x32x16_bf16 v[160:175], v[40:43], v[144:147], v[160:175]
  v_mov_b32 v88, 0
  v_mov_b32 v89, 0
  v_mov_b32 v90, 0
  v_mov_b32 v91, 0
  v_mov_b32 v92, 0
  v_mov_b32 v93, 0
  v_mov_b32 v94, 0
  v_mov_b32 v95, 0
  s_waitcnt lgkmcnt(2)
  v_mfma_f32_32x32x16_bf16 v[160:175], v[44:47], v[148:151], v[160:175]
  v_mov_b32 v96, 0
  v_mov_b32 v97, 0
  v_mov_b32 v98, 0
  v_mov_b32 v99, 0
  v_mov_b32 v100, 0
  v_mov_b32 v101, 0
  v_mov_b32 v102, 0
  v_mov_b32 v103, 0
  s_waitcnt lgkmcnt(1)
  v_mfma_f32_32x32x16_bf16 v[160:175], v[48:51], v[152:155], v[160:175]
  v_mov_b32 v104, 0
  v_mov_b32 v105, 0
  v_mov_b32 v106, 0
  v_mov_b32 v107, 0
  v_mov_b32 v108, 0
  v_mov_b32 v109, 0
  v_mov_b32 v110, 0
  v_mov_b32 v111, 0
  s_waitcnt lgkmcnt(0)
  v_mfma_f32_32x32x16_bf16 v[160:175], v[52:55], v[156:159], v[160:175]
  v_mov_b32 v112, 0
  v_mov_b32 v113, 0
  v_mov_b32 v114, 0
  v_mov_b32 v115, 0
  v_mov_b32 v116, 0
  v_mov_b32 v117, 0
  v_mov_b32 v118, 0
  v_mov_b32 v119, 0
  s_load_dwordx2 s[50:51], s[0:1], 40
  s_load_dwordx2 s[52:53], s[0:1], 80
  s_mul_i32 s22, s2, 24576
  s_mul_i32 s23, s20, 6144
  s_add_u32 s22, s22, s23
  s_add_u32 s22, s22, 0x4800000
  s_add_u32 s16, s58, s22
  s_addc_u32 s17, s59, 0
  s_mov_b32 s18, 6144
  s_mov_b32 s19, 0x00020000
  v_mov_b32 v224, -1
  v_mov_b32 v225, -1
  v_mov_b32 v226, -1
  v_mov_b32 v227, -1
  s_mov_b32 s32, 0x0
  s_waitcnt lgkmcnt(0)
  s_lshl_b32 s72, s2, 2
  s_add_u32 s72, s72, s20
  v_lshlrev_b32 v5, 7, v2
  s_mov_b32 s68, s50
  s_mov_b32 s69, s51
  s_mov_b32 s70, 0x400000
  s_mov_b32 s71, 0x00020000
  s_mov_b32 s74, s72
  s_sub_u32 s75, s72, 512
  s_cmp_ge_u32 s72, 512
  s_cselect_b32 s68, s52, s68
  s_cselect_b32 s69, s53, s69
  s_cselect_b32 s70, 0x158000, s70
  s_cselect_b32 s74, s75, s74
  s_lshl_b32 s74, s74, 13
  buffer_load_dword v5, v5, s[68:71], s74 offen
  s_mov_b32 s46, 32768
  s_sub_u32 s61, s40, 1
  ds_read_b128 v[24:27], v14 offset:16384
  ds_read_b128 v[28:31], v14 offset:17408
  ds_read_b128 v[32:35], v14 offset:18432
  ds_read_b128 v[36:39], v14 offset:19456
  ds_read_b128 v[40:43], v14 offset:20480
  ds_read_b128 v[44:47], v14 offset:21504
  ds_read_b128 v[48:51], v14 offset:22528
  s_nop 15
  s_cmp_lg_u32 s40, 0
  s_cbranch_scc1 main_kernel_l_nomask0
  v_cmp_ge_i32 s[64:65], v7, 0
  v_cmp_ge_i32 s[66:67], v7, 1
  v_cmp_ge_i32 s[68:69], v7, 2
  v_cmp_ge_i32 s[70:71], v7, 3
  v_cmp_ge_i32 s[72:73], v7, 8
  v_cmp_ge_i32 s[74:75], v7, 9
  v_cmp_ge_i32 s[76:77], v7, 10
  v_cmp_ge_i32 s[78:79], v7, 11
  v_cmp_ge_i32 s[80:81], v7, 16
  v_cmp_ge_i32 s[82:83], v7, 17
  v_cmp_ge_i32 s[84:85], v7, 18
  v_cmp_ge_i32 s[86:87], v7, 19
  v_cmp_ge_i32 s[88:89], v7, 24
  v_cmp_ge_i32 s[90:91], v7, 25
  v_cmp_ge_i32 s[92:93], v7, 26
  v_cmp_ge_i32 s[94:95], v7, 27
  v_cndmask_b32 v160, v8, v160, s[64:65]
  v_cndmask_b32 v161, v8, v161, s[66:67]
  v_cndmask_b32 v162, v8, v162, s[68:69]
  v_cndmask_b32 v163, v8, v163, s[70:71]
  v_cndmask_b32 v164, v8, v164, s[72:73]
  v_cndmask_b32 v165, v8, v165, s[74:75]
  v_cndmask_b32 v166, v8, v166, s[76:77]
  v_cndmask_b32 v167, v8, v167, s[78:79]
  v_cndmask_b32 v168, v8, v168, s[80:81]
  v_cndmask_b32 v169, v8, v169, s[82:83]
  v_cndmask_b32 v170, v8, v170, s[84:85]
  v_cndmask_b32 v171, v8, v171, s[86:87]
  v_cndmask_b32 v172, v8, v172, s[88:89]
  v_cndmask_b32 v173, v8, v173, s[90:91]
  v_cndmask_b32 v174, v8, v174, s[92:93]
  v_cndmask_b32 v175, v8, v175, s[94:95]
main_kernel_l_nomask0:
  v_max3_f32 v9, v160, v161, v162
  v_max3_f32 v9, v9, v163, v164
  v_max3_f32 v9, v9, v165, v166
  v_max3_f32 v9, v9, v167, v168
  v_max3_f32 v9, v9, v169, v170
  v_max3_f32 v9, v9, v171, v172
  v_max3_f32 v9, v9, v173, v174
  v_max_f32 v9, v9, v175
  v_mov_b32 v12, v9
  s_nop 1
  v_permlane32_swap_b32 v9, v12
  s_nop 1
  v_max_f32 v9, v9, v12
  v_ceil_f32 v9, v9
  v_sub_f32 v160, v160, v9
  v_sub_f32 v161, v161, v9
  v_sub_f32 v162, v162, v9
  v_sub_f32 v163, v163, v9
  v_sub_f32 v164, v164, v9
  v_sub_f32 v165, v165, v9
  v_sub_f32 v166, v166, v9
  v_sub_f32 v167, v167, v9
  v_sub_f32 v168, v168, v9
  v_sub_f32 v169, v169, v9
  v_sub_f32 v170, v170, v9
  v_sub_f32 v171, v171, v9
  v_sub_f32 v172, v172, v9
  v_sub_f32 v173, v173, v9
  v_sub_f32 v174, v174, v9
  v_sub_f32 v175, v175, v9
  v_sub_f32 v208, 0, v9
  v_sub_f32 v209, 0, v9
  v_sub_f32 v210, 0, v9
  v_sub_f32 v211, 0, v9
  v_sub_f32 v212, 0, v9
  v_sub_f32 v213, 0, v9
  v_sub_f32 v214, 0, v9
  v_sub_f32 v215, 0, v9
  v_sub_f32 v216, 0, v9
  v_sub_f32 v217, 0, v9
  v_sub_f32 v218, 0, v9
  v_sub_f32 v219, 0, v9
  v_sub_f32 v220, 0, v9
  v_sub_f32 v221, 0, v9
  v_sub_f32 v222, 0, v9
  v_sub_f32 v223, 0, v9
  s_mov_b32 s28, -1
  s_waitcnt vmcnt(4)
  s_barrier
  s_waitcnt lgkmcnt(5)
  v_mfma_f32_32x32x16_bf16 v[176:191], v[24:27], v[128:131], v[208:223]
  ds_read_b128 v[52:55], v14 offset:23552
  v_add_u32 v14, s46, v20
  v_exp_f32 v120, v160
  v_exp_f32 v121, v161
  v_add_f32 v4, v3, v120
  v_exp_f32 v122, v162
  v_add_f32 v4, v4, v121
  v_mfma_f32_32x32x16_bf16 v[176:191], v[28:31], v[132:135], v[176:191]
  ds_read_b128 v[24:27], v14 offset:0
  v_cvt_pk_bf16_f32 v192, v120, v121
  v_exp_f32 v123, v163
  v_add_f32 v4, v4, v122
  v_exp_f32 v124, v164
  v_add_f32 v4, v4, v123
  v_cvt_pk_bf16_f32 v193, v122, v123
  s_waitcnt lgkmcnt(5)
  v_mfma_f32_32x32x16_bf16 v[176:191], v[32:35], v[136:139], v[176:191]
  ds_read_b128 v[28:31], v14 offset:1024
  s_add_u32 s46, s46, 32768
  s_and_b32 s46, s46, 0x1ffff
  v_exp_f32 v125, v165
  v_add_f32 v4, v4, v124
  v_exp_f32 v126, v166
  v_add_f32 v4, v4, v125
  v_cvt_pk_bf16_f32 v194, v124, v125
  v_mfma_f32_32x32x16_bf16 v[176:191], v[36:39], v[140:143], v[176:191]
  ds_read_b128 v[32:35], v14 offset:2048
  v_exp_f32 v127, v167
  v_add_f32 v4, v4, v126
  v_exp_f32 v120, v168
  v_add_f32 v4, v4, v127
  v_cvt_pk_bf16_f32 v195, v126, v127
  v_exp_f32 v121, v169
  s_waitcnt lgkmcnt(5)
  v_mfma_f32_32x32x16_bf16 v[176:191], v[40:43], v[144:147], v[176:191]
  ds_read_b128 v[36:39], v14 offset:3072
  s_add_u32 s28, s28, 2
  v_add_f32 v4, v4, v120
  v_exp_f32 v122, v170
  v_add_f32 v4, v4, v121
  v_cvt_pk_bf16_f32 v196, v120, v121
  v_exp_f32 v123, v171
  v_mfma_f32_32x32x16_bf16 v[176:191], v[44:47], v[148:151], v[176:191]
  ds_read_b128 v[40:43], v14 offset:4096
  v_add_f32 v4, v4, v122
  v_exp_f32 v124, v172
  v_add_f32 v4, v4, v123
  v_cvt_pk_bf16_f32 v197, v122, v123
  v_exp_f32 v125, v173
  v_add_f32 v4, v4, v124
  s_waitcnt lgkmcnt(5)
  v_mfma_f32_32x32x16_bf16 v[176:191], v[48:51], v[152:155], v[176:191]
  ds_read_b128 v[44:47], v14 offset:5120
  v_exp_f32 v126, v174
  v_add_f32 v4, v4, v125
  v_cvt_pk_bf16_f32 v198, v124, v125
  v_exp_f32 v127, v175
  v_add_f32 v4, v4, v126
  v_add_f32 v4, v4, v127
  v_cvt_pk_bf16_f32 v199, v126, v127
  s_cmp_eq_u32 s28, s40
  v_mfma_f32_32x32x16_bf16 v[176:191], v[52:55], v[156:159], v[176:191]
  ds_read_b128 v[48:51], v14 offset:6144
  s_waitcnt lgkmcnt(5)
  v_mfma_f32_32x32x16_bf16 v[160:175], v[24:27], v[128:131], v[208:223]
  ds_read_b128 v[52:55], v14 offset:7168
  v_exp_f32 v120, v176
  v_exp_f32 v121, v177
  v_mfma_f32_32x32x16_bf16 v[160:175], v[28:31], v[132:135], v[160:175]
  ds_read_b128 v[24:27], v14 offset:24576
  v_add_f32 v3, v4, v120
  v_exp_f32 v122, v178
  v_add_f32 v3, v3, v121
  s_waitcnt lgkmcnt(5)
  v_mfma_f32_32x32x16_bf16 v[160:175], v[32:35], v[136:139], v[160:175]
  ds_read_b128 v[28:31], v14 offset:25600
  v_cvt_pk_bf16_f32 v200, v120, v121
  v_exp_f32 v123, v179
  v_add_f32 v3, v3, v122
  v_mfma_f32_32x32x16_bf16 v[160:175], v[36:39], v[140:143], v[160:175]
  ds_read_b128 v[32:35], v14 offset:26624
  v_exp_f32 v124, v180
  v_add_f32 v3, v3, v123
  s_waitcnt lgkmcnt(5)
  v_mfma_f32_32x32x16_bf16 v[160:175], v[40:43], v[144:147], v[160:175]
  ds_read_b128 v[36:39], v14 offset:27648
  v_cvt_pk_bf16_f32 v201, v122, v123
  v_exp_f32 v125, v181
  v_add_f32 v3, v3, v124
  v_mfma_f32_32x32x16_bf16 v[160:175], v[44:47], v[148:151], v[160:175]
  ds_read_b128 v[40:43], v14 offset:28672
  v_exp_f32 v126, v182
  v_add_f32 v3, v3, v125
  v_cvt_pk_bf16_f32 v202, v124, v125
  s_waitcnt lgkmcnt(5)
  v_mfma_f32_32x32x16_bf16 v[160:175], v[48:51], v[152:155], v[160:175]
  ds_read_b128 v[44:47], v14 offset:29696
  buffer_store_dwordx4 v[224:227], v20, s[16:19], s32 offen offset:0 sc1
  v_exp_f32 v127, v183
  v_add_f32 v3, v3, v126
  v_mfma_f32_32x32x16_bf16 v[160:175], v[52:55], v[156:159], v[160:175]
  ds_read_b128 v[48:51], v14 offset:30720
  v_exp_f32 v120, v184
  v_add_f32 v3, v3, v127
  v_cvt_pk_bf16_f32 v203, v126, v127
  s_waitcnt lgkmcnt(5)
  v_mfma_f32_32x32x16_bf16 v[56:71], v[24:27], v[192:195], v[56:71]
  ds_read_b128 v[52:55], v14 offset:31744
  v_exp_f32 v121, v185
  v_add_f32 v3, v3, v120
  v_exp_f32 v122, v186
  v_mfma_f32_32x32x16_bf16 v[56:71], v[28:31], v[196:199], v[56:71]
  ds_read_b128 v[24:27], v14 offset:16384
  v_add_f32 v3, v3, v121
  v_cvt_pk_bf16_f32 v204, v120, v121
  s_waitcnt lgkmcnt(5)
  v_mfma_f32_32x32x16_bf16 v[72:87], v[32:35], v[192:195], v[72:87]
  ds_read_b128 v[28:31], v14 offset:17408
  v_exp_f32 v123, v187
  v_add_f32 v3, v3, v122
  v_exp_f32 v124, v188
  v_mfma_f32_32x32x16_bf16 v[72:87], v[36:39], v[196:199], v[72:87]
  ds_read_b128 v[32:35], v14 offset:18432
  v_add_f32 v3, v3, v123
  v_cvt_pk_bf16_f32 v205, v122, v123
  v_exp_f32 v125, v189
  s_waitcnt lgkmcnt(5)
  v_mfma_f32_32x32x16_bf16 v[88:103], v[40:43], v[192:195], v[88:103]
  ds_read_b128 v[36:39], v14 offset:19456
  v_add_f32 v3, v3, v124
  v_exp_f32 v126, v190
  v_mfma_f32_32x32x16_bf16 v[88:103], v[44:47], v[196:199], v[88:103]
  ds_read_b128 v[40:43], v14 offset:20480
  v_add_f32 v3, v3, v125
  v_cvt_pk_bf16_f32 v206, v124, v125
  v_exp_f32 v127, v191
  s_waitcnt lgkmcnt(5)
  v_mfma_f32_32x32x16_bf16 v[104:119], v[48:51], v[192:195], v[104:119]
  ds_read_b128 v[44:47], v14 offset:21504
  v_add_f32 v3, v3, v126
  v_add_f32 v3, v3, v127
  v_cvt_pk_bf16_f32 v207, v126, v127
  v_cmp_nge_f32 vcc, s31, v3
  v_mfma_f32_32x32x16_bf16 v[104:119], v[52:55], v[196:199], v[104:119]
  ds_read_b128 v[48:51], v14 offset:22528
  s_cbranch_vccnz main_kernel_rare_13
main_kernel_back_14:
  s_waitcnt lgkmcnt(5)
  v_mfma_f32_32x32x16_bf16 v[176:191], v[24:27], v[128:131], v[208:223]
  ds_read_b128 v[52:55], v14 offset:23552
  v_exp_f32 v120, v160
  v_exp_f32 v121, v161
  s_barrier
  v_add_u32 v14, s46, v20
  v_mfma_f32_32x32x16_bf16 v[176:191], v[28:31], v[132:135], v[176:191]
  ds_read_b128 v[24:27], v14 offset:8192
  v_add_f32 v4, v3, v120
  v_exp_f32 v122, v162
  s_waitcnt lgkmcnt(5)
  v_mfma_f32_32x32x16_bf16 v[176:191], v[32:35], v[136:139], v[176:191]
  ds_read_b128 v[28:31], v14 offset:9216
  s_add_u32 s46, s46, 32768
  s_and_b32 s46, s46, 0x1ffff
  v_add_f32 v4, v4, v121
  v_cvt_pk_bf16_f32 v192, v120, v121
  v_mfma_f32_32x32x16_bf16 v[176:191], v[36:39], v[140:143], v[176:191]
  ds_read_b128 v[32:35], v14 offset:10240
  v_exp_f32 v123, v163
  v_add_f32 v4, v4, v122
  v_exp_f32 v124, v164
  s_waitcnt lgkmcnt(5)
  v_mfma_f32_32x32x16_bf16 v[176:191], v[40:43], v[144:147], v[176:191]
  ds_read_b128 v[36:39], v14 offset:11264
  v_add_f32 v4, v4, v123
  v_cvt_pk_bf16_f32 v193, v122, v123
  v_exp_f32 v125, v165
  v_mfma_f32_32x32x16_bf16 v[176:191], v[44:47], v[148:151], v[176:191]
  ds_read_b128 v[40:43], v14 offset:12288
  v_add_f32 v4, v4, v124
  v_exp_f32 v126, v166
  s_waitcnt lgkmcnt(5)
  v_mfma_f32_32x32x16_bf16 v[176:191], v[48:51], v[152:155], v[176:191]
  ds_read_b128 v[44:47], v14 offset:13312
  buffer_store_dwordx4 v[224:227], v20, s[16:19], s32 offen offset:1024 sc1
  v_add_f32 v4, v4, v125
  v_cvt_pk_bf16_f32 v194, v124, v125
  v_exp_f32 v127, v167
  v_mfma_f32_32x32x16_bf16 v[176:191], v[52:55], v[156:159], v[176:191]
  ds_read_b128 v[48:51], v14 offset:14336
  v_add_f32 v4, v4, v126
  v_exp_f32 v120, v168
  v_add_f32 v4, v4, v127
  s_waitcnt lgkmcnt(5)
  v_mfma_f32_32x32x16_bf16 v[56:71], v[24:27], v[200:203], v[56:71]
  ds_read_b128 v[52:55], v14 offset:15360
  v_cvt_pk_bf16_f32 v195, v126, v127
  v_exp_f32 v121, v169
  v_add_f32 v4, v4, v120
  v_mfma_f32_32x32x16_bf16 v[56:71], v[28:31], v[204:207], v[56:71]
  ds_read_b128 v[24:27], v14 offset:0
  v_exp_f32 v122, v170
  v_add_f32 v4, v4, v121
  v_cvt_pk_bf16_f32 v196, v120, v121
  s_waitcnt lgkmcnt(5)
  v_mfma_f32_32x32x16_bf16 v[72:87], v[32:35], v[200:203], v[72:87]
  ds_read_b128 v[28:31], v14 offset:1024
  v_exp_f32 v123, v171
  v_add_f32 v4, v4, v122
  v_mfma_f32_32x32x16_bf16 v[72:87], v[36:39], v[204:207], v[72:87]
  ds_read_b128 v[32:35], v14 offset:2048
  v_exp_f32 v124, v172
  v_add_f32 v4, v4, v123
  v_cvt_pk_bf16_f32 v197, v122, v123
  s_waitcnt lgkmcnt(5)
  v_mfma_f32_32x32x16_bf16 v[88:103], v[40:43], v[200:203], v[88:103]
  ds_read_b128 v[36:39], v14 offset:3072
  v_exp_f32 v125, v173
  v_add_f32 v4, v4, v124
  v_exp_f32 v126, v174
  v_mfma_f32_32x32x16_bf16 v[88:103], v[44:47], v[204:207], v[88:103]
  ds_read_b128 v[40:43], v14 offset:4096
  v_add_f32 v4, v4, v125
  v_cvt_pk_bf16_f32 v198, v124, v125
  v_exp_f32 v127, v175
  s_waitcnt lgkmcnt(5)
  v_mfma_f32_32x32x16_bf16 v[104:119], v[48:51], v[200:203], v[104:119]
  ds_read_b128 v[44:47], v14 offset:5120
  v_add_f32 v4, v4, v126
  v_add_f32 v4, v4, v127
  v_cvt_pk_bf16_f32 v199, v126, v127
  v_cmp_nge_f32 vcc, s31, v4
  v_mfma_f32_32x32x16_bf16 v[104:119], v[52:55], v[204:207], v[104:119]
  ds_read_b128 v[48:51], v14 offset:6144
  s_cbranch_vccnz main_kernel_rare_15
main_kernel_back_16:
  s_waitcnt lgkmcnt(5)
  v_mfma_f32_32x32x16_bf16 v[160:175], v[24:27], v[128:131], v[208:223]
  ds_read_b128 v[52:55], v14 offset:7168
  v_exp_f32 v120, v176
  v_exp_f32 v121, v177
  v_mfma_f32_32x32x16_bf16 v[160:175], v[28:31], v[132:135], v[160:175]
  ds_read_b128 v[24:27], v14 offset:24576
  v_add_f32 v3, v4, v120
  v_exp_f32 v122, v178
  v_add_f32 v3, v3, v121
  s_waitcnt lgkmcnt(5)
  v_mfma_f32_32x32x16_bf16 v[160:175], v[32:35], v[136:139], v[160:175]
  ds_read_b128 v[28:31], v14 offset:25600
  v_cvt_pk_bf16_f32 v200, v120, v121
  v_exp_f32 v123, v179
  v_add_f32 v3, v3, v122
  v_mfma_f32_32x32x16_bf16 v[160:175], v[36:39], v[140:143], v[160:175]
  ds_read_b128 v[32:35], v14 offset:26624
  v_exp_f32 v124, v180
  v_add_f32 v3, v3, v123
  s_waitcnt lgkmcnt(5)
  v_mfma_f32_32x32x16_bf16 v[160:175], v[40:43], v[144:147], v[160:175]
  ds_read_b128 v[36:39], v14 offset:27648
  v_cvt_pk_bf16_f32 v201, v122, v123
  v_exp_f32 v125, v181
  v_add_f32 v3, v3, v124
  v_mfma_f32_32x32x16_bf16 v[160:175], v[44:47], v[148:151], v[160:175]
  ds_read_b128 v[40:43], v14 offset:28672
  v_exp_f32 v126, v182
  v_add_f32 v3, v3, v125
  v_cvt_pk_bf16_f32 v202, v124, v125
  s_waitcnt lgkmcnt(5)
  v_mfma_f32_32x32x16_bf16 v[160:175], v[48:51], v[152:155], v[160:175]
  ds_read_b128 v[44:47], v14 offset:29696
  buffer_store_dwordx4 v[224:227], v20, s[16:19], s32 offen offset:2048 sc1
  v_exp_f32 v127, v183
  v_add_f32 v3, v3, v126
  v_mfma_f32_32x32x16_bf16 v[160:175], v[52:55], v[156:159], v[160:175]
  ds_read_b128 v[48:51], v14 offset:30720
  v_exp_f32 v120, v184
  v_add_f32 v3, v3, v127
  v_cvt_pk_bf16_f32 v203, v126, v127
  s_waitcnt lgkmcnt(5)
  v_mfma_f32_32x32x16_bf16 v[56:71], v[24:27], v[192:195], v[56:71]
  ds_read_b128 v[52:55], v14 offset:31744
  v_exp_f32 v121, v185
  v_add_f32 v3, v3, v120
  v_exp_f32 v122, v186
  v_mfma_f32_32x32x16_bf16 v[56:71], v[28:31], v[196:199], v[56:71]
  ds_read_b128 v[24:27], v14 offset:16384
  v_add_f32 v3, v3, v121
  v_cvt_pk_bf16_f32 v204, v120, v121
  s_waitcnt lgkmcnt(5)
  v_mfma_f32_32x32x16_bf16 v[72:87], v[32:35], v[192:195], v[72:87]
  ds_read_b128 v[28:31], v14 offset:17408
  v_exp_f32 v123, v187
  v_add_f32 v3, v3, v122
  v_exp_f32 v124, v188
  v_mfma_f32_32x32x16_bf16 v[72:87], v[36:39], v[196:199], v[72:87]
  ds_read_b128 v[32:35], v14 offset:18432
  v_add_f32 v3, v3, v123
  v_cvt_pk_bf16_f32 v205, v122, v123
  v_exp_f32 v125, v189
  s_waitcnt lgkmcnt(5)
  v_mfma_f32_32x32x16_bf16 v[88:103], v[40:43], v[192:195], v[88:103]
  ds_read_b128 v[36:39], v14 offset:19456
  v_add_f32 v3, v3, v124
  v_exp_f32 v126, v190
  v_mfma_f32_32x32x16_bf16 v[88:103], v[44:47], v[196:199], v[88:103]
  ds_read_b128 v[40:43], v14 offset:20480
  v_add_f32 v3, v3, v125
  v_cvt_pk_bf16_f32 v206, v124, v125
  v_exp_f32 v127, v191
  s_waitcnt lgkmcnt(5)
  v_mfma_f32_32x32x16_bf16 v[104:119], v[48:51], v[192:195], v[104:119]
  ds_read_b128 v[44:47], v14 offset:21504
  v_add_f32 v3, v3, v126
  v_add_f32 v3, v3, v127
  v_cvt_pk_bf16_f32 v207, v126, v127
  v_cmp_nge_f32 vcc, s31, v3
  v_mfma_f32_32x32x16_bf16 v[104:119], v[52:55], v[196:199], v[104:119]
  ds_read_b128 v[48:51], v14 offset:22528
  s_cbranch_vccnz main_kernel_rare_17
main_kernel_back_18:
  s_waitcnt lgkmcnt(5)
  v_mfma_f32_32x32x16_bf16 v[176:191], v[24:27], v[128:131], v[208:223]
  ds_read_b128 v[52:55], v14 offset:23552
  v_exp_f32 v120, v160
  v_exp_f32 v121, v161
  s_barrier
  v_add_u32 v14, s46, v20
  v_mfma_f32_32x32x16_bf16 v[176:191], v[28:31], v[132:135], v[176:191]
  ds_read_b128 v[24:27], v14 offset:8192
  v_add_f32 v4, v3, v120
  v_exp_f32 v122, v162
  s_waitcnt lgkmcnt(5)
  v_mfma_f32_32x32x16_bf16 v[176:191], v[32:35], v[136:139], v[176:191]
  ds_read_b128 v[28:31], v14 offset:9216
  s_add_u32 s46, s46, 32768
  s_and_b32 s46, s46, 0x1ffff
  v_add_f32 v4, v4, v121
  v_cvt_pk_bf16_f32 v192, v120, v121
  v_mfma_f32_32x32x16_bf16 v[176:191], v[36:39], v[140:143], v[176:191]
  ds_read_b128 v[32:35], v14 offset:10240
  v_exp_f32 v123, v163
  v_add_f32 v4, v4, v122
  v_exp_f32 v124, v164
  s_waitcnt lgkmcnt(5)
  v_mfma_f32_32x32x16_bf16 v[176:191], v[40:43], v[144:147], v[176:191]
  ds_read_b128 v[36:39], v14 offset:11264
  v_add_f32 v4, v4, v123
  v_cvt_pk_bf16_f32 v193, v122, v123
  v_exp_f32 v125, v165
  v_mfma_f32_32x32x16_bf16 v[176:191], v[44:47], v[148:151], v[176:191]
  ds_read_b128 v[40:43], v14 offset:12288
  v_add_f32 v4, v4, v124
  v_exp_f32 v126, v166
  s_waitcnt lgkmcnt(5)
  v_mfma_f32_32x32x16_bf16 v[176:191], v[48:51], v[152:155], v[176:191]
  ds_read_b128 v[44:47], v14 offset:13312
  buffer_store_dwordx4 v[224:227], v20, s[16:19], s32 offen offset:3072 sc1
  v_add_f32 v4, v4, v125
  v_cvt_pk_bf16_f32 v194, v124, v125
  v_exp_f32 v127, v167
  v_mfma_f32_32x32x16_bf16 v[176:191], v[52:55], v[156:159], v[176:191]
  ds_read_b128 v[48:51], v14 offset:14336
  v_add_f32 v4, v4, v126
  v_exp_f32 v120, v168
  v_add_f32 v4, v4, v127
  s_waitcnt lgkmcnt(5)
  v_mfma_f32_32x32x16_bf16 v[56:71], v[24:27], v[200:203], v[56:71]
  ds_read_b128 v[52:55], v14 offset:15360
  v_cvt_pk_bf16_f32 v195, v126, v127
  v_exp_f32 v121, v169
  v_add_f32 v4, v4, v120
  v_mfma_f32_32x32x16_bf16 v[56:71], v[28:31], v[204:207], v[56:71]
  ds_read_b128 v[24:27], v14 offset:0
  v_exp_f32 v122, v170
  v_add_f32 v4, v4, v121
  v_cvt_pk_bf16_f32 v196, v120, v121
  s_waitcnt lgkmcnt(5)
  v_mfma_f32_32x32x16_bf16 v[72:87], v[32:35], v[200:203], v[72:87]
  ds_read_b128 v[28:31], v14 offset:1024
  v_exp_f32 v123, v171
  v_add_f32 v4, v4, v122
  v_mfma_f32_32x32x16_bf16 v[72:87], v[36:39], v[204:207], v[72:87]
  ds_read_b128 v[32:35], v14 offset:2048
  v_exp_f32 v124, v172
  v_add_f32 v4, v4, v123
  v_cvt_pk_bf16_f32 v197, v122, v123
  s_waitcnt lgkmcnt(5)
  v_mfma_f32_32x32x16_bf16 v[88:103], v[40:43], v[200:203], v[88:103]
  ds_read_b128 v[36:39], v14 offset:3072
  v_exp_f32 v125, v173
  v_add_f32 v4, v4, v124
  v_exp_f32 v126, v174
  v_mfma_f32_32x32x16_bf16 v[88:103], v[44:47], v[204:207], v[88:103]
  ds_read_b128 v[40:43], v14 offset:4096
  v_add_f32 v4, v4, v125
  v_cvt_pk_bf16_f32 v198, v124, v125
  v_exp_f32 v127, v175
  s_waitcnt lgkmcnt(5)
  v_mfma_f32_32x32x16_bf16 v[104:119], v[48:51], v[200:203], v[104:119]
  ds_read_b128 v[44:47], v14 offset:5120
  v_add_f32 v4, v4, v126
  v_add_f32 v4, v4, v127
  v_cvt_pk_bf16_f32 v199, v126, v127
  v_cmp_nge_f32 vcc, s31, v4
  v_mfma_f32_32x32x16_bf16 v[104:119], v[52:55], v[204:207], v[104:119]
  ds_read_b128 v[48:51], v14 offset:6144
  s_cbranch_vccnz main_kernel_rare_19
main_kernel_back_20:
  s_mov_b32 s32, 4096
  s_waitcnt lgkmcnt(5)
  v_mfma_f32_32x32x16_bf16 v[160:175], v[24:27], v[128:131], v[208:223]
  ds_read_b128 v[52:55], v14 offset:7168
  v_exp_f32 v120, v176
  v_exp_f32 v121, v177
  v_mfma_f32_32x32x16_bf16 v[160:175], v[28:31], v[132:135], v[160:175]
  ds_read_b128 v[24:27], v14 offset:24576
  v_add_f32 v3, v4, v120
  v_exp_f32 v122, v178
  v_add_f32 v3, v3, v121
  s_waitcnt lgkmcnt(5)
  v_mfma_f32_32x32x16_bf16 v[160:175], v[32:35], v[136:139], v[160:175]
  ds_read_b128 v[28:31], v14 offset:25600
  v_cvt_pk_bf16_f32 v200, v120, v121
  v_exp_f32 v123, v179
  v_add_f32 v3, v3, v122
  v_mfma_f32_32x32x16_bf16 v[160:175], v[36:39], v[140:143], v[160:175]
  ds_read_b128 v[32:35], v14 offset:26624
  v_exp_f32 v124, v180
  v_add_f32 v3, v3, v123
  s_waitcnt lgkmcnt(5)
  v_mfma_f32_32x32x16_bf16 v[160:175], v[40:43], v[144:147], v[160:175]
  ds_read_b128 v[36:39], v14 offset:27648
  v_cvt_pk_bf16_f32 v201, v122, v123
  v_exp_f32 v125, v181
  v_add_f32 v3, v3, v124
  v_mfma_f32_32x32x16_bf16 v[160:175], v[44:47], v[148:151], v[160:175]
  ds_read_b128 v[40:43], v14 offset:28672
  v_exp_f32 v126, v182
  v_add_f32 v3, v3, v125
  v_cvt_pk_bf16_f32 v202, v124, v125
  s_waitcnt lgkmcnt(5)
  v_mfma_f32_32x32x16_bf16 v[160:175], v[48:51], v[152:155], v[160:175]
  ds_read_b128 v[44:47], v14 offset:29696
  buffer_store_dwordx4 v[224:227], v20, s[16:19], s32 offen offset:0 sc1
  v_exp_f32 v127, v183
  v_add_f32 v3, v3, v126
  v_mfma_f32_32x32x16_bf16 v[160:175], v[52:55], v[156:159], v[160:175]
  ds_read_b128 v[48:51], v14 offset:30720
  v_exp_f32 v120, v184
  v_add_f32 v3, v3, v127
  v_cvt_pk_bf16_f32 v203, v126, v127
  s_waitcnt lgkmcnt(5)
  v_mfma_f32_32x32x16_bf16 v[56:71], v[24:27], v[192:195], v[56:71]
  ds_read_b128 v[52:55], v14 offset:31744
  v_exp_f32 v121, v185
  v_add_f32 v3, v3, v120
  v_exp_f32 v122, v186
  v_mfma_f32_32x32x16_bf16 v[56:71], v[28:31], v[196:199], v[56:71]
  ds_read_b128 v[24:27], v14 offset:16384
  v_add_f32 v3, v3, v121
  v_cvt_pk_bf16_f32 v204, v120, v121
  s_waitcnt lgkmcnt(5)
  v_mfma_f32_32x32x16_bf16 v[72:87], v[32:35], v[192:195], v[72:87]
  ds_read_b128 v[28:31], v14 offset:17408
  v_exp_f32 v123, v187
  v_add_f32 v3, v3, v122
  v_exp_f32 v124, v188
  v_mfma_f32_32x32x16_bf16 v[72:87], v[36:39], v[196:199], v[72:87]
  ds_read_b128 v[32:35], v14 offset:18432
  v_add_f32 v3, v3, v123
  v_cvt_pk_bf16_f32 v205, v122, v123
  v_exp_f32 v125, v189
  s_waitcnt lgkmcnt(5)
  v_mfma_f32_32x32x16_bf16 v[88:103], v[40:43], v[192:195], v[88:103]
  ds_read_b128 v[36:39], v14 offset:19456
  v_add_f32 v3, v3, v124
  v_exp_f32 v126, v190
  v_mfma_f32_32x32x16_bf16 v[88:103], v[44:47], v[196:199], v[88:103]
  ds_read_b128 v[40:43], v14 offset:20480
  v_add_f32 v3, v3, v125
  v_cvt_pk_bf16_f32 v206, v124, v125
  v_exp_f32 v127, v191
  s_waitcnt lgkmcnt(5)
  v_mfma_f32_32x32x16_bf16 v[104:119], v[48:51], v[192:195], v[104:119]
  ds_read_b128 v[44:47], v14 offset:21504
  v_add_f32 v3, v3, v126
  v_add_f32 v3, v3, v127
  v_cvt_pk_bf16_f32 v207, v126, v127
  v_cmp_nge_f32 vcc, s31, v3
  v_mfma_f32_32x32x16_bf16 v[104:119], v[52:55], v[196:199], v[104:119]
  ds_read_b128 v[48:51], v14 offset:22528
  s_cbranch_vccnz main_kernel_rare_21
main_kernel_back_22:
  s_waitcnt lgkmcnt(5)
  v_mfma_f32_32x32x16_bf16 v[176:191], v[24:27], v[128:131], v[208:223]
  ds_read_b128 v[52:55], v14 offset:23552
  v_exp_f32 v120, v160
  v_exp_f32 v121, v161
  s_barrier
  v_add_u32 v14, s46, v20
  v_mfma_f32_32x32x16_bf16 v[176:191], v[28:31], v[132:135], v[176:191]
  ds_read_b128 v[24:27], v14 offset:8192
  v_add_f32 v4, v3, v120
  v_exp_f32 v122, v162
  s_waitcnt lgkmcnt(5)
  v_mfma_f32_32x32x16_bf16 v[176:191], v[32:35], v[136:139], v[176:191]
  ds_read_b128 v[28:31], v14 offset:9216
  s_add_u32 s46, s46, 32768
  s_and_b32 s46, s46, 0x1ffff
  v_add_f32 v4, v4, v121
  v_cvt_pk_bf16_f32 v192, v120, v121
  v_mfma_f32_32x32x16_bf16 v[176:191], v[36:39], v[140:143], v[176:191]
  ds_read_b128 v[32:35], v14 offset:10240
  v_exp_f32 v123, v163
  v_add_f32 v4, v4, v122
  v_exp_f32 v124, v164
  s_waitcnt lgkmcnt(5)
  v_mfma_f32_32x32x16_bf16 v[176:191], v[40:43], v[144:147], v[176:191]
  ds_read_b128 v[36:39], v14 offset:11264
  v_add_f32 v4, v4, v123
  v_cvt_pk_bf16_f32 v193, v122, v123
  v_exp_f32 v125, v165
  v_mfma_f32_32x32x16_bf16 v[176:191], v[44:47], v[148:151], v[176:191]
  ds_read_b128 v[40:43], v14 offset:12288
  v_add_f32 v4, v4, v124
  v_exp_f32 v126, v166
  s_waitcnt lgkmcnt(5)
  v_mfma_f32_32x32x16_bf16 v[176:191], v[48:51], v[152:155], v[176:191]
  ds_read_b128 v[44:47], v14 offset:13312
  buffer_store_dwordx4 v[224:227], v20, s[16:19], s32 offen offset:1024 sc1
  v_add_f32 v4, v4, v125
  v_cvt_pk_bf16_f32 v194, v124, v125
  v_exp_f32 v127, v167
  v_mfma_f32_32x32x16_bf16 v[176:191], v[52:55], v[156:159], v[176:191]
  ds_read_b128 v[48:51], v14 offset:14336
  v_add_f32 v4, v4, v126
  v_exp_f32 v120, v168
  v_add_f32 v4, v4, v127
  s_waitcnt lgkmcnt(5)
  v_mfma_f32_32x32x16_bf16 v[56:71], v[24:27], v[200:203], v[56:71]
  ds_read_b128 v[52:55], v14 offset:15360
  v_cvt_pk_bf16_f32 v195, v126, v127
  v_exp_f32 v121, v169
  v_add_f32 v4, v4, v120
  v_mfma_f32_32x32x16_bf16 v[56:71], v[28:31], v[204:207], v[56:71]
  ds_read_b128 v[24:27], v14 offset:0
  v_exp_f32 v122, v170
  v_add_f32 v4, v4, v121
  v_cvt_pk_bf16_f32 v196, v120, v121
  s_waitcnt lgkmcnt(5)
  v_mfma_f32_32x32x16_bf16 v[72:87], v[32:35], v[200:203], v[72:87]
  ds_read_b128 v[28:31], v14 offset:1024
  v_exp_f32 v123, v171
  v_add_f32 v4, v4, v122
  v_mfma_f32_32x32x16_bf16 v[72:87], v[36:39], v[204:207], v[72:87]
  ds_read_b128 v[32:35], v14 offset:2048
  v_exp_f32 v124, v172
  v_add_f32 v4, v4, v123
  v_cvt_pk_bf16_f32 v197, v122, v123
  s_waitcnt lgkmcnt(5)
  v_mfma_f32_32x32x16_bf16 v[88:103], v[40:43], v[200:203], v[88:103]
  ds_read_b128 v[36:39], v14 offset:3072
  v_exp_f32 v125, v173
  v_add_f32 v4, v4, v124
  v_exp_f32 v126, v174
  v_mfma_f32_32x32x16_bf16 v[88:103], v[44:47], v[204:207], v[88:103]
  ds_read_b128 v[40:43], v14 offset:4096
  v_add_f32 v4, v4, v125
  v_cvt_pk_bf16_f32 v198, v124, v125
  v_exp_f32 v127, v175
  s_waitcnt lgkmcnt(5)
  v_mfma_f32_32x32x16_bf16 v[104:119], v[48:51], v[200:203], v[104:119]
  ds_read_b128 v[44:47], v14 offset:5120
  v_add_f32 v4, v4, v126
  v_add_f32 v4, v4, v127
  v_cvt_pk_bf16_f32 v199, v126, v127
  v_cmp_nge_f32 vcc, s31, v4
  v_mfma_f32_32x32x16_bf16 v[104:119], v[52:55], v[204:207], v[104:119]
  ds_read_b128 v[48:51], v14 offset:6144
  s_cbranch_vccnz main_kernel_rare_23
main_kernel_back_24:
  s_add_u32 s28, s28, 6
  s_branch main_kernel_l_odd
  .p2align 6
main_kernel_l_loop:
  s_waitcnt lgkmcnt(5)
  v_mfma_f32_32x32x16_bf16 v[176:191], v[24:27], v[128:131], v[208:223]
  ds_read_b128 v[52:55], v14 offset:23552
  v_exp_f32 v120, v160
  v_exp_f32 v121, v161
  s_barrier
  v_add_u32 v14, s46, v20
  v_mfma_f32_32x32x16_bf16 v[176:191], v[28:31], v[132:135], v[176:191]
  ds_read_b128 v[24:27], v14 offset:8192
  v_add_f32 v4, v3, v120
  v_exp_f32 v122, v162
  s_waitcnt lgkmcnt(5)
  v_mfma_f32_32x32x16_bf16 v[176:191], v[32:35], v[136:139], v[176:191]
  ds_read_b128 v[28:31], v14 offset:9216
  s_add_u32 s46, s46, 32768
  s_and_b32 s46, s46, 0x1ffff
  v_add_f32 v4, v4, v121
  v_cvt_pk_bf16_f32 v192, v120, v121
  v_mfma_f32_32x32x16_bf16 v[176:191], v[36:39], v[140:143], v[176:191]
  ds_read_b128 v[32:35], v14 offset:10240
  v_exp_f32 v123, v163
  v_add_f32 v4, v4, v122
  v_exp_f32 v124, v164
  s_waitcnt lgkmcnt(5)
  v_mfma_f32_32x32x16_bf16 v[176:191], v[40:43], v[144:147], v[176:191]
  ds_read_b128 v[36:39], v14 offset:11264
  s_add_u32 s28, s28, 2
  v_add_f32 v4, v4, v123
  v_cvt_pk_bf16_f32 v193, v122, v123
  v_exp_f32 v125, v165
  v_mfma_f32_32x32x16_bf16 v[176:191], v[44:47], v[148:151], v[176:191]
  ds_read_b128 v[40:43], v14 offset:12288
  v_add_f32 v4, v4, v124
  v_exp_f32 v126, v166
  s_waitcnt lgkmcnt(5)
  v_mfma_f32_32x32x16_bf16 v[176:191], v[48:51], v[152:155], v[176:191]
  ds_read_b128 v[44:47], v14 offset:13312
  v_add_f32 v4, v4, v125
  v_cvt_pk_bf16_f32 v194, v124, v125
  v_exp_f32 v127, v167
  v_mfma_f32_32x32x16_bf16 v[176:191], v[52:55], v[156:159], v[176:191]
  ds_read_b128 v[48:51], v14 offset:14336
  v_add_f32 v4, v4, v126
  v_exp_f32 v120, v168
  v_add_f32 v4, v4, v127
  s_waitcnt lgkmcnt(5)
  v_mfma_f32_32x32x16_bf16 v[56:71], v[24:27], v[200:203], v[56:71]
  ds_read_b128 v[52:55], v14 offset:15360
  v_cvt_pk_bf16_f32 v195, v126, v127
  v_exp_f32 v121, v169
  v_add_f32 v4, v4, v120
  v_mfma_f32_32x32x16_bf16 v[56:71], v[28:31], v[204:207], v[56:71]
  ds_read_b128 v[24:27], v14 offset:0
  v_exp_f32 v122, v170
  v_add_f32 v4, v4, v121
  v_cvt_pk_bf16_f32 v196, v120, v121
  s_waitcnt lgkmcnt(5)
  v_mfma_f32_32x32x16_bf16 v[72:87], v[32:35], v[200:203], v[72:87]
  ds_read_b128 v[28:31], v14 offset:1024
  v_exp_f32 v123, v171
  v_add_f32 v4, v4, v122
  v_exp_f32 v124, v172
  v_mfma_f32_32x32x16_bf16 v[72:87], v[36:39], v[204:207], v[72:87]
  ds_read_b128 v[32:35], v14 offset:2048
  v_add_f32 v4, v4, v123
  v_cvt_pk_bf16_f32 v197, v122, v123
  v_exp_f32 v125, v173
  s_waitcnt lgkmcnt(5)
  v_mfma_f32_32x32x16_bf16 v[88:103], v[40:43], v[200:203], v[88:103]
  ds_read_b128 v[36:39], v14 offset:3072
  v_add_f32 v4, v4, v124
  v_exp_f32 v126, v174
  v_add_f32 v4, v4, v125
  v_mfma_f32_32x32x16_bf16 v[88:103], v[44:47], v[204:207], v[88:103]
  ds_read_b128 v[40:43], v14 offset:4096
  v_cvt_pk_bf16_f32 v198, v124, v125
  v_exp_f32 v127, v175
  s_waitcnt lgkmcnt(5)
  v_mfma_f32_32x32x16_bf16 v[104:119], v[48:51], v[200:203], v[104:119]
  ds_read_b128 v[44:47], v14 offset:5120
  v_add_f32 v4, v4, v126
  v_add_f32 v4, v4, v127
  v_cvt_pk_bf16_f32 v199, v126, v127
  v_cmp_nge_f32 vcc, s31, v4
  s_cmp_eq_u32 s28, s40
  v_mfma_f32_32x32x16_bf16 v[104:119], v[52:55], v[204:207], v[104:119]
  ds_read_b128 v[48:51], v14 offset:6144
  s_cbranch_vccnz main_kernel_rare_25
main_kernel_back_26:
  s_cbranch_scc1 main_kernel_l_fin1
main_kernel_l_odd:
  s_waitcnt lgkmcnt(5)
  v_mfma_f32_32x32x16_bf16 v[160:175], v[24:27], v[128:131], v[208:223]
  ds_read_b128 v[52:55], v14 offset:7168
  v_exp_f32 v120, v176
  v_exp_f32 v121, v177
  v_mfma_f32_32x32x16_bf16 v[160:175], v[28:31], v[132:135], v[160:175]
  ds_read_b128 v[24:27], v14 offset:24576
  v_add_f32 v3, v4, v120
  v_exp_f32 v122, v178
  v_add_f32 v3, v3, v121
  s_waitcnt lgkmcnt(5)
  v_mfma_f32_32x32x16_bf16 v[160:175], v[32:35], v[136:139], v[160:175]
  ds_read_b128 v[28:31], v14 offset:25600
  v_cvt_pk_bf16_f32 v200, v120, v121
  v_exp_f32 v123, v179
  v_add_f32 v3, v3, v122
  v_mfma_f32_32x32x16_bf16 v[160:175], v[36:39], v[140:143], v[160:175]
  ds_read_b128 v[32:35], v14 offset:26624
  v_exp_f32 v124, v180
  v_add_f32 v3, v3, v123
  s_waitcnt lgkmcnt(5)
  v_mfma_f32_32x32x16_bf16 v[160:175], v[40:43], v[144:147], v[160:175]
  ds_read_b128 v[36:39], v14 offset:27648
  v_cvt_pk_bf16_f32 v201, v122, v123
  v_exp_f32 v125, v181
  v_add_f32 v3, v3, v124
  v_mfma_f32_32x32x16_bf16 v[160:175], v[44:47], v[148:151], v[160:175]
  ds_read_b128 v[40:43], v14 offset:28672
  v_exp_f32 v126, v182
  v_add_f32 v3, v3, v125
  v_cvt_pk_bf16_f32 v202, v124, v125
  s_waitcnt lgkmcnt(5)
  v_mfma_f32_32x32x16_bf16 v[160:175], v[48:51], v[152:155], v[160:175]
  ds_read_b128 v[44:47], v14 offset:29696
  v_exp_f32 v127, v183
  v_add_f32 v3, v3, v126
  v_exp_f32 v120, v184
  v_mfma_f32_32x32x16_bf16 v[160:175], v[52:55], v[156:159], v[160:175]
  ds_read_b128 v[48:51], v14 offset:30720
  v_add_f32 v3, v3, v127
  v_cvt_pk_bf16_f32 v203, v126, v127
  s_waitcnt lgkmcnt(5)
  v_mfma_f32_32x32x16_bf16 v[56:71], v[24:27], v[192:195], v[56:71]
  ds_read_b128 v[52:55], v14 offset:31744
  v_exp_f32 v121, v185
  v_add_f32 v3, v3, v120
  v_exp_f32 v122, v186
  v_mfma_f32_32x32x16_bf16 v[56:71], v[28:31], v[196:199], v[56:71]
  ds_read_b128 v[24:27], v14 offset:16384
  v_add_f32 v3, v3, v121
  v_cvt_pk_bf16_f32 v204, v120, v121
  v_exp_f32 v123, v187
  s_waitcnt lgkmcnt(5)
  v_mfma_f32_32x32x16_bf16 v[72:87], v[32:35], v[192:195], v[72:87]
  ds_read_b128 v[28:31], v14 offset:17408
  v_add_f32 v3, v3, v122
  v_exp_f32 v124, v188
  v_add_f32 v3, v3, v123
  v_mfma_f32_32x32x16_bf16 v[72:87], v[36:39], v[196:199], v[72:87]
  ds_read_b128 v[32:35], v14 offset:18432
  v_cvt_pk_bf16_f32 v205, v122, v123
  v_exp_f32 v125, v189
  s_waitcnt lgkmcnt(5)
  v_mfma_f32_32x32x16_bf16 v[88:103], v[40:43], v[192:195], v[88:103]
  ds_read_b128 v[36:39], v14 offset:19456
  v_add_f32 v3, v3, v124
  v_exp_f32 v126, v190
  v_add_f32 v3, v3, v125
  v_mfma_f32_32x32x16_bf16 v[88:103], v[44:47], v[196:199], v[88:103]
  ds_read_b128 v[40:43], v14 offset:20480
  v_cvt_pk_bf16_f32 v206, v124, v125
  v_exp_f32 v127, v191
  v_add_f32 v3, v3, v126
  s_waitcnt lgkmcnt(5)
  v_mfma_f32_32x32x16_bf16 v[104:119], v[48:51], v[192:195], v[104:119]
  ds_read_b128 v[44:47], v14 offset:21504
  v_add_f32 v3, v3, v127
  v_cvt_pk_bf16_f32 v207, v126, v127
  v_cmp_nge_f32 vcc, s31, v3
  s_cmp_eq_u32 s28, s61
  v_mfma_f32_32x32x16_bf16 v[104:119], v[52:55], v[196:199], v[104:119]
  ds_read_b128 v[48:51], v14 offset:22528
  s_cbranch_vccnz main_kernel_rare_27
main_kernel_back_28:
  s_cbranch_scc0 main_kernel_l_loop
  s_barrier
  v_add_u32 v14, s46, v20
  ds_read_b128 v[24:27], v14 offset:8192
  ds_read_b128 v[28:31], v14 offset:9216
  ds_read_b128 v[32:35], v14 offset:10240
  ds_read_b128 v[36:39], v14 offset:11264
  ds_read_b128 v[40:43], v14 offset:12288
  ds_read_b128 v[44:47], v14 offset:13312
  ds_read_b128 v[48:51], v14 offset:14336
  ds_read_b128 v[52:55], v14 offset:15360
  s_add_u32 s46, s46, 32768
  s_and_b32 s46, s46, 0x1ffff
  v_cmp_ge_i32 s[64:65], v7, 0
  v_cmp_ge_i32 s[66:67], v7, 1
  v_cmp_ge_i32 s[68:69], v7, 2
  v_cmp_ge_i32 s[70:71], v7, 3
  v_cmp_ge_i32 s[72:73], v7, 8
  v_cmp_ge_i32 s[74:75], v7, 9
  v_cmp_ge_i32 s[76:77], v7, 10
  v_cmp_ge_i32 s[78:79], v7, 11
  v_cmp_ge_i32 s[80:81], v7, 16
  v_cmp_ge_i32 s[82:83], v7, 17
  v_cmp_ge_i32 s[84:85], v7, 18
  v_cmp_ge_i32 s[86:87], v7, 19
  v_cmp_ge_i32 s[88:89], v7, 24
  v_cmp_ge_i32 s[90:91], v7, 25
  v_cmp_ge_i32 s[92:93], v7, 26
  v_cmp_ge_i32 s[94:95], v7, 27
  v_cndmask_b32 v160, v8, v160, s[64:65]
  v_cndmask_b32 v161, v8, v161, s[66:67]
  v_cndmask_b32 v162, v8, v162, s[68:69]
  v_cndmask_b32 v163, v8, v163, s[70:71]
  s_waitcnt lgkmcnt(7)
  v_mfma_f32_32x32x16_bf16 v[56:71], v[24:27], v[200:203], v[56:71]
  v_cndmask_b32 v164, v8, v164, s[72:73]
  v_cndmask_b32 v165, v8, v165, s[74:75]
  v_cndmask_b32 v166, v8, v166, s[76:77]
  v_cndmask_b32 v167, v8, v167, s[78:79]
  v_cndmask_b32 v168, v8, v168, s[80:81]
  v_cndmask_b32 v169, v8, v169, s[82:83]
  v_cndmask_b32 v170, v8, v170, s[84:85]
  v_cndmask_b32 v171, v8, v171, s[86:87]
  v_cndmask_b32 v172, v8, v172, s[88:89]
  s_waitcnt lgkmcnt(6)
  v_mfma_f32_32x32x16_bf16 v[56:71], v[28:31], v[204:207], v[56:71]
  v_cndmask_b32 v173, v8, v173, s[90:91]
  v_cndmask_b32 v174, v8, v174, s[92:93]
  v_cndmask_b32 v175, v8, v175, s[94:95]
  v_exp_f32 v120, v160
  v_exp_f32 v121, v161
  v_add_f32 v4, v3, v120
  v_exp_f32 v122, v162
  s_waitcnt lgkmcnt(5)
  v_mfma_f32_32x32x16_bf16 v[72:87], v[32:35], v[200:203], v[72:87]
  v_add_f32 v4, v4, v121
  v_cvt_pk_bf16_f32 v192, v120, v121
  v_exp_f32 v123, v163
  v_add_f32 v4, v4, v122
  v_exp_f32 v124, v164
  s_waitcnt lgkmcnt(4)
  v_mfma_f32_32x32x16_bf16 v[72:87], v[36:39], v[204:207], v[72:87]
  v_add_f32 v4, v4, v123
  v_cvt_pk_bf16_f32 v193, v122, v123
  v_exp_f32 v125, v165
  v_add_f32 v4, v4, v124
  v_exp_f32 v126, v166
  v_add_f32 v4, v4, v125
  v_cvt_pk_bf16_f32 v194, v124, v125
  s_waitcnt lgkmcnt(3)
  v_mfma_f32_32x32x16_bf16 v[88:103], v[40:43], v[200:203], v[88:103]
  v_exp_f32 v127, v167
  v_add_f32 v4, v4, v126
  v_exp_f32 v120, v168
  v_add_f32 v4, v4, v127
  v_cvt_pk_bf16_f32 v195, v126, v127
  v_exp_f32 v121, v169
  s_waitcnt lgkmcnt(2)
  v_mfma_f32_32x32x16_bf16 v[88:103], v[44:47], v[204:207], v[88:103]
  v_add_f32 v4, v4, v120
  v_exp_f32 v122, v170
  v_add_f32 v4, v4, v121
  v_cvt_pk_bf16_f32 v196, v120, v121
  v_exp_f32 v123, v171
  v_add_f32 v4, v4, v122
  s_waitcnt lgkmcnt(1)
  v_mfma_f32_32x32x16_bf16 v[104:119], v[48:51], v[200:203], v[104:119]
  v_exp_f32 v124, v172
  v_add_f32 v4, v4, v123
  v_cvt_pk_bf16_f32 v197, v122, v123
  v_exp_f32 v125, v173
  v_add_f32 v4, v4, v124
  v_exp_f32 v126, v174
  s_waitcnt lgkmcnt(0)
  v_mfma_f32_32x32x16_bf16 v[104:119], v[52:55], v[204:207], v[104:119]
  v_add_f32 v4, v4, v125
  v_cvt_pk_bf16_f32 v198, v124, v125
  v_exp_f32 v127, v175
  v_add_f32 v4, v4, v126
  s_nop 0
  v_add_f32 v4, v4, v127
  v_cvt_pk_bf16_f32 v199, v126, v127
  v_cmp_nge_f32 vcc, s31, v4
  s_cbranch_vccnz main_kernel_rare_29
main_kernel_back_30:
main_kernel_l_t0:
  ds_read_b128 v[24:27], v14 offset:24576
  ds_read_b128 v[28:31], v14 offset:25600
  ds_read_b128 v[32:35], v14 offset:26624
  ds_read_b128 v[36:39], v14 offset:27648
  ds_read_b128 v[40:43], v14 offset:28672
  ds_read_b128 v[44:47], v14 offset:29696
  ds_read_b128 v[48:51], v14 offset:30720
  ds_read_b128 v[52:55], v14 offset:31744
  s_waitcnt lgkmcnt(7)
  v_mfma_f32_32x32x16_bf16 v[56:71], v[24:27], v[192:195], v[56:71]
  s_waitcnt lgkmcnt(6)
  v_mfma_f32_32x32x16_bf16 v[56:71], v[28:31], v[196:199], v[56:71]
  s_waitcnt lgkmcnt(5)
  v_mfma_f32_32x32x16_bf16 v[72:87], v[32:35], v[192:195], v[72:87]
  s_waitcnt lgkmcnt(4)
  v_mfma_f32_32x32x16_bf16 v[72:87], v[36:39], v[196:199], v[72:87]
  s_waitcnt lgkmcnt(3)
  v_mfma_f32_32x32x16_bf16 v[88:103], v[40:43], v[192:195], v[88:103]
  s_waitcnt lgkmcnt(2)
  v_mfma_f32_32x32x16_bf16 v[88:103], v[44:47], v[196:199], v[88:103]
  s_waitcnt lgkmcnt(1)
  v_mfma_f32_32x32x16_bf16 v[104:119], v[48:51], v[192:195], v[104:119]
  s_waitcnt lgkmcnt(0)
  v_mfma_f32_32x32x16_bf16 v[104:119], v[52:55], v[196:199], v[104:119]
  s_branch main_kernel_l_fin
main_kernel_l_fin1:
  ds_read_b128 v[24:27], v14 offset:24576
  ds_read_b128 v[28:31], v14 offset:25600
  ds_read_b128 v[32:35], v14 offset:26624
  ds_read_b128 v[36:39], v14 offset:27648
  ds_read_b128 v[40:43], v14 offset:28672
  ds_read_b128 v[44:47], v14 offset:29696
  ds_read_b128 v[48:51], v14 offset:30720
  ds_read_b128 v[52:55], v14 offset:31744
  v_cmp_ge_i32 s[64:65], v7, 0
  v_cmp_ge_i32 s[66:67], v7, 1
  v_cmp_ge_i32 s[68:69], v7, 2
  v_cmp_ge_i32 s[70:71], v7, 3
  v_cmp_ge_i32 s[72:73], v7, 8
  v_cmp_ge_i32 s[74:75], v7, 9
  v_cmp_ge_i32 s[76:77], v7, 10
  v_cmp_ge_i32 s[78:79], v7, 11
  v_cmp_ge_i32 s[80:81], v7, 16
  v_cmp_ge_i32 s[82:83], v7, 17
  v_cmp_ge_i32 s[84:85], v7, 18
  v_cmp_ge_i32 s[86:87], v7, 19
  v_cmp_ge_i32 s[88:89], v7, 24
  v_cmp_ge_i32 s[90:91], v7, 25
  v_cmp_ge_i32 s[92:93], v7, 26
  v_cmp_ge_i32 s[94:95], v7, 27
  v_cndmask_b32 v176, v8, v176, s[64:65]
  v_cndmask_b32 v177, v8, v177, s[66:67]
  v_cndmask_b32 v178, v8, v178, s[68:69]
  v_cndmask_b32 v179, v8, v179, s[70:71]
  s_waitcnt lgkmcnt(7)
  v_mfma_f32_32x32x16_bf16 v[56:71], v[24:27], v[192:195], v[56:71]
  v_cndmask_b32 v180, v8, v180, s[72:73]
  v_cndmask_b32 v181, v8, v181, s[74:75]
  v_cndmask_b32 v182, v8, v182, s[76:77]
  v_cndmask_b32 v183, v8, v183, s[78:79]
  v_cndmask_b32 v184, v8, v184, s[80:81]
  v_cndmask_b32 v185, v8, v185, s[82:83]
  v_cndmask_b32 v186, v8, v186, s[84:85]
  v_cndmask_b32 v187, v8, v187, s[86:87]
  v_cndmask_b32 v188, v8, v188, s[88:89]
  s_waitcnt lgkmcnt(6)
  v_mfma_f32_32x32x16_bf16 v[56:71], v[28:31], v[196:199], v[56:71]
  v_cndmask_b32 v189, v8, v189, s[90:91]
  v_cndmask_b32 v190, v8, v190, s[92:93]
  v_cndmask_b32 v191, v8, v191, s[94:95]
  v_exp_f32 v120, v176
  v_exp_f32 v121, v177
  v_add_f32 v3, v4, v120
  v_exp_f32 v122, v178
  s_waitcnt lgkmcnt(5)
  v_mfma_f32_32x32x16_bf16 v[72:87], v[32:35], v[192:195], v[72:87]
  v_add_f32 v3, v3, v121
  v_cvt_pk_bf16_f32 v200, v120, v121
  v_exp_f32 v123, v179
  v_add_f32 v3, v3, v122
  v_exp_f32 v124, v180
  s_waitcnt lgkmcnt(4)
  v_mfma_f32_32x32x16_bf16 v[72:87], v[36:39], v[196:199], v[72:87]
  v_add_f32 v3, v3, v123
  v_cvt_pk_bf16_f32 v201, v122, v123
  v_exp_f32 v125, v181
  v_add_f32 v3, v3, v124
  v_exp_f32 v126, v182
  v_add_f32 v3, v3, v125
  v_cvt_pk_bf16_f32 v202, v124, v125
  s_waitcnt lgkmcnt(3)
  v_mfma_f32_32x32x16_bf16 v[88:103], v[40:43], v[192:195], v[88:103]
  v_exp_f32 v127, v183
  v_add_f32 v3, v3, v126
  v_exp_f32 v120, v184
  v_add_f32 v3, v3, v127
  v_cvt_pk_bf16_f32 v203, v126, v127
  v_exp_f32 v121, v185
  s_waitcnt lgkmcnt(2)
  v_mfma_f32_32x32x16_bf16 v[88:103], v[44:47], v[196:199], v[88:103]
  v_add_f32 v3, v3, v120
  v_exp_f32 v122, v186
  v_add_f32 v3, v3, v121
  v_cvt_pk_bf16_f32 v204, v120, v121
  v_exp_f32 v123, v187
  v_add_f32 v3, v3, v122
  s_waitcnt lgkmcnt(1)
  v_mfma_f32_32x32x16_bf16 v[104:119], v[48:51], v[192:195], v[104:119]
  v_exp_f32 v124, v188
  v_add_f32 v3, v3, v123
  v_cvt_pk_bf16_f32 v205, v122, v123
  v_exp_f32 v125, v189
  v_add_f32 v3, v3, v124
  v_exp_f32 v126, v190
  s_waitcnt lgkmcnt(0)
  v_mfma_f32_32x32x16_bf16 v[104:119], v[52:55], v[196:199], v[104:119]
  v_add_f32 v3, v3, v125
  v_cvt_pk_bf16_f32 v206, v124, v125
  v_exp_f32 v127, v191
  v_add_f32 v3, v3, v126
  s_nop 0
  v_add_f32 v3, v3, v127
  v_cvt_pk_bf16_f32 v207, v126, v127
  v_cmp_nge_f32 vcc, s31, v3
  s_cbranch_vccnz main_kernel_rare_31
main_kernel_back_32:
  s_barrier
  v_mov_b32 v4, v3
  v_add_u32 v14, s46, v20
  ds_read_b128 v[24:27], v14 offset:8192
  ds_read_b128 v[28:31], v14 offset:9216
  ds_read_b128 v[32:35], v14 offset:10240
  ds_read_b128 v[36:39], v14 offset:11264
  ds_read_b128 v[40:43], v14 offset:12288
  ds_read_b128 v[44:47], v14 offset:13312
  ds_read_b128 v[48:51], v14 offset:14336
  ds_read_b128 v[52:55], v14 offset:15360
  s_waitcnt lgkmcnt(7)
  v_mfma_f32_32x32x16_bf16 v[56:71], v[24:27], v[200:203], v[56:71]
  s_waitcnt lgkmcnt(6)
  v_mfma_f32_32x32x16_bf16 v[56:71], v[28:31], v[204:207], v[56:71]
  s_waitcnt lgkmcnt(5)
  v_mfma_f32_32x32x16_bf16 v[72:87], v[32:35], v[200:203], v[72:87]
  s_waitcnt lgkmcnt(4)
  v_mfma_f32_32x32x16_bf16 v[72:87], v[36:39], v[204:207], v[72:87]
  s_waitcnt lgkmcnt(3)
  v_mfma_f32_32x32x16_bf16 v[88:103], v[40:43], v[200:203], v[88:103]
  s_waitcnt lgkmcnt(2)
  v_mfma_f32_32x32x16_bf16 v[88:103], v[44:47], v[204:207], v[88:103]
  s_waitcnt lgkmcnt(1)
  v_mfma_f32_32x32x16_bf16 v[104:119], v[48:51], v[200:203], v[104:119]
  s_waitcnt lgkmcnt(0)
  v_mfma_f32_32x32x16_bf16 v[104:119], v[52:55], v[204:207], v[104:119]
main_kernel_l_fin:
  s_add_u32 s29, s40, 3
  s_lshr_b32 s29, s29, 1
  s_cmp_gt_u32 s29, s30
  s_cbranch_scc1 main_kernel_l_ep0
  s_barrier
  s_add_u32 s29, s29, 1
main_kernel_l_ep0:
  v_mov_b32 v9, v4
  s_nop 1
  v_permlane32_swap_b32 v4, v9
  s_nop 1
  v_add_f32 v4, v4, v9
  v_rcp_f32 v4, v4
  s_lshl_b32 s22, s40, 5
  s_add_u32 s22, s22, s43
  s_lshl_b32 s22, s22, 13
  s_add_u32 s23, s22, 4096
  s_nop 15
  v_mul_f32 v56, v56, v4
  v_mul_f32 v57, v57, v4
  v_mul_f32 v58, v58, v4
  v_mul_f32 v59, v59, v4
  v_mul_f32 v60, v60, v4
  v_mul_f32 v61, v61, v4
  v_mul_f32 v62, v62, v4
  v_mul_f32 v63, v63, v4
  v_cvt_pk_bf16_f32 v24, v56, v57
  v_cvt_pk_bf16_f32 v25, v58, v59
  v_cvt_pk_bf16_f32 v26, v60, v61
  v_cvt_pk_bf16_f32 v27, v62, v63
  buffer_store_dwordx4 v[24:27], v20, s[12:15], s22 offen sc1
  v_mul_f32 v64, v64, v4
  v_mul_f32 v65, v65, v4
  v_mul_f32 v66, v66, v4
  v_mul_f32 v67, v67, v4
  v_mul_f32 v68, v68, v4
  v_mul_f32 v69, v69, v4
  v_mul_f32 v70, v70, v4
  v_mul_f32 v71, v71, v4
  v_cvt_pk_bf16_f32 v28, v64, v65
  v_cvt_pk_bf16_f32 v29, v66, v67
  v_cvt_pk_bf16_f32 v30, v68, v69
  v_cvt_pk_bf16_f32 v31, v70, v71
  buffer_store_dwordx4 v[28:31], v20, s[12:15], s22 offen offset:1024 sc1
  v_mul_f32 v72, v72, v4
  v_mul_f32 v73, v73, v4
  v_mul_f32 v74, v74, v4
  v_mul_f32 v75, v75, v4
  v_mul_f32 v76, v76, v4
  v_mul_f32 v77, v77, v4
  v_mul_f32 v78, v78, v4
  v_mul_f32 v79, v79, v4
  v_cvt_pk_bf16_f32 v32, v72, v73
  v_cvt_pk_bf16_f32 v33, v74, v75
  v_cvt_pk_bf16_f32 v34, v76, v77
  v_cvt_pk_bf16_f32 v35, v78, v79
  buffer_store_dwordx4 v[32:35], v20, s[12:15], s22 offen offset:2048 sc1
  v_mul_f32 v80, v80, v4
  v_mul_f32 v81, v81, v4
  v_mul_f32 v82, v82, v4
  v_mul_f32 v83, v83, v4
  v_mul_f32 v84, v84, v4
  v_mul_f32 v85, v85, v4
  v_mul_f32 v86, v86, v4
  v_mul_f32 v87, v87, v4
  v_cvt_pk_bf16_f32 v36, v80, v81
  v_cvt_pk_bf16_f32 v37, v82, v83
  v_cvt_pk_bf16_f32 v38, v84, v85
  v_cvt_pk_bf16_f32 v39, v86, v87
  buffer_store_dwordx4 v[36:39], v20, s[12:15], s22 offen offset:3072 sc1
  v_mul_f32 v88, v88, v4
  v_mul_f32 v89, v89, v4
  v_mul_f32 v90, v90, v4
  v_mul_f32 v91, v91, v4
  v_mul_f32 v92, v92, v4
  v_mul_f32 v93, v93, v4
  v_mul_f32 v94, v94, v4
  v_mul_f32 v95, v95, v4
  v_cvt_pk_bf16_f32 v40, v88, v89
  v_cvt_pk_bf16_f32 v41, v90, v91
  v_cvt_pk_bf16_f32 v42, v92, v93
  v_cvt_pk_bf16_f32 v43, v94, v95
  buffer_store_dwordx4 v[40:43], v20, s[12:15], s23 offen sc1
  v_mul_f32 v96, v96, v4
  v_mul_f32 v97, v97, v4
  v_mul_f32 v98, v98, v4
  v_mul_f32 v99, v99, v4
  v_mul_f32 v100, v100, v4
  v_mul_f32 v101, v101, v4
  v_mul_f32 v102, v102, v4
  v_mul_f32 v103, v103, v4
  v_cvt_pk_bf16_f32 v44, v96, v97
  v_cvt_pk_bf16_f32 v45, v98, v99
  v_cvt_pk_bf16_f32 v46, v100, v101
  v_cvt_pk_bf16_f32 v47, v102, v103
  buffer_store_dwordx4 v[44:47], v20, s[12:15], s23 offen offset:1024 sc1
  v_mul_f32 v104, v104, v4
  v_mul_f32 v105, v105, v4
  v_mul_f32 v106, v106, v4
  v_mul_f32 v107, v107, v4
  v_mul_f32 v108, v108, v4
  v_mul_f32 v109, v109, v4
  v_mul_f32 v110, v110, v4
  v_mul_f32 v111, v111, v4
  v_cvt_pk_bf16_f32 v48, v104, v105
  v_cvt_pk_bf16_f32 v49, v106, v107
  v_cvt_pk_bf16_f32 v50, v108, v109
  v_cvt_pk_bf16_f32 v51, v110, v111
  buffer_store_dwordx4 v[48:51], v20, s[12:15], s23 offen offset:2048 sc1
  v_mul_f32 v112, v112, v4
  v_mul_f32 v113, v113, v4
  v_mul_f32 v114, v114, v4
  v_mul_f32 v115, v115, v4
  v_mul_f32 v116, v116, v4
  v_mul_f32 v117, v117, v4
  v_mul_f32 v118, v118, v4
  v_mul_f32 v119, v119, v4
  v_cvt_pk_bf16_f32 v52, v112, v113
  v_cvt_pk_bf16_f32 v53, v114, v115
  v_cvt_pk_bf16_f32 v54, v116, v117
  v_cvt_pk_bf16_f32 v55, v118, v119
  buffer_store_dwordx4 v[52:55], v20, s[12:15], s23 offen offset:3072 sc1
main_kernel_l_ld:
  s_cmp_gt_u32 s29, s30
  s_cbranch_scc1 main_kernel_l_ldend
  s_barrier
  s_add_u32 s29, s29, 1
  s_branch main_kernel_l_ld
main_kernel_l_ldend:
  s_endpgm
main_kernel_rare_13:
  s_nop 15
  s_nop 15
  v_log_f32 v11, v4
  v_max3_f32 v9, v176, v177, v178
  v_max3_f32 v9, v9, v179, v180
  v_max3_f32 v9, v9, v181, v182
  v_max3_f32 v9, v9, v183, v184
  v_max3_f32 v9, v9, v185, v186
  v_max3_f32 v9, v9, v187, v188
  v_max3_f32 v9, v9, v189, v190
  v_max_f32 v9, v9, v191
  v_max_f32 v9, v9, v11
  v_mov_b32 v12, v9
  s_nop 1
  v_permlane32_swap_b32 v9, v12
  s_nop 1
  v_max_f32 v9, v9, v12
  v_ceil_f32 v9, v9
  v_max_f32 v9, 0, v9
  v_sub_f32 v10, 0, v9
  v_cvt_i32_f32 v10, v10
  v_sub_f32 v176, v176, v9
  v_sub_f32 v177, v177, v9
  v_sub_f32 v178, v178, v9
  v_sub_f32 v179, v179, v9
  v_sub_f32 v180, v180, v9
  v_sub_f32 v181, v181, v9
  v_sub_f32 v182, v182, v9
  v_sub_f32 v183, v183, v9
  v_sub_f32 v184, v184, v9
  v_sub_f32 v185, v185, v9
  v_sub_f32 v186, v186, v9
  v_sub_f32 v187, v187, v9
  v_sub_f32 v188, v188, v9
  v_sub_f32 v189, v189, v9
  v_sub_f32 v190, v190, v9
  v_sub_f32 v191, v191, v9
  v_sub_f32 v160, v160, v9
  v_sub_f32 v161, v161, v9
  v_sub_f32 v162, v162, v9
  v_sub_f32 v163, v163, v9
  v_sub_f32 v164, v164, v9
  v_sub_f32 v165, v165, v9
  v_sub_f32 v166, v166, v9
  v_sub_f32 v167, v167, v9
  v_sub_f32 v168, v168, v9
  v_sub_f32 v169, v169, v9
  v_sub_f32 v170, v170, v9
  v_sub_f32 v171, v171, v9
  v_sub_f32 v172, v172, v9
  v_sub_f32 v173, v173, v9
  v_sub_f32 v174, v174, v9
  v_sub_f32 v175, v175, v9
  v_sub_f32 v208, v208, v9
  v_sub_f32 v209, v209, v9
  v_sub_f32 v210, v210, v9
  v_sub_f32 v211, v211, v9
  v_sub_f32 v212, v212, v9
  v_sub_f32 v213, v213, v9
  v_sub_f32 v214, v214, v9
  v_sub_f32 v215, v215, v9
  v_sub_f32 v216, v216, v9
  v_sub_f32 v217, v217, v9
  v_sub_f32 v218, v218, v9
  v_sub_f32 v219, v219, v9
  v_sub_f32 v220, v220, v9
  v_sub_f32 v221, v221, v9
  v_sub_f32 v222, v222, v9
  v_sub_f32 v223, v223, v9
  v_ldexp_f32 v56, v56, v10
  v_ldexp_f32 v57, v57, v10
  v_ldexp_f32 v58, v58, v10
  v_ldexp_f32 v59, v59, v10
  v_ldexp_f32 v60, v60, v10
  v_ldexp_f32 v61, v61, v10
  v_ldexp_f32 v62, v62, v10
  v_ldexp_f32 v63, v63, v10
  v_ldexp_f32 v64, v64, v10
  v_ldexp_f32 v65, v65, v10
  v_ldexp_f32 v66, v66, v10
  v_ldexp_f32 v67, v67, v10
  v_ldexp_f32 v68, v68, v10
  v_ldexp_f32 v69, v69, v10
  v_ldexp_f32 v70, v70, v10
  v_ldexp_f32 v71, v71, v10
  v_ldexp_f32 v72, v72, v10
  v_ldexp_f32 v73, v73, v10
  v_ldexp_f32 v74, v74, v10
  v_ldexp_f32 v75, v75, v10
  v_ldexp_f32 v76, v76, v10
  v_ldexp_f32 v77, v77, v10
  v_ldexp_f32 v78, v78, v10
  v_ldexp_f32 v79, v79, v10
  v_ldexp_f32 v80, v80, v10
  v_ldexp_f32 v81, v81, v10
  v_ldexp_f32 v82, v82, v10
  v_ldexp_f32 v83, v83, v10
  v_ldexp_f32 v84, v84, v10
  v_ldexp_f32 v85, v85, v10
  v_ldexp_f32 v86, v86, v10
  v_ldexp_f32 v87, v87, v10
  v_ldexp_f32 v88, v88, v10
  v_ldexp_f32 v89, v89, v10
  v_ldexp_f32 v90, v90, v10
  v_ldexp_f32 v91, v91, v10
  v_ldexp_f32 v92, v92, v10
  v_ldexp_f32 v93, v93, v10
  v_ldexp_f32 v94, v94, v10
  v_ldexp_f32 v95, v95, v10
  v_ldexp_f32 v96, v96, v10
  v_ldexp_f32 v97, v97, v10
  v_ldexp_f32 v98, v98, v10
  v_ldexp_f32 v99, v99, v10
  v_ldexp_f32 v100, v100, v10
  v_ldexp_f32 v101, v101, v10
  v_ldexp_f32 v102, v102, v10
  v_ldexp_f32 v103, v103, v10
  v_ldexp_f32 v104, v104, v10
  v_ldexp_f32 v105, v105, v10
  v_ldexp_f32 v106, v106, v10
  v_ldexp_f32 v107, v107, v10
  v_ldexp_f32 v108, v108, v10
  v_ldexp_f32 v109, v109, v10
  v_ldexp_f32 v110, v110, v10
  v_ldexp_f32 v111, v111, v10
  v_ldexp_f32 v112, v112, v10
  v_ldexp_f32 v113, v113, v10
  v_ldexp_f32 v114, v114, v10
  v_ldexp_f32 v115, v115, v10
  v_ldexp_f32 v116, v116, v10
  v_ldexp_f32 v117, v117, v10
  v_ldexp_f32 v118, v118, v10
  v_ldexp_f32 v119, v119, v10
  v_ldexp_f32 v4, v4, v10
  v_exp_f32 v120, v176
  v_exp_f32 v121, v177
  v_add_f32 v3, v4, v120
  v_exp_f32 v122, v178
  v_add_f32 v3, v3, v121
  v_cvt_pk_bf16_f32 v200, v120, v121
  v_exp_f32 v123, v179
  v_add_f32 v3, v3, v122
  v_exp_f32 v124, v180
  v_add_f32 v3, v3, v123
  v_cvt_pk_bf16_f32 v201, v122, v123
  v_exp_f32 v125, v181
  v_add_f32 v3, v3, v124
  v_exp_f32 v126, v182
  v_add_f32 v3, v3, v125
  v_cvt_pk_bf16_f32 v202, v124, v125
  v_exp_f32 v127, v183
  v_add_f32 v3, v3, v126
  v_exp_f32 v120, v184
  v_add_f32 v3, v3, v127
  v_cvt_pk_bf16_f32 v203, v126, v127
  v_exp_f32 v121, v185
  v_add_f32 v3, v3, v120
  v_exp_f32 v122, v186
  v_add_f32 v3, v3, v121
  v_cvt_pk_bf16_f32 v204, v120, v121
  v_exp_f32 v123, v187
  v_add_f32 v3, v3, v122
  v_exp_f32 v124, v188
  v_add_f32 v3, v3, v123
  v_cvt_pk_bf16_f32 v205, v122, v123
  v_exp_f32 v125, v189
  v_add_f32 v3, v3, v124
  v_exp_f32 v126, v190
  v_add_f32 v3, v3, v125
  v_cvt_pk_bf16_f32 v206, v124, v125
  v_exp_f32 v127, v191
  v_add_f32 v3, v3, v126
  v_add_f32 v3, v3, v127
  v_cvt_pk_bf16_f32 v207, v126, v127
  s_nop 1
  s_branch main_kernel_back_14
main_kernel_rare_15:
  s_nop 15
  s_nop 15
  v_log_f32 v11, v3
  v_max3_f32 v9, v160, v161, v162
  v_max3_f32 v9, v9, v163, v164
  v_max3_f32 v9, v9, v165, v166
  v_max3_f32 v9, v9, v167, v168
  v_max3_f32 v9, v9, v169, v170
  v_max3_f32 v9, v9, v171, v172
  v_max3_f32 v9, v9, v173, v174
  v_max_f32 v9, v9, v175
  v_max_f32 v9, v9, v11
  v_mov_b32 v12, v9
  s_nop 1
  v_permlane32_swap_b32 v9, v12
  s_nop 1
  v_max_f32 v9, v9, v12
  v_ceil_f32 v9, v9
  v_max_f32 v9, 0, v9
  v_sub_f32 v10, 0, v9
  v_cvt_i32_f32 v10, v10
  v_sub_f32 v160, v160, v9
  v_sub_f32 v161, v161, v9
  v_sub_f32 v162, v162, v9
  v_sub_f32 v163, v163, v9
  v_sub_f32 v164, v164, v9
  v_sub_f32 v165, v165, v9
  v_sub_f32 v166, v166, v9
  v_sub_f32 v167, v167, v9
  v_sub_f32 v168, v168, v9
  v_sub_f32 v169, v169, v9
  v_sub_f32 v170, v170, v9
  v_sub_f32 v171, v171, v9
  v_sub_f32 v172, v172, v9
  v_sub_f32 v173, v173, v9
  v_sub_f32 v174, v174, v9
  v_sub_f32 v175, v175, v9
  v_sub_f32 v176, v176, v9
  v_sub_f32 v177, v177, v9
  v_sub_f32 v178, v178, v9
  v_sub_f32 v179, v179, v9
  v_sub_f32 v180, v180, v9
  v_sub_f32 v181, v181, v9
  v_sub_f32 v182, v182, v9
  v_sub_f32 v183, v183, v9
  v_sub_f32 v184, v184, v9
  v_sub_f32 v185, v185, v9
  v_sub_f32 v186, v186, v9
  v_sub_f32 v187, v187, v9
  v_sub_f32 v188, v188, v9
  v_sub_f32 v189, v189, v9
  v_sub_f32 v190, v190, v9
  v_sub_f32 v191, v191, v9
  v_sub_f32 v208, v208, v9
  v_sub_f32 v209, v209, v9
  v_sub_f32 v210, v210, v9
  v_sub_f32 v211, v211, v9
  v_sub_f32 v212, v212, v9
  v_sub_f32 v213, v213, v9
  v_sub_f32 v214, v214, v9
  v_sub_f32 v215, v215, v9
  v_sub_f32 v216, v216, v9
  v_sub_f32 v217, v217, v9
  v_sub_f32 v218, v218, v9
  v_sub_f32 v219, v219, v9
  v_sub_f32 v220, v220, v9
  v_sub_f32 v221, v221, v9
  v_sub_f32 v222, v222, v9
  v_sub_f32 v223, v223, v9
  v_ldexp_f32 v56, v56, v10
  v_ldexp_f32 v57, v57, v10
  v_ldexp_f32 v58, v58, v10
  v_ldexp_f32 v59, v59, v10
  v_ldexp_f32 v60, v60, v10
  v_ldexp_f32 v61, v61, v10
  v_ldexp_f32 v62, v62, v10
  v_ldexp_f32 v63, v63, v10
  v_ldexp_f32 v64, v64, v10
  v_ldexp_f32 v65, v65, v10
  v_ldexp_f32 v66, v66, v10
  v_ldexp_f32 v67, v67, v10
  v_ldexp_f32 v68, v68, v10
  v_ldexp_f32 v69, v69, v10
  v_ldexp_f32 v70, v70, v10
  v_ldexp_f32 v71, v71, v10
  v_ldexp_f32 v72, v72, v10
  v_ldexp_f32 v73, v73, v10
  v_ldexp_f32 v74, v74, v10
  v_ldexp_f32 v75, v75, v10
  v_ldexp_f32 v76, v76, v10
  v_ldexp_f32 v77, v77, v10
  v_ldexp_f32 v78, v78, v10
  v_ldexp_f32 v79, v79, v10
  v_ldexp_f32 v80, v80, v10
  v_ldexp_f32 v81, v81, v10
  v_ldexp_f32 v82, v82, v10
  v_ldexp_f32 v83, v83, v10
  v_ldexp_f32 v84, v84, v10
  v_ldexp_f32 v85, v85, v10
  v_ldexp_f32 v86, v86, v10
  v_ldexp_f32 v87, v87, v10
  v_ldexp_f32 v88, v88, v10
  v_ldexp_f32 v89, v89, v10
  v_ldexp_f32 v90, v90, v10
  v_ldexp_f32 v91, v91, v10
  v_ldexp_f32 v92, v92, v10
  v_ldexp_f32 v93, v93, v10
  v_ldexp_f32 v94, v94, v10
  v_ldexp_f32 v95, v95, v10
  v_ldexp_f32 v96, v96, v10
  v_ldexp_f32 v97, v97, v10
  v_ldexp_f32 v98, v98, v10
  v_ldexp_f32 v99, v99, v10
  v_ldexp_f32 v100, v100, v10
  v_ldexp_f32 v101, v101, v10
  v_ldexp_f32 v102, v102, v10
  v_ldexp_f32 v103, v103, v10
  v_ldexp_f32 v104, v104, v10
  v_ldexp_f32 v105, v105, v10
  v_ldexp_f32 v106, v106, v10
  v_ldexp_f32 v107, v107, v10
  v_ldexp_f32 v108, v108, v10
  v_ldexp_f32 v109, v109, v10
  v_ldexp_f32 v110, v110, v10
  v_ldexp_f32 v111, v111, v10
  v_ldexp_f32 v112, v112, v10
  v_ldexp_f32 v113, v113, v10
  v_ldexp_f32 v114, v114, v10
  v_ldexp_f32 v115, v115, v10
  v_ldexp_f32 v116, v116, v10
  v_ldexp_f32 v117, v117, v10
  v_ldexp_f32 v118, v118, v10
  v_ldexp_f32 v119, v119, v10
  v_ldexp_f32 v3, v3, v10
  v_exp_f32 v120, v160
  v_exp_f32 v121, v161
  v_add_f32 v4, v3, v120
  v_exp_f32 v122, v162
  v_add_f32 v4, v4, v121
  v_cvt_pk_bf16_f32 v192, v120, v121
  v_exp_f32 v123, v163
  v_add_f32 v4, v4, v122
  v_exp_f32 v124, v164
  v_add_f32 v4, v4, v123
  v_cvt_pk_bf16_f32 v193, v122, v123
  v_exp_f32 v125, v165
  v_add_f32 v4, v4, v124
  v_exp_f32 v126, v166
  v_add_f32 v4, v4, v125
  v_cvt_pk_bf16_f32 v194, v124, v125
  v_exp_f32 v127, v167
  v_add_f32 v4, v4, v126
  v_exp_f32 v120, v168
  v_add_f32 v4, v4, v127
  v_cvt_pk_bf16_f32 v195, v126, v127
  v_exp_f32 v121, v169
  v_add_f32 v4, v4, v120
  v_exp_f32 v122, v170
  v_add_f32 v4, v4, v121
  v_cvt_pk_bf16_f32 v196, v120, v121
  v_exp_f32 v123, v171
  v_add_f32 v4, v4, v122
  v_exp_f32 v124, v172
  v_add_f32 v4, v4, v123
  v_cvt_pk_bf16_f32 v197, v122, v123
  v_exp_f32 v125, v173
  v_add_f32 v4, v4, v124
  v_exp_f32 v126, v174
  v_add_f32 v4, v4, v125
  v_cvt_pk_bf16_f32 v198, v124, v125
  v_exp_f32 v127, v175
  v_add_f32 v4, v4, v126
  v_add_f32 v4, v4, v127
  v_cvt_pk_bf16_f32 v199, v126, v127
  s_nop 1
  s_branch main_kernel_back_16
main_kernel_rare_17:
  s_nop 15
  s_nop 15
  v_log_f32 v11, v4
  v_max3_f32 v9, v176, v177, v178
  v_max3_f32 v9, v9, v179, v180
  v_max3_f32 v9, v9, v181, v182
  v_max3_f32 v9, v9, v183, v184
  v_max3_f32 v9, v9, v185, v186
  v_max3_f32 v9, v9, v187, v188
  v_max3_f32 v9, v9, v189, v190
  v_max_f32 v9, v9, v191
  v_max_f32 v9, v9, v11
  v_mov_b32 v12, v9
  s_nop 1
  v_permlane32_swap_b32 v9, v12
  s_nop 1
  v_max_f32 v9, v9, v12
  v_ceil_f32 v9, v9
  v_max_f32 v9, 0, v9
  v_sub_f32 v10, 0, v9
  v_cvt_i32_f32 v10, v10
  v_sub_f32 v176, v176, v9
  v_sub_f32 v177, v177, v9
  v_sub_f32 v178, v178, v9
  v_sub_f32 v179, v179, v9
  v_sub_f32 v180, v180, v9
  v_sub_f32 v181, v181, v9
  v_sub_f32 v182, v182, v9
  v_sub_f32 v183, v183, v9
  v_sub_f32 v184, v184, v9
  v_sub_f32 v185, v185, v9
  v_sub_f32 v186, v186, v9
  v_sub_f32 v187, v187, v9
  v_sub_f32 v188, v188, v9
  v_sub_f32 v189, v189, v9
  v_sub_f32 v190, v190, v9
  v_sub_f32 v191, v191, v9
  v_sub_f32 v160, v160, v9
  v_sub_f32 v161, v161, v9
  v_sub_f32 v162, v162, v9
  v_sub_f32 v163, v163, v9
  v_sub_f32 v164, v164, v9
  v_sub_f32 v165, v165, v9
  v_sub_f32 v166, v166, v9
  v_sub_f32 v167, v167, v9
  v_sub_f32 v168, v168, v9
  v_sub_f32 v169, v169, v9
  v_sub_f32 v170, v170, v9
  v_sub_f32 v171, v171, v9
  v_sub_f32 v172, v172, v9
  v_sub_f32 v173, v173, v9
  v_sub_f32 v174, v174, v9
  v_sub_f32 v175, v175, v9
  v_sub_f32 v208, v208, v9
  v_sub_f32 v209, v209, v9
  v_sub_f32 v210, v210, v9
  v_sub_f32 v211, v211, v9
  v_sub_f32 v212, v212, v9
  v_sub_f32 v213, v213, v9
  v_sub_f32 v214, v214, v9
  v_sub_f32 v215, v215, v9
  v_sub_f32 v216, v216, v9
  v_sub_f32 v217, v217, v9
  v_sub_f32 v218, v218, v9
  v_sub_f32 v219, v219, v9
  v_sub_f32 v220, v220, v9
  v_sub_f32 v221, v221, v9
  v_sub_f32 v222, v222, v9
  v_sub_f32 v223, v223, v9
  v_ldexp_f32 v56, v56, v10
  v_ldexp_f32 v57, v57, v10
  v_ldexp_f32 v58, v58, v10
  v_ldexp_f32 v59, v59, v10
  v_ldexp_f32 v60, v60, v10
  v_ldexp_f32 v61, v61, v10
  v_ldexp_f32 v62, v62, v10
  v_ldexp_f32 v63, v63, v10
  v_ldexp_f32 v64, v64, v10
  v_ldexp_f32 v65, v65, v10
  v_ldexp_f32 v66, v66, v10
  v_ldexp_f32 v67, v67, v10
  v_ldexp_f32 v68, v68, v10
  v_ldexp_f32 v69, v69, v10
  v_ldexp_f32 v70, v70, v10
  v_ldexp_f32 v71, v71, v10
  v_ldexp_f32 v72, v72, v10
  v_ldexp_f32 v73, v73, v10
  v_ldexp_f32 v74, v74, v10
  v_ldexp_f32 v75, v75, v10
  v_ldexp_f32 v76, v76, v10
  v_ldexp_f32 v77, v77, v10
  v_ldexp_f32 v78, v78, v10
  v_ldexp_f32 v79, v79, v10
  v_ldexp_f32 v80, v80, v10
  v_ldexp_f32 v81, v81, v10
  v_ldexp_f32 v82, v82, v10
  v_ldexp_f32 v83, v83, v10
  v_ldexp_f32 v84, v84, v10
  v_ldexp_f32 v85, v85, v10
  v_ldexp_f32 v86, v86, v10
  v_ldexp_f32 v87, v87, v10
  v_ldexp_f32 v88, v88, v10
  v_ldexp_f32 v89, v89, v10
  v_ldexp_f32 v90, v90, v10
  v_ldexp_f32 v91, v91, v10
  v_ldexp_f32 v92, v92, v10
  v_ldexp_f32 v93, v93, v10
  v_ldexp_f32 v94, v94, v10
  v_ldexp_f32 v95, v95, v10
  v_ldexp_f32 v96, v96, v10
  v_ldexp_f32 v97, v97, v10
  v_ldexp_f32 v98, v98, v10
  v_ldexp_f32 v99, v99, v10
  v_ldexp_f32 v100, v100, v10
  v_ldexp_f32 v101, v101, v10
  v_ldexp_f32 v102, v102, v10
  v_ldexp_f32 v103, v103, v10
  v_ldexp_f32 v104, v104, v10
  v_ldexp_f32 v105, v105, v10
  v_ldexp_f32 v106, v106, v10
  v_ldexp_f32 v107, v107, v10
  v_ldexp_f32 v108, v108, v10
  v_ldexp_f32 v109, v109, v10
  v_ldexp_f32 v110, v110, v10
  v_ldexp_f32 v111, v111, v10
  v_ldexp_f32 v112, v112, v10
  v_ldexp_f32 v113, v113, v10
  v_ldexp_f32 v114, v114, v10
  v_ldexp_f32 v115, v115, v10
  v_ldexp_f32 v116, v116, v10
  v_ldexp_f32 v117, v117, v10
  v_ldexp_f32 v118, v118, v10
  v_ldexp_f32 v119, v119, v10
  v_ldexp_f32 v4, v4, v10
  v_exp_f32 v120, v176
  v_exp_f32 v121, v177
  v_add_f32 v3, v4, v120
  v_exp_f32 v122, v178
  v_add_f32 v3, v3, v121
  v_cvt_pk_bf16_f32 v200, v120, v121
  v_exp_f32 v123, v179
  v_add_f32 v3, v3, v122
  v_exp_f32 v124, v180
  v_add_f32 v3, v3, v123
  v_cvt_pk_bf16_f32 v201, v122, v123
  v_exp_f32 v125, v181
  v_add_f32 v3, v3, v124
  v_exp_f32 v126, v182
  v_add_f32 v3, v3, v125
  v_cvt_pk_bf16_f32 v202, v124, v125
  v_exp_f32 v127, v183
  v_add_f32 v3, v3, v126
  v_exp_f32 v120, v184
  v_add_f32 v3, v3, v127
  v_cvt_pk_bf16_f32 v203, v126, v127
  v_exp_f32 v121, v185
  v_add_f32 v3, v3, v120
  v_exp_f32 v122, v186
  v_add_f32 v3, v3, v121
  v_cvt_pk_bf16_f32 v204, v120, v121
  v_exp_f32 v123, v187
  v_add_f32 v3, v3, v122
  v_exp_f32 v124, v188
  v_add_f32 v3, v3, v123
  v_cvt_pk_bf16_f32 v205, v122, v123
  v_exp_f32 v125, v189
  v_add_f32 v3, v3, v124
  v_exp_f32 v126, v190
  v_add_f32 v3, v3, v125
  v_cvt_pk_bf16_f32 v206, v124, v125
  v_exp_f32 v127, v191
  v_add_f32 v3, v3, v126
  v_add_f32 v3, v3, v127
  v_cvt_pk_bf16_f32 v207, v126, v127
  s_nop 1
  s_branch main_kernel_back_18
main_kernel_rare_19:
  s_nop 15
  s_nop 15
  v_log_f32 v11, v3
  v_max3_f32 v9, v160, v161, v162
  v_max3_f32 v9, v9, v163, v164
  v_max3_f32 v9, v9, v165, v166
  v_max3_f32 v9, v9, v167, v168
  v_max3_f32 v9, v9, v169, v170
  v_max3_f32 v9, v9, v171, v172
  v_max3_f32 v9, v9, v173, v174
  v_max_f32 v9, v9, v175
  v_max_f32 v9, v9, v11
  v_mov_b32 v12, v9
  s_nop 1
  v_permlane32_swap_b32 v9, v12
  s_nop 1
  v_max_f32 v9, v9, v12
  v_ceil_f32 v9, v9
  v_max_f32 v9, 0, v9
  v_sub_f32 v10, 0, v9
  v_cvt_i32_f32 v10, v10
  v_sub_f32 v160, v160, v9
  v_sub_f32 v161, v161, v9
  v_sub_f32 v162, v162, v9
  v_sub_f32 v163, v163, v9
  v_sub_f32 v164, v164, v9
  v_sub_f32 v165, v165, v9
  v_sub_f32 v166, v166, v9
  v_sub_f32 v167, v167, v9
  v_sub_f32 v168, v168, v9
  v_sub_f32 v169, v169, v9
  v_sub_f32 v170, v170, v9
  v_sub_f32 v171, v171, v9
  v_sub_f32 v172, v172, v9
  v_sub_f32 v173, v173, v9
  v_sub_f32 v174, v174, v9
  v_sub_f32 v175, v175, v9
  v_sub_f32 v176, v176, v9
  v_sub_f32 v177, v177, v9
  v_sub_f32 v178, v178, v9
  v_sub_f32 v179, v179, v9
  v_sub_f32 v180, v180, v9
  v_sub_f32 v181, v181, v9
  v_sub_f32 v182, v182, v9
  v_sub_f32 v183, v183, v9
  v_sub_f32 v184, v184, v9
  v_sub_f32 v185, v185, v9
  v_sub_f32 v186, v186, v9
  v_sub_f32 v187, v187, v9
  v_sub_f32 v188, v188, v9
  v_sub_f32 v189, v189, v9
  v_sub_f32 v190, v190, v9
  v_sub_f32 v191, v191, v9
  v_sub_f32 v208, v208, v9
  v_sub_f32 v209, v209, v9
  v_sub_f32 v210, v210, v9
  v_sub_f32 v211, v211, v9
  v_sub_f32 v212, v212, v9
  v_sub_f32 v213, v213, v9
  v_sub_f32 v214, v214, v9
  v_sub_f32 v215, v215, v9
  v_sub_f32 v216, v216, v9
  v_sub_f32 v217, v217, v9
  v_sub_f32 v218, v218, v9
  v_sub_f32 v219, v219, v9
  v_sub_f32 v220, v220, v9
  v_sub_f32 v221, v221, v9
  v_sub_f32 v222, v222, v9
  v_sub_f32 v223, v223, v9
  v_ldexp_f32 v56, v56, v10
  v_ldexp_f32 v57, v57, v10
  v_ldexp_f32 v58, v58, v10
  v_ldexp_f32 v59, v59, v10
  v_ldexp_f32 v60, v60, v10
  v_ldexp_f32 v61, v61, v10
  v_ldexp_f32 v62, v62, v10
  v_ldexp_f32 v63, v63, v10
  v_ldexp_f32 v64, v64, v10
  v_ldexp_f32 v65, v65, v10
  v_ldexp_f32 v66, v66, v10
  v_ldexp_f32 v67, v67, v10
  v_ldexp_f32 v68, v68, v10
  v_ldexp_f32 v69, v69, v10
  v_ldexp_f32 v70, v70, v10
  v_ldexp_f32 v71, v71, v10
  v_ldexp_f32 v72, v72, v10
  v_ldexp_f32 v73, v73, v10
  v_ldexp_f32 v74, v74, v10
  v_ldexp_f32 v75, v75, v10
  v_ldexp_f32 v76, v76, v10
  v_ldexp_f32 v77, v77, v10
  v_ldexp_f32 v78, v78, v10
  v_ldexp_f32 v79, v79, v10
  v_ldexp_f32 v80, v80, v10
  v_ldexp_f32 v81, v81, v10
  v_ldexp_f32 v82, v82, v10
  v_ldexp_f32 v83, v83, v10
  v_ldexp_f32 v84, v84, v10
  v_ldexp_f32 v85, v85, v10
  v_ldexp_f32 v86, v86, v10
  v_ldexp_f32 v87, v87, v10
  v_ldexp_f32 v88, v88, v10
  v_ldexp_f32 v89, v89, v10
  v_ldexp_f32 v90, v90, v10
  v_ldexp_f32 v91, v91, v10
  v_ldexp_f32 v92, v92, v10
  v_ldexp_f32 v93, v93, v10
  v_ldexp_f32 v94, v94, v10
  v_ldexp_f32 v95, v95, v10
  v_ldexp_f32 v96, v96, v10
  v_ldexp_f32 v97, v97, v10
  v_ldexp_f32 v98, v98, v10
  v_ldexp_f32 v99, v99, v10
  v_ldexp_f32 v100, v100, v10
  v_ldexp_f32 v101, v101, v10
  v_ldexp_f32 v102, v102, v10
  v_ldexp_f32 v103, v103, v10
  v_ldexp_f32 v104, v104, v10
  v_ldexp_f32 v105, v105, v10
  v_ldexp_f32 v106, v106, v10
  v_ldexp_f32 v107, v107, v10
  v_ldexp_f32 v108, v108, v10
  v_ldexp_f32 v109, v109, v10
  v_ldexp_f32 v110, v110, v10
  v_ldexp_f32 v111, v111, v10
  v_ldexp_f32 v112, v112, v10
  v_ldexp_f32 v113, v113, v10
  v_ldexp_f32 v114, v114, v10
  v_ldexp_f32 v115, v115, v10
  v_ldexp_f32 v116, v116, v10
  v_ldexp_f32 v117, v117, v10
  v_ldexp_f32 v118, v118, v10
  v_ldexp_f32 v119, v119, v10
  v_ldexp_f32 v3, v3, v10
  v_exp_f32 v120, v160
  v_exp_f32 v121, v161
  v_add_f32 v4, v3, v120
  v_exp_f32 v122, v162
  v_add_f32 v4, v4, v121
  v_cvt_pk_bf16_f32 v192, v120, v121
  v_exp_f32 v123, v163
  v_add_f32 v4, v4, v122
  v_exp_f32 v124, v164
  v_add_f32 v4, v4, v123
  v_cvt_pk_bf16_f32 v193, v122, v123
  v_exp_f32 v125, v165
  v_add_f32 v4, v4, v124
  v_exp_f32 v126, v166
  v_add_f32 v4, v4, v125
  v_cvt_pk_bf16_f32 v194, v124, v125
  v_exp_f32 v127, v167
  v_add_f32 v4, v4, v126
  v_exp_f32 v120, v168
  v_add_f32 v4, v4, v127
  v_cvt_pk_bf16_f32 v195, v126, v127
  v_exp_f32 v121, v169
  v_add_f32 v4, v4, v120
  v_exp_f32 v122, v170
  v_add_f32 v4, v4, v121
  v_cvt_pk_bf16_f32 v196, v120, v121
  v_exp_f32 v123, v171
  v_add_f32 v4, v4, v122
  v_exp_f32 v124, v172
  v_add_f32 v4, v4, v123
  v_cvt_pk_bf16_f32 v197, v122, v123
  v_exp_f32 v125, v173
  v_add_f32 v4, v4, v124
  v_exp_f32 v126, v174
  v_add_f32 v4, v4, v125
  v_cvt_pk_bf16_f32 v198, v124, v125
  v_exp_f32 v127, v175
  v_add_f32 v4, v4, v126
  v_add_f32 v4, v4, v127
  v_cvt_pk_bf16_f32 v199, v126, v127
  s_nop 1
  s_branch main_kernel_back_20
main_kernel_rare_21:
  s_nop 15
  s_nop 15
  v_log_f32 v11, v4
  v_max3_f32 v9, v176, v177, v178
  v_max3_f32 v9, v9, v179, v180
  v_max3_f32 v9, v9, v181, v182
  v_max3_f32 v9, v9, v183, v184
  v_max3_f32 v9, v9, v185, v186
  v_max3_f32 v9, v9, v187, v188
  v_max3_f32 v9, v9, v189, v190
  v_max_f32 v9, v9, v191
  v_max_f32 v9, v9, v11
  v_mov_b32 v12, v9
  s_nop 1
  v_permlane32_swap_b32 v9, v12
  s_nop 1
  v_max_f32 v9, v9, v12
  v_ceil_f32 v9, v9
  v_max_f32 v9, 0, v9
  v_sub_f32 v10, 0, v9
  v_cvt_i32_f32 v10, v10
  v_sub_f32 v176, v176, v9
  v_sub_f32 v177, v177, v9
  v_sub_f32 v178, v178, v9
  v_sub_f32 v179, v179, v9
  v_sub_f32 v180, v180, v9
  v_sub_f32 v181, v181, v9
  v_sub_f32 v182, v182, v9
  v_sub_f32 v183, v183, v9
  v_sub_f32 v184, v184, v9
  v_sub_f32 v185, v185, v9
  v_sub_f32 v186, v186, v9
  v_sub_f32 v187, v187, v9
  v_sub_f32 v188, v188, v9
  v_sub_f32 v189, v189, v9
  v_sub_f32 v190, v190, v9
  v_sub_f32 v191, v191, v9
  v_sub_f32 v160, v160, v9
  v_sub_f32 v161, v161, v9
  v_sub_f32 v162, v162, v9
  v_sub_f32 v163, v163, v9
  v_sub_f32 v164, v164, v9
  v_sub_f32 v165, v165, v9
  v_sub_f32 v166, v166, v9
  v_sub_f32 v167, v167, v9
  v_sub_f32 v168, v168, v9
  v_sub_f32 v169, v169, v9
  v_sub_f32 v170, v170, v9
  v_sub_f32 v171, v171, v9
  v_sub_f32 v172, v172, v9
  v_sub_f32 v173, v173, v9
  v_sub_f32 v174, v174, v9
  v_sub_f32 v175, v175, v9
  v_sub_f32 v208, v208, v9
  v_sub_f32 v209, v209, v9
  v_sub_f32 v210, v210, v9
  v_sub_f32 v211, v211, v9
  v_sub_f32 v212, v212, v9
  v_sub_f32 v213, v213, v9
  v_sub_f32 v214, v214, v9
  v_sub_f32 v215, v215, v9
  v_sub_f32 v216, v216, v9
  v_sub_f32 v217, v217, v9
  v_sub_f32 v218, v218, v9
  v_sub_f32 v219, v219, v9
  v_sub_f32 v220, v220, v9
  v_sub_f32 v221, v221, v9
  v_sub_f32 v222, v222, v9
  v_sub_f32 v223, v223, v9
  v_ldexp_f32 v56, v56, v10
  v_ldexp_f32 v57, v57, v10
  v_ldexp_f32 v58, v58, v10
  v_ldexp_f32 v59, v59, v10
  v_ldexp_f32 v60, v60, v10
  v_ldexp_f32 v61, v61, v10
  v_ldexp_f32 v62, v62, v10
  v_ldexp_f32 v63, v63, v10
  v_ldexp_f32 v64, v64, v10
  v_ldexp_f32 v65, v65, v10
  v_ldexp_f32 v66, v66, v10
  v_ldexp_f32 v67, v67, v10
  v_ldexp_f32 v68, v68, v10
  v_ldexp_f32 v69, v69, v10
  v_ldexp_f32 v70, v70, v10
  v_ldexp_f32 v71, v71, v10
  v_ldexp_f32 v72, v72, v10
  v_ldexp_f32 v73, v73, v10
  v_ldexp_f32 v74, v74, v10
  v_ldexp_f32 v75, v75, v10
  v_ldexp_f32 v76, v76, v10
  v_ldexp_f32 v77, v77, v10
  v_ldexp_f32 v78, v78, v10
  v_ldexp_f32 v79, v79, v10
  v_ldexp_f32 v80, v80, v10
  v_ldexp_f32 v81, v81, v10
  v_ldexp_f32 v82, v82, v10
  v_ldexp_f32 v83, v83, v10
  v_ldexp_f32 v84, v84, v10
  v_ldexp_f32 v85, v85, v10
  v_ldexp_f32 v86, v86, v10
  v_ldexp_f32 v87, v87, v10
  v_ldexp_f32 v88, v88, v10
  v_ldexp_f32 v89, v89, v10
  v_ldexp_f32 v90, v90, v10
  v_ldexp_f32 v91, v91, v10
  v_ldexp_f32 v92, v92, v10
  v_ldexp_f32 v93, v93, v10
  v_ldexp_f32 v94, v94, v10
  v_ldexp_f32 v95, v95, v10
  v_ldexp_f32 v96, v96, v10
  v_ldexp_f32 v97, v97, v10
  v_ldexp_f32 v98, v98, v10
  v_ldexp_f32 v99, v99, v10
  v_ldexp_f32 v100, v100, v10
  v_ldexp_f32 v101, v101, v10
  v_ldexp_f32 v102, v102, v10
  v_ldexp_f32 v103, v103, v10
  v_ldexp_f32 v104, v104, v10
  v_ldexp_f32 v105, v105, v10
  v_ldexp_f32 v106, v106, v10
  v_ldexp_f32 v107, v107, v10
  v_ldexp_f32 v108, v108, v10
  v_ldexp_f32 v109, v109, v10
  v_ldexp_f32 v110, v110, v10
  v_ldexp_f32 v111, v111, v10
  v_ldexp_f32 v112, v112, v10
  v_ldexp_f32 v113, v113, v10
  v_ldexp_f32 v114, v114, v10
  v_ldexp_f32 v115, v115, v10
  v_ldexp_f32 v116, v116, v10
  v_ldexp_f32 v117, v117, v10
  v_ldexp_f32 v118, v118, v10
  v_ldexp_f32 v119, v119, v10
  v_ldexp_f32 v4, v4, v10
  v_exp_f32 v120, v176
  v_exp_f32 v121, v177
  v_add_f32 v3, v4, v120
  v_exp_f32 v122, v178
  v_add_f32 v3, v3, v121
  v_cvt_pk_bf16_f32 v200, v120, v121
  v_exp_f32 v123, v179
  v_add_f32 v3, v3, v122
  v_exp_f32 v124, v180
  v_add_f32 v3, v3, v123
  v_cvt_pk_bf16_f32 v201, v122, v123
  v_exp_f32 v125, v181
  v_add_f32 v3, v3, v124
  v_exp_f32 v126, v182
  v_add_f32 v3, v3, v125
  v_cvt_pk_bf16_f32 v202, v124, v125
  v_exp_f32 v127, v183
  v_add_f32 v3, v3, v126
  v_exp_f32 v120, v184
  v_add_f32 v3, v3, v127
  v_cvt_pk_bf16_f32 v203, v126, v127
  v_exp_f32 v121, v185
  v_add_f32 v3, v3, v120
  v_exp_f32 v122, v186
  v_add_f32 v3, v3, v121
  v_cvt_pk_bf16_f32 v204, v120, v121
  v_exp_f32 v123, v187
  v_add_f32 v3, v3, v122
  v_exp_f32 v124, v188
  v_add_f32 v3, v3, v123
  v_cvt_pk_bf16_f32 v205, v122, v123
  v_exp_f32 v125, v189
  v_add_f32 v3, v3, v124
  v_exp_f32 v126, v190
  v_add_f32 v3, v3, v125
  v_cvt_pk_bf16_f32 v206, v124, v125
  v_exp_f32 v127, v191
  v_add_f32 v3, v3, v126
  v_add_f32 v3, v3, v127
  v_cvt_pk_bf16_f32 v207, v126, v127
  s_nop 1
  s_branch main_kernel_back_22
main_kernel_rare_23:
  s_nop 15
  s_nop 15
  v_log_f32 v11, v3
  v_max3_f32 v9, v160, v161, v162
  v_max3_f32 v9, v9, v163, v164
  v_max3_f32 v9, v9, v165, v166
  v_max3_f32 v9, v9, v167, v168
  v_max3_f32 v9, v9, v169, v170
  v_max3_f32 v9, v9, v171, v172
  v_max3_f32 v9, v9, v173, v174
  v_max_f32 v9, v9, v175
  v_max_f32 v9, v9, v11
  v_mov_b32 v12, v9
  s_nop 1
  v_permlane32_swap_b32 v9, v12
  s_nop 1
  v_max_f32 v9, v9, v12
  v_ceil_f32 v9, v9
  v_max_f32 v9, 0, v9
  v_sub_f32 v10, 0, v9
  v_cvt_i32_f32 v10, v10
  v_sub_f32 v160, v160, v9
  v_sub_f32 v161, v161, v9
  v_sub_f32 v162, v162, v9
  v_sub_f32 v163, v163, v9
  v_sub_f32 v164, v164, v9
  v_sub_f32 v165, v165, v9
  v_sub_f32 v166, v166, v9
  v_sub_f32 v167, v167, v9
  v_sub_f32 v168, v168, v9
  v_sub_f32 v169, v169, v9
  v_sub_f32 v170, v170, v9
  v_sub_f32 v171, v171, v9
  v_sub_f32 v172, v172, v9
  v_sub_f32 v173, v173, v9
  v_sub_f32 v174, v174, v9
  v_sub_f32 v175, v175, v9
  v_sub_f32 v176, v176, v9
  v_sub_f32 v177, v177, v9
  v_sub_f32 v178, v178, v9
  v_sub_f32 v179, v179, v9
  v_sub_f32 v180, v180, v9
  v_sub_f32 v181, v181, v9
  v_sub_f32 v182, v182, v9
  v_sub_f32 v183, v183, v9
  v_sub_f32 v184, v184, v9
  v_sub_f32 v185, v185, v9
  v_sub_f32 v186, v186, v9
  v_sub_f32 v187, v187, v9
  v_sub_f32 v188, v188, v9
  v_sub_f32 v189, v189, v9
  v_sub_f32 v190, v190, v9
  v_sub_f32 v191, v191, v9
  v_sub_f32 v208, v208, v9
  v_sub_f32 v209, v209, v9
  v_sub_f32 v210, v210, v9
  v_sub_f32 v211, v211, v9
  v_sub_f32 v212, v212, v9
  v_sub_f32 v213, v213, v9
  v_sub_f32 v214, v214, v9
  v_sub_f32 v215, v215, v9
  v_sub_f32 v216, v216, v9
  v_sub_f32 v217, v217, v9
  v_sub_f32 v218, v218, v9
  v_sub_f32 v219, v219, v9
  v_sub_f32 v220, v220, v9
  v_sub_f32 v221, v221, v9
  v_sub_f32 v222, v222, v9
  v_sub_f32 v223, v223, v9
  v_ldexp_f32 v56, v56, v10
  v_ldexp_f32 v57, v57, v10
  v_ldexp_f32 v58, v58, v10
  v_ldexp_f32 v59, v59, v10
  v_ldexp_f32 v60, v60, v10
  v_ldexp_f32 v61, v61, v10
  v_ldexp_f32 v62, v62, v10
  v_ldexp_f32 v63, v63, v10
  v_ldexp_f32 v64, v64, v10
  v_ldexp_f32 v65, v65, v10
  v_ldexp_f32 v66, v66, v10
  v_ldexp_f32 v67, v67, v10
  v_ldexp_f32 v68, v68, v10
  v_ldexp_f32 v69, v69, v10
  v_ldexp_f32 v70, v70, v10
  v_ldexp_f32 v71, v71, v10
  v_ldexp_f32 v72, v72, v10
  v_ldexp_f32 v73, v73, v10
  v_ldexp_f32 v74, v74, v10
  v_ldexp_f32 v75, v75, v10
  v_ldexp_f32 v76, v76, v10
  v_ldexp_f32 v77, v77, v10
  v_ldexp_f32 v78, v78, v10
  v_ldexp_f32 v79, v79, v10
  v_ldexp_f32 v80, v80, v10
  v_ldexp_f32 v81, v81, v10
  v_ldexp_f32 v82, v82, v10
  v_ldexp_f32 v83, v83, v10
  v_ldexp_f32 v84, v84, v10
  v_ldexp_f32 v85, v85, v10
  v_ldexp_f32 v86, v86, v10
  v_ldexp_f32 v87, v87, v10
  v_ldexp_f32 v88, v88, v10
  v_ldexp_f32 v89, v89, v10
  v_ldexp_f32 v90, v90, v10
  v_ldexp_f32 v91, v91, v10
  v_ldexp_f32 v92, v92, v10
  v_ldexp_f32 v93, v93, v10
  v_ldexp_f32 v94, v94, v10
  v_ldexp_f32 v95, v95, v10
  v_ldexp_f32 v96, v96, v10
  v_ldexp_f32 v97, v97, v10
  v_ldexp_f32 v98, v98, v10
  v_ldexp_f32 v99, v99, v10
  v_ldexp_f32 v100, v100, v10
  v_ldexp_f32 v101, v101, v10
  v_ldexp_f32 v102, v102, v10
  v_ldexp_f32 v103, v103, v10
  v_ldexp_f32 v104, v104, v10
  v_ldexp_f32 v105, v105, v10
  v_ldexp_f32 v106, v106, v10
  v_ldexp_f32 v107, v107, v10
  v_ldexp_f32 v108, v108, v10
  v_ldexp_f32 v109, v109, v10
  v_ldexp_f32 v110, v110, v10
  v_ldexp_f32 v111, v111, v10
  v_ldexp_f32 v112, v112, v10
  v_ldexp_f32 v113, v113, v10
  v_ldexp_f32 v114, v114, v10
  v_ldexp_f32 v115, v115, v10
  v_ldexp_f32 v116, v116, v10
  v_ldexp_f32 v117, v117, v10
  v_ldexp_f32 v118, v118, v10
  v_ldexp_f32 v119, v119, v10
  v_ldexp_f32 v3, v3, v10
  v_exp_f32 v120, v160
  v_exp_f32 v121, v161
  v_add_f32 v4, v3, v120
  v_exp_f32 v122, v162
  v_add_f32 v4, v4, v121
  v_cvt_pk_bf16_f32 v192, v120, v121
  v_exp_f32 v123, v163
  v_add_f32 v4, v4, v122
  v_exp_f32 v124, v164
  v_add_f32 v4, v4, v123
  v_cvt_pk_bf16_f32 v193, v122, v123
  v_exp_f32 v125, v165
  v_add_f32 v4, v4, v124
  v_exp_f32 v126, v166
  v_add_f32 v4, v4, v125
  v_cvt_pk_bf16_f32 v194, v124, v125
  v_exp_f32 v127, v167
  v_add_f32 v4, v4, v126
  v_exp_f32 v120, v168
  v_add_f32 v4, v4, v127
  v_cvt_pk_bf16_f32 v195, v126, v127
  v_exp_f32 v121, v169
  v_add_f32 v4, v4, v120
  v_exp_f32 v122, v170
  v_add_f32 v4, v4, v121
  v_cvt_pk_bf16_f32 v196, v120, v121
  v_exp_f32 v123, v171
  v_add_f32 v4, v4, v122
  v_exp_f32 v124, v172
  v_add_f32 v4, v4, v123
  v_cvt_pk_bf16_f32 v197, v122, v123
  v_exp_f32 v125, v173
  v_add_f32 v4, v4, v124
  v_exp_f32 v126, v174
  v_add_f32 v4, v4, v125
  v_cvt_pk_bf16_f32 v198, v124, v125
  v_exp_f32 v127, v175
  v_add_f32 v4, v4, v126
  v_add_f32 v4, v4, v127
  v_cvt_pk_bf16_f32 v199, v126, v127
  s_nop 1
  s_branch main_kernel_back_24
main_kernel_rare_25:
  s_nop 15
  s_nop 15
  v_log_f32 v11, v3
  v_max3_f32 v9, v160, v161, v162
  v_max3_f32 v9, v9, v163, v164
  v_max3_f32 v9, v9, v165, v166
  v_max3_f32 v9, v9, v167, v168
  v_max3_f32 v9, v9, v169, v170
  v_max3_f32 v9, v9, v171, v172
  v_max3_f32 v9, v9, v173, v174
  v_max_f32 v9, v9, v175
  v_max_f32 v9, v9, v11
  v_mov_b32 v12, v9
  s_nop 1
  v_permlane32_swap_b32 v9, v12
  s_nop 1
  v_max_f32 v9, v9, v12
  v_ceil_f32 v9, v9
  v_max_f32 v9, 0, v9
  v_sub_f32 v10, 0, v9
  v_cvt_i32_f32 v10, v10
  v_sub_f32 v160, v160, v9
  v_sub_f32 v161, v161, v9
  v_sub_f32 v162, v162, v9
  v_sub_f32 v163, v163, v9
  v_sub_f32 v164, v164, v9
  v_sub_f32 v165, v165, v9
  v_sub_f32 v166, v166, v9
  v_sub_f32 v167, v167, v9
  v_sub_f32 v168, v168, v9
  v_sub_f32 v169, v169, v9
  v_sub_f32 v170, v170, v9
  v_sub_f32 v171, v171, v9
  v_sub_f32 v172, v172, v9
  v_sub_f32 v173, v173, v9
  v_sub_f32 v174, v174, v9
  v_sub_f32 v175, v175, v9
  v_sub_f32 v176, v176, v9
  v_sub_f32 v177, v177, v9
  v_sub_f32 v178, v178, v9
  v_sub_f32 v179, v179, v9
  v_sub_f32 v180, v180, v9
  v_sub_f32 v181, v181, v9
  v_sub_f32 v182, v182, v9
  v_sub_f32 v183, v183, v9
  v_sub_f32 v184, v184, v9
  v_sub_f32 v185, v185, v9
  v_sub_f32 v186, v186, v9
  v_sub_f32 v187, v187, v9
  v_sub_f32 v188, v188, v9
  v_sub_f32 v189, v189, v9
  v_sub_f32 v190, v190, v9
  v_sub_f32 v191, v191, v9
  v_sub_f32 v208, v208, v9
  v_sub_f32 v209, v209, v9
  v_sub_f32 v210, v210, v9
  v_sub_f32 v211, v211, v9
  v_sub_f32 v212, v212, v9
  v_sub_f32 v213, v213, v9
  v_sub_f32 v214, v214, v9
  v_sub_f32 v215, v215, v9
  v_sub_f32 v216, v216, v9
  v_sub_f32 v217, v217, v9
  v_sub_f32 v218, v218, v9
  v_sub_f32 v219, v219, v9
  v_sub_f32 v220, v220, v9
  v_sub_f32 v221, v221, v9
  v_sub_f32 v222, v222, v9
  v_sub_f32 v223, v223, v9
  v_ldexp_f32 v56, v56, v10
  v_ldexp_f32 v57, v57, v10
  v_ldexp_f32 v58, v58, v10
  v_ldexp_f32 v59, v59, v10
  v_ldexp_f32 v60, v60, v10
  v_ldexp_f32 v61, v61, v10
  v_ldexp_f32 v62, v62, v10
  v_ldexp_f32 v63, v63, v10
  v_ldexp_f32 v64, v64, v10
  v_ldexp_f32 v65, v65, v10
  v_ldexp_f32 v66, v66, v10
  v_ldexp_f32 v67, v67, v10
  v_ldexp_f32 v68, v68, v10
  v_ldexp_f32 v69, v69, v10
  v_ldexp_f32 v70, v70, v10
  v_ldexp_f32 v71, v71, v10
  v_ldexp_f32 v72, v72, v10
  v_ldexp_f32 v73, v73, v10
  v_ldexp_f32 v74, v74, v10
  v_ldexp_f32 v75, v75, v10
  v_ldexp_f32 v76, v76, v10
  v_ldexp_f32 v77, v77, v10
  v_ldexp_f32 v78, v78, v10
  v_ldexp_f32 v79, v79, v10
  v_ldexp_f32 v80, v80, v10
  v_ldexp_f32 v81, v81, v10
  v_ldexp_f32 v82, v82, v10
  v_ldexp_f32 v83, v83, v10
  v_ldexp_f32 v84, v84, v10
  v_ldexp_f32 v85, v85, v10
  v_ldexp_f32 v86, v86, v10
  v_ldexp_f32 v87, v87, v10
  v_ldexp_f32 v88, v88, v10
  v_ldexp_f32 v89, v89, v10
  v_ldexp_f32 v90, v90, v10
  v_ldexp_f32 v91, v91, v10
  v_ldexp_f32 v92, v92, v10
  v_ldexp_f32 v93, v93, v10
  v_ldexp_f32 v94, v94, v10
  v_ldexp_f32 v95, v95, v10
  v_ldexp_f32 v96, v96, v10
  v_ldexp_f32 v97, v97, v10
  v_ldexp_f32 v98, v98, v10
  v_ldexp_f32 v99, v99, v10
  v_ldexp_f32 v100, v100, v10
  v_ldexp_f32 v101, v101, v10
  v_ldexp_f32 v102, v102, v10
  v_ldexp_f32 v103, v103, v10
  v_ldexp_f32 v104, v104, v10
  v_ldexp_f32 v105, v105, v10
  v_ldexp_f32 v106, v106, v10
  v_ldexp_f32 v107, v107, v10
  v_ldexp_f32 v108, v108, v10
  v_ldexp_f32 v109, v109, v10
  v_ldexp_f32 v110, v110, v10
  v_ldexp_f32 v111, v111, v10
  v_ldexp_f32 v112, v112, v10
  v_ldexp_f32 v113, v113, v10
  v_ldexp_f32 v114, v114, v10
  v_ldexp_f32 v115, v115, v10
  v_ldexp_f32 v116, v116, v10
  v_ldexp_f32 v117, v117, v10
  v_ldexp_f32 v118, v118, v10
  v_ldexp_f32 v119, v119, v10
  v_ldexp_f32 v3, v3, v10
  v_exp_f32 v120, v160
  v_exp_f32 v121, v161
  v_add_f32 v4, v3, v120
  v_exp_f32 v122, v162
  v_add_f32 v4, v4, v121
  v_cvt_pk_bf16_f32 v192, v120, v121
  v_exp_f32 v123, v163
  v_add_f32 v4, v4, v122
  v_exp_f32 v124, v164
  v_add_f32 v4, v4, v123
  v_cvt_pk_bf16_f32 v193, v122, v123
  v_exp_f32 v125, v165
  v_add_f32 v4, v4, v124
  v_exp_f32 v126, v166
  v_add_f32 v4, v4, v125
  v_cvt_pk_bf16_f32 v194, v124, v125
  v_exp_f32 v127, v167
  v_add_f32 v4, v4, v126
  v_exp_f32 v120, v168
  v_add_f32 v4, v4, v127
  v_cvt_pk_bf16_f32 v195, v126, v127
  v_exp_f32 v121, v169
  v_add_f32 v4, v4, v120
  v_exp_f32 v122, v170
  v_add_f32 v4, v4, v121
  v_cvt_pk_bf16_f32 v196, v120, v121
  v_exp_f32 v123, v171
  v_add_f32 v4, v4, v122
  v_exp_f32 v124, v172
  v_add_f32 v4, v4, v123
  v_cvt_pk_bf16_f32 v197, v122, v123
  v_exp_f32 v125, v173
  v_add_f32 v4, v4, v124
  v_exp_f32 v126, v174
  v_add_f32 v4, v4, v125
  v_cvt_pk_bf16_f32 v198, v124, v125
  v_exp_f32 v127, v175
  v_add_f32 v4, v4, v126
  v_add_f32 v4, v4, v127
  v_cvt_pk_bf16_f32 v199, v126, v127
  s_nop 1
  s_branch main_kernel_back_26
main_kernel_rare_27:
  s_nop 15
  s_nop 15
  v_log_f32 v11, v4
  v_max3_f32 v9, v176, v177, v178
  v_max3_f32 v9, v9, v179, v180
  v_max3_f32 v9, v9, v181, v182
  v_max3_f32 v9, v9, v183, v184
  v_max3_f32 v9, v9, v185, v186
  v_max3_f32 v9, v9, v187, v188
  v_max3_f32 v9, v9, v189, v190
  v_max_f32 v9, v9, v191
  v_max_f32 v9, v9, v11
  v_mov_b32 v12, v9
  s_nop 1
  v_permlane32_swap_b32 v9, v12
  s_nop 1
  v_max_f32 v9, v9, v12
  v_ceil_f32 v9, v9
  v_max_f32 v9, 0, v9
  v_sub_f32 v10, 0, v9
  v_cvt_i32_f32 v10, v10
  v_sub_f32 v176, v176, v9
  v_sub_f32 v177, v177, v9
  v_sub_f32 v178, v178, v9
  v_sub_f32 v179, v179, v9
  v_sub_f32 v180, v180, v9
  v_sub_f32 v181, v181, v9
  v_sub_f32 v182, v182, v9
  v_sub_f32 v183, v183, v9
  v_sub_f32 v184, v184, v9
  v_sub_f32 v185, v185, v9
  v_sub_f32 v186, v186, v9
  v_sub_f32 v187, v187, v9
  v_sub_f32 v188, v188, v9
  v_sub_f32 v189, v189, v9
  v_sub_f32 v190, v190, v9
  v_sub_f32 v191, v191, v9
  v_sub_f32 v160, v160, v9
  v_sub_f32 v161, v161, v9
  v_sub_f32 v162, v162, v9
  v_sub_f32 v163, v163, v9
  v_sub_f32 v164, v164, v9
  v_sub_f32 v165, v165, v9
  v_sub_f32 v166, v166, v9
  v_sub_f32 v167, v167, v9
  v_sub_f32 v168, v168, v9
  v_sub_f32 v169, v169, v9
  v_sub_f32 v170, v170, v9
  v_sub_f32 v171, v171, v9
  v_sub_f32 v172, v172, v9
  v_sub_f32 v173, v173, v9
  v_sub_f32 v174, v174, v9
  v_sub_f32 v175, v175, v9
  v_sub_f32 v208, v208, v9
  v_sub_f32 v209, v209, v9
  v_sub_f32 v210, v210, v9
  v_sub_f32 v211, v211, v9
  v_sub_f32 v212, v212, v9
  v_sub_f32 v213, v213, v9
  v_sub_f32 v214, v214, v9
  v_sub_f32 v215, v215, v9
  v_sub_f32 v216, v216, v9
  v_sub_f32 v217, v217, v9
  v_sub_f32 v218, v218, v9
  v_sub_f32 v219, v219, v9
  v_sub_f32 v220, v220, v9
  v_sub_f32 v221, v221, v9
  v_sub_f32 v222, v222, v9
  v_sub_f32 v223, v223, v9
  v_ldexp_f32 v56, v56, v10
  v_ldexp_f32 v57, v57, v10
  v_ldexp_f32 v58, v58, v10
  v_ldexp_f32 v59, v59, v10
  v_ldexp_f32 v60, v60, v10
  v_ldexp_f32 v61, v61, v10
  v_ldexp_f32 v62, v62, v10
  v_ldexp_f32 v63, v63, v10
  v_ldexp_f32 v64, v64, v10
  v_ldexp_f32 v65, v65, v10
  v_ldexp_f32 v66, v66, v10
  v_ldexp_f32 v67, v67, v10
  v_ldexp_f32 v68, v68, v10
  v_ldexp_f32 v69, v69, v10
  v_ldexp_f32 v70, v70, v10
  v_ldexp_f32 v71, v71, v10
  v_ldexp_f32 v72, v72, v10
  v_ldexp_f32 v73, v73, v10
  v_ldexp_f32 v74, v74, v10
  v_ldexp_f32 v75, v75, v10
  v_ldexp_f32 v76, v76, v10
  v_ldexp_f32 v77, v77, v10
  v_ldexp_f32 v78, v78, v10
  v_ldexp_f32 v79, v79, v10
  v_ldexp_f32 v80, v80, v10
  v_ldexp_f32 v81, v81, v10
  v_ldexp_f32 v82, v82, v10
  v_ldexp_f32 v83, v83, v10
  v_ldexp_f32 v84, v84, v10
  v_ldexp_f32 v85, v85, v10
  v_ldexp_f32 v86, v86, v10
  v_ldexp_f32 v87, v87, v10
  v_ldexp_f32 v88, v88, v10
  v_ldexp_f32 v89, v89, v10
  v_ldexp_f32 v90, v90, v10
  v_ldexp_f32 v91, v91, v10
  v_ldexp_f32 v92, v92, v10
  v_ldexp_f32 v93, v93, v10
  v_ldexp_f32 v94, v94, v10
  v_ldexp_f32 v95, v95, v10
  v_ldexp_f32 v96, v96, v10
  v_ldexp_f32 v97, v97, v10
  v_ldexp_f32 v98, v98, v10
  v_ldexp_f32 v99, v99, v10
  v_ldexp_f32 v100, v100, v10
  v_ldexp_f32 v101, v101, v10
  v_ldexp_f32 v102, v102, v10
  v_ldexp_f32 v103, v103, v10
  v_ldexp_f32 v104, v104, v10
  v_ldexp_f32 v105, v105, v10
  v_ldexp_f32 v106, v106, v10
  v_ldexp_f32 v107, v107, v10
  v_ldexp_f32 v108, v108, v10
  v_ldexp_f32 v109, v109, v10
  v_ldexp_f32 v110, v110, v10
  v_ldexp_f32 v111, v111, v10
  v_ldexp_f32 v112, v112, v10
  v_ldexp_f32 v113, v113, v10
  v_ldexp_f32 v114, v114, v10
  v_ldexp_f32 v115, v115, v10
  v_ldexp_f32 v116, v116, v10
  v_ldexp_f32 v117, v117, v10
  v_ldexp_f32 v118, v118, v10
  v_ldexp_f32 v119, v119, v10
  v_ldexp_f32 v4, v4, v10
  v_exp_f32 v120, v176
  v_exp_f32 v121, v177
  v_add_f32 v3, v4, v120
  v_exp_f32 v122, v178
  v_add_f32 v3, v3, v121
  v_cvt_pk_bf16_f32 v200, v120, v121
  v_exp_f32 v123, v179
  v_add_f32 v3, v3, v122
  v_exp_f32 v124, v180
  v_add_f32 v3, v3, v123
  v_cvt_pk_bf16_f32 v201, v122, v123
  v_exp_f32 v125, v181
  v_add_f32 v3, v3, v124
  v_exp_f32 v126, v182
  v_add_f32 v3, v3, v125
  v_cvt_pk_bf16_f32 v202, v124, v125
  v_exp_f32 v127, v183
  v_add_f32 v3, v3, v126
  v_exp_f32 v120, v184
  v_add_f32 v3, v3, v127
  v_cvt_pk_bf16_f32 v203, v126, v127
  v_exp_f32 v121, v185
  v_add_f32 v3, v3, v120
  v_exp_f32 v122, v186
  v_add_f32 v3, v3, v121
  v_cvt_pk_bf16_f32 v204, v120, v121
  v_exp_f32 v123, v187
  v_add_f32 v3, v3, v122
  v_exp_f32 v124, v188
  v_add_f32 v3, v3, v123
  v_cvt_pk_bf16_f32 v205, v122, v123
  v_exp_f32 v125, v189
  v_add_f32 v3, v3, v124
  v_exp_f32 v126, v190
  v_add_f32 v3, v3, v125
  v_cvt_pk_bf16_f32 v206, v124, v125
  v_exp_f32 v127, v191
  v_add_f32 v3, v3, v126
  v_add_f32 v3, v3, v127
  v_cvt_pk_bf16_f32 v207, v126, v127
  s_nop 1
  s_branch main_kernel_back_28
main_kernel_rare_29:
  s_nop 15
  s_nop 15
  v_log_f32 v11, v3
  v_max3_f32 v9, v160, v161, v162
  v_max3_f32 v9, v9, v163, v164
  v_max3_f32 v9, v9, v165, v166
  v_max3_f32 v9, v9, v167, v168
  v_max3_f32 v9, v9, v169, v170
  v_max3_f32 v9, v9, v171, v172
  v_max3_f32 v9, v9, v173, v174
  v_max_f32 v9, v9, v175
  v_max_f32 v9, v9, v11
  v_mov_b32 v12, v9
  s_nop 1
  v_permlane32_swap_b32 v9, v12
  s_nop 1
  v_max_f32 v9, v9, v12
  v_ceil_f32 v9, v9
  v_max_f32 v9, 0, v9
  v_sub_f32 v10, 0, v9
  v_cvt_i32_f32 v10, v10
  v_sub_f32 v160, v160, v9
  v_sub_f32 v161, v161, v9
  v_sub_f32 v162, v162, v9
  v_sub_f32 v163, v163, v9
  v_sub_f32 v164, v164, v9
  v_sub_f32 v165, v165, v9
  v_sub_f32 v166, v166, v9
  v_sub_f32 v167, v167, v9
  v_sub_f32 v168, v168, v9
  v_sub_f32 v169, v169, v9
  v_sub_f32 v170, v170, v9
  v_sub_f32 v171, v171, v9
  v_sub_f32 v172, v172, v9
  v_sub_f32 v173, v173, v9
  v_sub_f32 v174, v174, v9
  v_sub_f32 v175, v175, v9
  v_sub_f32 v176, v176, v9
  v_sub_f32 v177, v177, v9
  v_sub_f32 v178, v178, v9
  v_sub_f32 v179, v179, v9
  v_sub_f32 v180, v180, v9
  v_sub_f32 v181, v181, v9
  v_sub_f32 v182, v182, v9
  v_sub_f32 v183, v183, v9
  v_sub_f32 v184, v184, v9
  v_sub_f32 v185, v185, v9
  v_sub_f32 v186, v186, v9
  v_sub_f32 v187, v187, v9
  v_sub_f32 v188, v188, v9
  v_sub_f32 v189, v189, v9
  v_sub_f32 v190, v190, v9
  v_sub_f32 v191, v191, v9
  v_sub_f32 v208, v208, v9
  v_sub_f32 v209, v209, v9
  v_sub_f32 v210, v210, v9
  v_sub_f32 v211, v211, v9
  v_sub_f32 v212, v212, v9
  v_sub_f32 v213, v213, v9
  v_sub_f32 v214, v214, v9
  v_sub_f32 v215, v215, v9
  v_sub_f32 v216, v216, v9
  v_sub_f32 v217, v217, v9
  v_sub_f32 v218, v218, v9
  v_sub_f32 v219, v219, v9
  v_sub_f32 v220, v220, v9
  v_sub_f32 v221, v221, v9
  v_sub_f32 v222, v222, v9
  v_sub_f32 v223, v223, v9
  v_ldexp_f32 v56, v56, v10
  v_ldexp_f32 v57, v57, v10
  v_ldexp_f32 v58, v58, v10
  v_ldexp_f32 v59, v59, v10
  v_ldexp_f32 v60, v60, v10
  v_ldexp_f32 v61, v61, v10
  v_ldexp_f32 v62, v62, v10
  v_ldexp_f32 v63, v63, v10
  v_ldexp_f32 v64, v64, v10
  v_ldexp_f32 v65, v65, v10
  v_ldexp_f32 v66, v66, v10
  v_ldexp_f32 v67, v67, v10
  v_ldexp_f32 v68, v68, v10
  v_ldexp_f32 v69, v69, v10
  v_ldexp_f32 v70, v70, v10
  v_ldexp_f32 v71, v71, v10
  v_ldexp_f32 v72, v72, v10
  v_ldexp_f32 v73, v73, v10
  v_ldexp_f32 v74, v74, v10
  v_ldexp_f32 v75, v75, v10
  v_ldexp_f32 v76, v76, v10
  v_ldexp_f32 v77, v77, v10
  v_ldexp_f32 v78, v78, v10
  v_ldexp_f32 v79, v79, v10
  v_ldexp_f32 v80, v80, v10
  v_ldexp_f32 v81, v81, v10
  v_ldexp_f32 v82, v82, v10
  v_ldexp_f32 v83, v83, v10
  v_ldexp_f32 v84, v84, v10
  v_ldexp_f32 v85, v85, v10
  v_ldexp_f32 v86, v86, v10
  v_ldexp_f32 v87, v87, v10
  v_ldexp_f32 v88, v88, v10
  v_ldexp_f32 v89, v89, v10
  v_ldexp_f32 v90, v90, v10
  v_ldexp_f32 v91, v91, v10
  v_ldexp_f32 v92, v92, v10
  v_ldexp_f32 v93, v93, v10
  v_ldexp_f32 v94, v94, v10
  v_ldexp_f32 v95, v95, v10
  v_ldexp_f32 v96, v96, v10
  v_ldexp_f32 v97, v97, v10
  v_ldexp_f32 v98, v98, v10
  v_ldexp_f32 v99, v99, v10
  v_ldexp_f32 v100, v100, v10
  v_ldexp_f32 v101, v101, v10
  v_ldexp_f32 v102, v102, v10
  v_ldexp_f32 v103, v103, v10
  v_ldexp_f32 v104, v104, v10
  v_ldexp_f32 v105, v105, v10
  v_ldexp_f32 v106, v106, v10
  v_ldexp_f32 v107, v107, v10
  v_ldexp_f32 v108, v108, v10
  v_ldexp_f32 v109, v109, v10
  v_ldexp_f32 v110, v110, v10
  v_ldexp_f32 v111, v111, v10
  v_ldexp_f32 v112, v112, v10
  v_ldexp_f32 v113, v113, v10
  v_ldexp_f32 v114, v114, v10
  v_ldexp_f32 v115, v115, v10
  v_ldexp_f32 v116, v116, v10
  v_ldexp_f32 v117, v117, v10
  v_ldexp_f32 v118, v118, v10
  v_ldexp_f32 v119, v119, v10
  v_ldexp_f32 v3, v3, v10
  v_exp_f32 v120, v160
  v_exp_f32 v121, v161
  v_add_f32 v4, v3, v120
  v_exp_f32 v122, v162
  v_add_f32 v4, v4, v121
  v_cvt_pk_bf16_f32 v192, v120, v121
  v_exp_f32 v123, v163
  v_add_f32 v4, v4, v122
  v_exp_f32 v124, v164
  v_add_f32 v4, v4, v123
  v_cvt_pk_bf16_f32 v193, v122, v123
  v_exp_f32 v125, v165
  v_add_f32 v4, v4, v124
  v_exp_f32 v126, v166
  v_add_f32 v4, v4, v125
  v_cvt_pk_bf16_f32 v194, v124, v125
  v_exp_f32 v127, v167
  v_add_f32 v4, v4, v126
  v_exp_f32 v120, v168
  v_add_f32 v4, v4, v127
  v_cvt_pk_bf16_f32 v195, v126, v127
  v_exp_f32 v121, v169
  v_add_f32 v4, v4, v120
  v_exp_f32 v122, v170
  v_add_f32 v4, v4, v121
  v_cvt_pk_bf16_f32 v196, v120, v121
  v_exp_f32 v123, v171
  v_add_f32 v4, v4, v122
  v_exp_f32 v124, v172
  v_add_f32 v4, v4, v123
  v_cvt_pk_bf16_f32 v197, v122, v123
  v_exp_f32 v125, v173
  v_add_f32 v4, v4, v124
  v_exp_f32 v126, v174
  v_add_f32 v4, v4, v125
  v_cvt_pk_bf16_f32 v198, v124, v125
  v_exp_f32 v127, v175
  v_add_f32 v4, v4, v126
  v_add_f32 v4, v4, v127
  v_cvt_pk_bf16_f32 v199, v126, v127
  s_nop 1
  s_branch main_kernel_back_30
main_kernel_rare_31:
  s_nop 15
  s_nop 15
  v_log_f32 v11, v4
  v_max3_f32 v9, v176, v177, v178
  v_max3_f32 v9, v9, v179, v180
  v_max3_f32 v9, v9, v181, v182
  v_max3_f32 v9, v9, v183, v184
  v_max3_f32 v9, v9, v185, v186
  v_max3_f32 v9, v9, v187, v188
  v_max3_f32 v9, v9, v189, v190
  v_max_f32 v9, v9, v191
  v_max_f32 v9, v9, v11
  v_mov_b32 v12, v9
  s_nop 1
  v_permlane32_swap_b32 v9, v12
  s_nop 1
  v_max_f32 v9, v9, v12
  v_ceil_f32 v9, v9
  v_max_f32 v9, 0, v9
  v_sub_f32 v10, 0, v9
  v_cvt_i32_f32 v10, v10
  v_sub_f32 v176, v176, v9
  v_sub_f32 v177, v177, v9
  v_sub_f32 v178, v178, v9
  v_sub_f32 v179, v179, v9
  v_sub_f32 v180, v180, v9
  v_sub_f32 v181, v181, v9
  v_sub_f32 v182, v182, v9
  v_sub_f32 v183, v183, v9
  v_sub_f32 v184, v184, v9
  v_sub_f32 v185, v185, v9
  v_sub_f32 v186, v186, v9
  v_sub_f32 v187, v187, v9
  v_sub_f32 v188, v188, v9
  v_sub_f32 v189, v189, v9
  v_sub_f32 v190, v190, v9
  v_sub_f32 v191, v191, v9
  v_sub_f32 v160, v160, v9
  v_sub_f32 v161, v161, v9
  v_sub_f32 v162, v162, v9
  v_sub_f32 v163, v163, v9
  v_sub_f32 v164, v164, v9
  v_sub_f32 v165, v165, v9
  v_sub_f32 v166, v166, v9
  v_sub_f32 v167, v167, v9
  v_sub_f32 v168, v168, v9
  v_sub_f32 v169, v169, v9
  v_sub_f32 v170, v170, v9
  v_sub_f32 v171, v171, v9
  v_sub_f32 v172, v172, v9
  v_sub_f32 v173, v173, v9
  v_sub_f32 v174, v174, v9
  v_sub_f32 v175, v175, v9
  v_sub_f32 v208, v208, v9
  v_sub_f32 v209, v209, v9
  v_sub_f32 v210, v210, v9
  v_sub_f32 v211, v211, v9
  v_sub_f32 v212, v212, v9
  v_sub_f32 v213, v213, v9
  v_sub_f32 v214, v214, v9
  v_sub_f32 v215, v215, v9
  v_sub_f32 v216, v216, v9
  v_sub_f32 v217, v217, v9
  v_sub_f32 v218, v218, v9
  v_sub_f32 v219, v219, v9
  v_sub_f32 v220, v220, v9
  v_sub_f32 v221, v221, v9
  v_sub_f32 v222, v222, v9
  v_sub_f32 v223, v223, v9
  v_ldexp_f32 v56, v56, v10
  v_ldexp_f32 v57, v57, v10
  v_ldexp_f32 v58, v58, v10
  v_ldexp_f32 v59, v59, v10
  v_ldexp_f32 v60, v60, v10
  v_ldexp_f32 v61, v61, v10
  v_ldexp_f32 v62, v62, v10
  v_ldexp_f32 v63, v63, v10
  v_ldexp_f32 v64, v64, v10
  v_ldexp_f32 v65, v65, v10
  v_ldexp_f32 v66, v66, v10
  v_ldexp_f32 v67, v67, v10
  v_ldexp_f32 v68, v68, v10
  v_ldexp_f32 v69, v69, v10
  v_ldexp_f32 v70, v70, v10
  v_ldexp_f32 v71, v71, v10
  v_ldexp_f32 v72, v72, v10
  v_ldexp_f32 v73, v73, v10
  v_ldexp_f32 v74, v74, v10
  v_ldexp_f32 v75, v75, v10
  v_ldexp_f32 v76, v76, v10
  v_ldexp_f32 v77, v77, v10
  v_ldexp_f32 v78, v78, v10
  v_ldexp_f32 v79, v79, v10
  v_ldexp_f32 v80, v80, v10
  v_ldexp_f32 v81, v81, v10
  v_ldexp_f32 v82, v82, v10
  v_ldexp_f32 v83, v83, v10
  v_ldexp_f32 v84, v84, v10
  v_ldexp_f32 v85, v85, v10
  v_ldexp_f32 v86, v86, v10
  v_ldexp_f32 v87, v87, v10
  v_ldexp_f32 v88, v88, v10
  v_ldexp_f32 v89, v89, v10
  v_ldexp_f32 v90, v90, v10
  v_ldexp_f32 v91, v91, v10
  v_ldexp_f32 v92, v92, v10
  v_ldexp_f32 v93, v93, v10
  v_ldexp_f32 v94, v94, v10
  v_ldexp_f32 v95, v95, v10
  v_ldexp_f32 v96, v96, v10
  v_ldexp_f32 v97, v97, v10
  v_ldexp_f32 v98, v98, v10
  v_ldexp_f32 v99, v99, v10
  v_ldexp_f32 v100, v100, v10
  v_ldexp_f32 v101, v101, v10
  v_ldexp_f32 v102, v102, v10
  v_ldexp_f32 v103, v103, v10
  v_ldexp_f32 v104, v104, v10
  v_ldexp_f32 v105, v105, v10
  v_ldexp_f32 v106, v106, v10
  v_ldexp_f32 v107, v107, v10
  v_ldexp_f32 v108, v108, v10
  v_ldexp_f32 v109, v109, v10
  v_ldexp_f32 v110, v110, v10
  v_ldexp_f32 v111, v111, v10
  v_ldexp_f32 v112, v112, v10
  v_ldexp_f32 v113, v113, v10
  v_ldexp_f32 v114, v114, v10
  v_ldexp_f32 v115, v115, v10
  v_ldexp_f32 v116, v116, v10
  v_ldexp_f32 v117, v117, v10
  v_ldexp_f32 v118, v118, v10
  v_ldexp_f32 v119, v119, v10
  v_ldexp_f32 v4, v4, v10
  v_exp_f32 v120, v176
  v_exp_f32 v121, v177
  v_add_f32 v3, v4, v120
  v_exp_f32 v122, v178
  v_add_f32 v3, v3, v121
  v_cvt_pk_bf16_f32 v200, v120, v121
  v_exp_f32 v123, v179
  v_add_f32 v3, v3, v122
  v_exp_f32 v124, v180
  v_add_f32 v3, v3, v123
  v_cvt_pk_bf16_f32 v201, v122, v123
  v_exp_f32 v125, v181
  v_add_f32 v3, v3, v124
  v_exp_f32 v126, v182
  v_add_f32 v3, v3, v125
  v_cvt_pk_bf16_f32 v202, v124, v125
  v_exp_f32 v127, v183
  v_add_f32 v3, v3, v126
  v_exp_f32 v120, v184
  v_add_f32 v3, v3, v127
  v_cvt_pk_bf16_f32 v203, v126, v127
  v_exp_f32 v121, v185
  v_add_f32 v3, v3, v120
  v_exp_f32 v122, v186
  v_add_f32 v3, v3, v121
  v_cvt_pk_bf16_f32 v204, v120, v121
  v_exp_f32 v123, v187
  v_add_f32 v3, v3, v122
  v_exp_f32 v124, v188
  v_add_f32 v3, v3, v123
  v_cvt_pk_bf16_f32 v205, v122, v123
  v_exp_f32 v125, v189
  v_add_f32 v3, v3, v124
  v_exp_f32 v126, v190
  v_add_f32 v3, v3, v125
  v_cvt_pk_bf16_f32 v206, v124, v125
  v_exp_f32 v127, v191
  v_add_f32 v3, v3, v126
  v_add_f32 v3, v3, v127
  v_cvt_pk_bf16_f32 v207, v126, v127
  s_nop 1
  s_branch main_kernel_back_32
main_kernel_short:
  s_mov_b32 s46, 0
  v_mov_b32 v14, v20
  ds_read_b128 v[24:27], v14 offset:0
  ds_read_b128 v[28:31], v14 offset:1024
  ds_read_b128 v[32:35], v14 offset:2048
  ds_read_b128 v[36:39], v14 offset:3072
  ds_read_b128 v[40:43], v14 offset:4096
  ds_read_b128 v[44:47], v14 offset:5120
  ds_read_b128 v[48:51], v14 offset:6144
  ds_read_b128 v[52:55], v14 offset:7168
  v_mov_b32 v3, 0
  s_waitcnt lgkmcnt(7)
  v_mfma_f32_32x32x16_bf16 v[160:175], v[24:27], v[128:131], 0
  v_mov_b32 v56, 0
  v_mov_b32 v57, 0
  v_mov_b32 v58, 0
  v_mov_b32 v59, 0
  v_mov_b32 v60, 0
  v_mov_b32 v61, 0
  v_mov_b32 v62, 0
  v_mov_b32 v63, 0
  s_waitcnt lgkmcnt(6)
  v_mfma_f32_32x32x16_bf16 v[160:175], v[28:31], v[132:135], v[160:175]
  v_mov_b32 v64, 0
  v_mov_b32 v65, 0
  v_mov_b32 v66, 0
  v_mov_b32 v67, 0
  v_mov_b32 v68, 0
  v_mov_b32 v69, 0
  v_mov_b32 v70, 0
  v_mov_b32 v71, 0
  s_waitcnt lgkmcnt(5)
  v_mfma_f32_32x32x16_bf16 v[160:175], v[32:35], v[136:139], v[160:175]
  v_mov_b32 v72, 0
  v_mov_b32 v73, 0
  v_mov_b32 v74, 0
  v_mov_b32 v75, 0
  v_mov_b32 v76, 0
  v_mov_b32 v77, 0
  v_mov_b32 v78, 0
  v_mov_b32 v79, 0
  s_waitcnt lgkmcnt(4)
  v_mfma_f32_32x32x16_bf16 v[160:175], v[36:39], v[140:143], v[160:175]
  v_mov_b32 v80, 0
  v_mov_b32 v81, 0
  v_mov_b32 v82, 0
  v_mov_b32 v83, 0
  v_mov_b32 v84, 0
  v_mov_b32 v85, 0
  v_mov_b32 v86, 0
  v_mov_b32 v87, 0
  s_waitcnt lgkmcnt(3)
  v_mfma_f32_32x32x16_bf16 v[160:175], v[40:43], v[144:147], v[160:175]
  v_mov_b32 v88, 0
  v_mov_b32 v89, 0
  v_mov_b32 v90, 0
  v_mov_b32 v91, 0
  v_mov_b32 v92, 0
  v_mov_b32 v93, 0
  v_mov_b32 v94, 0
  v_mov_b32 v95, 0
  s_waitcnt lgkmcnt(2)
  v_mfma_f32_32x32x16_bf16 v[160:175], v[44:47], v[148:151], v[160:175]
  v_mov_b32 v96, 0
  v_mov_b32 v97, 0
  v_mov_b32 v98, 0
  v_mov_b32 v99, 0
  v_mov_b32 v100, 0
  v_mov_b32 v101, 0
  v_mov_b32 v102, 0
  v_mov_b32 v103, 0
  s_waitcnt lgkmcnt(1)
  v_mfma_f32_32x32x16_bf16 v[160:175], v[48:51], v[152:155], v[160:175]
  v_mov_b32 v104, 0
  v_mov_b32 v105, 0
  v_mov_b32 v106, 0
  v_mov_b32 v107, 0
  v_mov_b32 v108, 0
  v_mov_b32 v109, 0
  v_mov_b32 v110, 0
  v_mov_b32 v111, 0
  s_waitcnt lgkmcnt(0)
  v_mfma_f32_32x32x16_bf16 v[160:175], v[52:55], v[156:159], v[160:175]
  v_mov_b32 v112, 0
  v_mov_b32 v113, 0
  v_mov_b32 v114, 0
  v_mov_b32 v115, 0
  v_mov_b32 v116, 0
  v_mov_b32 v117, 0
  v_mov_b32 v118, 0
  v_mov_b32 v119, 0
  s_mov_b32 s46, 32768
  s_sub_u32 s61, s40, 1
  ds_read_b128 v[24:27], v14 offset:16384
  ds_read_b128 v[28:31], v14 offset:17408
  ds_read_b128 v[32:35], v14 offset:18432
  ds_read_b128 v[36:39], v14 offset:19456
  ds_read_b128 v[40:43], v14 offset:20480
  ds_read_b128 v[44:47], v14 offset:21504
  ds_read_b128 v[48:51], v14 offset:22528
  s_nop 15
  s_cmp_lg_u32 s40, 0
  s_cbranch_scc1 main_kernel_s_nomask0
  v_cmp_ge_i32 s[64:65], v7, 0
  v_cmp_ge_i32 s[66:67], v7, 1
  v_cmp_ge_i32 s[68:69], v7, 2
  v_cmp_ge_i32 s[70:71], v7, 3
  v_cmp_ge_i32 s[72:73], v7, 8
  v_cmp_ge_i32 s[74:75], v7, 9
  v_cmp_ge_i32 s[76:77], v7, 10
  v_cmp_ge_i32 s[78:79], v7, 11
  v_cmp_ge_i32 s[80:81], v7, 16
  v_cmp_ge_i32 s[82:83], v7, 17
  v_cmp_ge_i32 s[84:85], v7, 18
  v_cmp_ge_i32 s[86:87], v7, 19
  v_cmp_ge_i32 s[88:89], v7, 24
  v_cmp_ge_i32 s[90:91], v7, 25
  v_cmp_ge_i32 s[92:93], v7, 26
  v_cmp_ge_i32 s[94:95], v7, 27
  v_cndmask_b32 v160, v8, v160, s[64:65]
  v_cndmask_b32 v161, v8, v161, s[66:67]
  v_cndmask_b32 v162, v8, v162, s[68:69]
  v_cndmask_b32 v163, v8, v163, s[70:71]
  v_cndmask_b32 v164, v8, v164, s[72:73]
  v_cndmask_b32 v165, v8, v165, s[74:75]
  v_cndmask_b32 v166, v8, v166, s[76:77]
  v_cndmask_b32 v167, v8, v167, s[78:79]
  v_cndmask_b32 v168, v8, v168, s[80:81]
  v_cndmask_b32 v169, v8, v169, s[82:83]
  v_cndmask_b32 v170, v8, v170, s[84:85]
  v_cndmask_b32 v171, v8, v171, s[86:87]
  v_cndmask_b32 v172, v8, v172, s[88:89]
  v_cndmask_b32 v173, v8, v173, s[90:91]
  v_cndmask_b32 v174, v8, v174, s[92:93]
  v_cndmask_b32 v175, v8, v175, s[94:95]
main_kernel_s_nomask0:
  v_max3_f32 v9, v160, v161, v162
  v_max3_f32 v9, v9, v163, v164
  v_max3_f32 v9, v9, v165, v166
  v_max3_f32 v9, v9, v167, v168
  v_max3_f32 v9, v9, v169, v170
  v_max3_f32 v9, v9, v171, v172
  v_max3_f32 v9, v9, v173, v174
  v_max_f32 v9, v9, v175
  v_mov_b32 v12, v9
  s_nop 1
  v_permlane32_swap_b32 v9, v12
  s_nop 1
  v_max_f32 v9, v9, v12
  v_ceil_f32 v9, v9
  v_sub_f32 v160, v160, v9
  v_sub_f32 v161, v161, v9
  v_sub_f32 v162, v162, v9
  v_sub_f32 v163, v163, v9
  v_sub_f32 v164, v164, v9
  v_sub_f32 v165, v165, v9
  v_sub_f32 v166, v166, v9
  v_sub_f32 v167, v167, v9
  v_sub_f32 v168, v168, v9
  v_sub_f32 v169, v169, v9
  v_sub_f32 v170, v170, v9
  v_sub_f32 v171, v171, v9
  v_sub_f32 v172, v172, v9
  v_sub_f32 v173, v173, v9
  v_sub_f32 v174, v174, v9
  v_sub_f32 v175, v175, v9
  v_sub_f32 v208, 0, v9
  v_sub_f32 v209, 0, v9
  v_sub_f32 v210, 0, v9
  v_sub_f32 v211, 0, v9
  v_sub_f32 v212, 0, v9
  v_sub_f32 v213, 0, v9
  v_sub_f32 v214, 0, v9
  v_sub_f32 v215, 0, v9
  v_sub_f32 v216, 0, v9
  v_sub_f32 v217, 0, v9
  v_sub_f32 v218, 0, v9
  v_sub_f32 v219, 0, v9
  v_sub_f32 v220, 0, v9
  v_sub_f32 v221, 0, v9
  v_sub_f32 v222, 0, v9
  v_sub_f32 v223, 0, v9
  s_mov_b32 s28, -1
  s_waitcnt vmcnt(8)
  s_barrier
  s_waitcnt lgkmcnt(5)
  v_mfma_f32_32x32x16_bf16 v[176:191], v[24:27], v[128:131], v[208:223]
  ds_read_b128 v[52:55], v14 offset:23552
  v_add_u32 v14, s46, v20
  s_mov_b32 m0, s47
  v_exp_f32 v120, v160
  v_exp_f32 v121, v161
  v_add_f32 v4, v3, v120
  v_exp_f32 v122, v162
  v_add_f32 v4, v4, v121
  v_cvt_pk_bf16_f32 v192, v120, v121
  v_exp_f32 v123, v163
  v_add_f32 v4, v4, v122
  v_mfma_f32_32x32x16_bf16 v[176:191], v[28:31], v[132:135], v[176:191]
  ds_read_b128 v[24:27], v14 offset:0
  buffer_load_dwordx4 v20, s[8:11], s48 offen sc1 lds
  v_exp_f32 v124, v164
  v_add_f32 v4, v4, v123
  v_cvt_pk_bf16_f32 v193, v122, v123
  s_waitcnt lgkmcnt(5)
  v_mfma_f32_32x32x16_bf16 v[176:191], v[32:35], v[136:139], v[176:191]
  ds_read_b128 v[28:31], v14 offset:1024
  s_add_u32 s46, s46, 32768
  s_and_b32 s46, s46, 0x1ffff
  v_exp_f32 v125, v165
  v_add_f32 v4, v4, v124
  v_exp_f32 v126, v166
  v_add_f32 v4, v4, v125
  v_cvt_pk_bf16_f32 v194, v124, v125
  v_exp_f32 v127, v167
  v_add_f32 v4, v4, v126
  v_exp_f32 v120, v168
  v_mfma_f32_32x32x16_bf16 v[176:191], v[36:39], v[140:143], v[176:191]
  ds_read_b128 v[32:35], v14 offset:2048
  buffer_load_dwordx4 v20, s[8:11], s48 offen offset:1024 sc1 lds
  v_add_f32 v4, v4, v127
  v_cvt_pk_bf16_f32 v195, v126, v127
  v_exp_f32 v121, v169
  s_waitcnt lgkmcnt(5)
  v_mfma_f32_32x32x16_bf16 v[176:191], v[40:43], v[144:147], v[176:191]
  ds_read_b128 v[36:39], v14 offset:3072
  s_add_u32 s28, s28, 2
  v_add_f32 v4, v4, v120
  v_exp_f32 v122, v170
  v_add_f32 v4, v4, v121
  v_cvt_pk_bf16_f32 v196, v120, v121
  v_exp_f32 v123, v171
  v_add_f32 v4, v4, v122
  v_exp_f32 v124, v172
  v_add_f32 v4, v4, v123
  v_cvt_pk_bf16_f32 v197, v122, v123
  v_exp_f32 v125, v173
  v_add_f32 v4, v4, v124
  v_exp_f32 v126, v174
  v_mfma_f32_32x32x16_bf16 v[176:191], v[44:47], v[148:151], v[176:191]
  ds_read_b128 v[40:43], v14 offset:4096
  buffer_load_dwordx4 v20, s[8:11], s48 offen offset:2048 sc1 lds
  v_add_f32 v4, v4, v125
  v_cvt_pk_bf16_f32 v198, v124, v125
  v_exp_f32 v127, v175
  s_waitcnt lgkmcnt(5)
  v_mfma_f32_32x32x16_bf16 v[176:191], v[48:51], v[152:155], v[176:191]
  ds_read_b128 v[44:47], v14 offset:5120
  buffer_load_dwordx4 v20, s[8:11], s48 offen offset:3072 sc1 lds
  v_add_f32 v4, v4, v126
  v_add_f32 v4, v4, v127
  v_cvt_pk_bf16_f32 v199, v126, v127
  s_cmp_eq_u32 s28, s40
  v_mfma_f32_32x32x16_bf16 v[176:191], v[52:55], v[156:159], v[176:191]
  ds_read_b128 v[48:51], v14 offset:6144
  s_cbranch_scc1 main_kernel_s_fin1
  s_cmp_eq_u32 s40, 0
  s_cbranch_scc1 main_kernel_s_t0
  s_branch main_kernel_s_odd
  .p2align 6
main_kernel_s_loop:
  s_waitcnt lgkmcnt(5)
  v_mfma_f32_32x32x16_bf16 v[176:191], v[24:27], v[128:131], v[208:223]
  ds_read_b128 v[52:55], v14 offset:23552
  v_exp_f32 v120, v160
  v_exp_f32 v121, v161
  s_waitcnt vmcnt(8)
  s_barrier
  v_add_u32 v14, s46, v20
  v_mfma_f32_32x32x16_bf16 v[176:191], v[28:31], v[132:135], v[176:191]
  ds_read_b128 v[24:27], v14 offset:8192
  s_mov_b32 m0, s47
  v_add_f32 v4, v3, v120
  v_exp_f32 v122, v162
  s_waitcnt lgkmcnt(5)
  v_mfma_f32_32x32x16_bf16 v[176:191], v[32:35], v[136:139], v[176:191]
  ds_read_b128 v[28:31], v14 offset:9216
  s_add_u32 s46, s46, 32768
  s_and_b32 s46, s46, 0x1ffff
  v_add_f32 v4, v4, v121
  v_cvt_pk_bf16_f32 v192, v120, v121
  v_exp_f32 v123, v163
  v_mfma_f32_32x32x16_bf16 v[176:191], v[36:39], v[140:143], v[176:191]
  ds_read_b128 v[32:35], v14 offset:10240
  buffer_load_dwordx4 v20, s[8:11], s48 offen sc1 lds
  v_add_f32 v4, v4, v122
  s_waitcnt lgkmcnt(5)
  v_mfma_f32_32x32x16_bf16 v[176:191], v[40:43], v[144:147], v[176:191]
  ds_read_b128 v[36:39], v14 offset:11264
  s_add_u32 s28, s28, 2
  v_exp_f32 v124, v164
  v_add_f32 v4, v4, v123
  v_cvt_pk_bf16_f32 v193, v122, v123
  v_mfma_f32_32x32x16_bf16 v[176:191], v[44:47], v[148:151], v[176:191]
  ds_read_b128 v[40:43], v14 offset:12288
  v_exp_f32 v125, v165
  v_add_f32 v4, v4, v124
  v_exp_f32 v126, v166
  s_waitcnt lgkmcnt(5)
  v_mfma_f32_32x32x16_bf16 v[176:191], v[48:51], v[152:155], v[176:191]
  ds_read_b128 v[44:47], v14 offset:13312
  buffer_load_dwordx4 v20, s[8:11], s48 offen offset:1024 sc1 lds
  v_add_f32 v4, v4, v125
  v_cvt_pk_bf16_f32 v194, v124, v125
  v_mfma_f32_32x32x16_bf16 v[176:191], v[52:55], v[156:159], v[176:191]
  ds_read_b128 v[48:51], v14 offset:14336
  v_exp_f32 v127, v167
  v_add_f32 v4, v4, v126
  v_exp_f32 v120, v168
  s_waitcnt lgkmcnt(5)
  v_mfma_f32_32x32x16_bf16 v[56:71], v[24:27], v[200:203], v[56:71]
  ds_read_b128 v[52:55], v14 offset:15360
  v_add_f32 v4, v4, v127
  v_cvt_pk_bf16_f32 v195, v126, v127
  v_exp_f32 v121, v169
  v_add_f32 v4, v4, v120
  v_mfma_f32_32x32x16_bf16 v[56:71], v[28:31], v[204:207], v[56:71]
  ds_read_b128 v[24:27], v14 offset:0
  buffer_load_dwordx4 v20, s[8:11], s48 offen offset:2048 sc1 lds
  v_exp_f32 v122, v170
  s_waitcnt lgkmcnt(5)
  v_mfma_f32_32x32x16_bf16 v[72:87], v[32:35], v[200:203], v[72:87]
  ds_read_b128 v[28:31], v14 offset:1024
  v_add_f32 v4, v4, v121
  v_cvt_pk_bf16_f32 v196, v120, v121
  v_exp_f32 v123, v171
  v_add_f32 v4, v4, v122
  v_mfma_f32_32x32x16_bf16 v[72:87], v[36:39], v[204:207], v[72:87]
  ds_read_b128 v[32:35], v14 offset:2048
  v_exp_f32 v124, v172
  v_add_f32 v4, v4, v123
  v_cvt_pk_bf16_f32 v197, v122, v123
  v_exp_f32 v125, v173
  s_waitcnt lgkmcnt(5)
  v_mfma_f32_32x32x16_bf16 v[88:103], v[40:43], v[200:203], v[88:103]
  ds_read_b128 v[36:39], v14 offset:3072
  buffer_load_dwordx4 v20, s[8:11], s48 offen offset:3072 sc1 lds
  v_add_f32 v4, v4, v124
  v_mfma_f32_32x32x16_bf16 v[88:103], v[44:47], v[204:207], v[88:103]
  ds_read_b128 v[40:43], v14 offset:4096
  v_exp_f32 v126, v174
  v_add_f32 v4, v4, v125
  v_cvt_pk_bf16_f32 v198, v124, v125
  v_exp_f32 v127, v175
  s_waitcnt lgkmcnt(5)
  v_mfma_f32_32x32x16_bf16 v[104:119], v[48:51], v[200:203], v[104:119]
  ds_read_b128 v[44:47], v14 offset:5120
  v_add_f32 v4, v4, v126
  v_add_f32 v4, v4, v127
  v_cvt_pk_bf16_f32 v199, v126, v127
  v_cmp_nge_f32 vcc, s31, v4
  s_cmp_eq_u32 s28, s40
  v_mfma_f32_32x32x16_bf16 v[104:119], v[52:55], v[204:207], v[104:119]
  ds_read_b128 v[48:51], v14 offset:6144
  s_cbranch_vccnz main_kernel_rare_33
main_kernel_back_34:
  s_cbranch_scc1 main_kernel_s_fin1
main_kernel_s_odd:
  s_waitcnt lgkmcnt(5)
  v_mfma_f32_32x32x16_bf16 v[160:175], v[24:27], v[128:131], v[208:223]
  ds_read_b128 v[52:55], v14 offset:7168
  v_exp_f32 v120, v176
  v_exp_f32 v121, v177
  v_add_f32 v3, v4, v120
  v_mfma_f32_32x32x16_bf16 v[160:175], v[28:31], v[132:135], v[160:175]
  ds_read_b128 v[24:27], v14 offset:24576
  s_add_u32 s49, s48, 4096
  s_add_u32 m0, s47, 4096
  v_exp_f32 v122, v178
  v_add_f32 v3, v3, v121
  s_waitcnt lgkmcnt(5)
  v_mfma_f32_32x32x16_bf16 v[160:175], v[32:35], v[136:139], v[160:175]
  ds_read_b128 v[28:31], v14 offset:25600
  v_cvt_pk_bf16_f32 v200, v120, v121
  v_exp_f32 v123, v179
  v_add_f32 v3, v3, v122
  v_exp_f32 v124, v180
  v_mfma_f32_32x32x16_bf16 v[160:175], v[36:39], v[140:143], v[160:175]
  ds_read_b128 v[32:35], v14 offset:26624
  buffer_load_dwordx4 v20, s[8:11], s49 offen sc1 lds
  v_add_f32 v3, v3, v123
  s_waitcnt lgkmcnt(5)
  v_mfma_f32_32x32x16_bf16 v[160:175], v[40:43], v[144:147], v[160:175]
  ds_read_b128 v[36:39], v14 offset:27648
  v_cvt_pk_bf16_f32 v201, v122, v123
  v_exp_f32 v125, v181
  v_add_f32 v3, v3, v124
  v_exp_f32 v126, v182
  v_mfma_f32_32x32x16_bf16 v[160:175], v[44:47], v[148:151], v[160:175]
  ds_read_b128 v[40:43], v14 offset:28672
  v_add_f32 v3, v3, v125
  v_cvt_pk_bf16_f32 v202, v124, v125
  v_exp_f32 v127, v183
  s_waitcnt lgkmcnt(5)
  v_mfma_f32_32x32x16_bf16 v[160:175], v[48:51], v[152:155], v[160:175]
  ds_read_b128 v[44:47], v14 offset:29696
  buffer_load_dwordx4 v20, s[8:11], s49 offen offset:1024 sc1 lds
  v_add_f32 v3, v3, v126
  v_exp_f32 v120, v184
  v_mfma_f32_32x32x16_bf16 v[160:175], v[52:55], v[156:159], v[160:175]
  ds_read_b128 v[48:51], v14 offset:30720
  v_add_f32 v3, v3, v127
  v_cvt_pk_bf16_f32 v203, v126, v127
  v_exp_f32 v121, v185
  s_waitcnt lgkmcnt(5)
  v_mfma_f32_32x32x16_bf16 v[56:71], v[24:27], v[192:195], v[56:71]
  ds_read_b128 v[52:55], v14 offset:31744
  v_add_f32 v3, v3, v120
  v_exp_f32 v122, v186
  v_add_f32 v3, v3, v121
  v_cvt_pk_bf16_f32 v204, v120, v121
  v_mfma_f32_32x32x16_bf16 v[56:71], v[28:31], v[196:199], v[56:71]
  ds_read_b128 v[24:27], v14 offset:16384
  buffer_load_dwordx4 v20, s[8:11], s49 offen offset:2048 sc1 lds
  v_exp_f32 v123, v187
  s_waitcnt lgkmcnt(5)
  v_mfma_f32_32x32x16_bf16 v[72:87], v[32:35], v[192:195], v[72:87]
  ds_read_b128 v[28:31], v14 offset:17408
  v_add_f32 v3, v3, v122
  v_exp_f32 v124, v188
  v_add_f32 v3, v3, v123
  v_cvt_pk_bf16_f32 v205, v122, v123
  v_mfma_f32_32x32x16_bf16 v[72:87], v[36:39], v[196:199], v[72:87]
  ds_read_b128 v[32:35], v14 offset:18432
  v_exp_f32 v125, v189
  v_add_f32 v3, v3, v124
  v_exp_f32 v126, v190
  s_waitcnt lgkmcnt(5)
  v_mfma_f32_32x32x16_bf16 v[88:103], v[40:43], v[192:195], v[88:103]
  ds_read_b128 v[36:39], v14 offset:19456
  buffer_load_dwordx4 v20, s[8:11], s49 offen offset:3072 sc1 lds
  v_add_f32 v3, v3, v125
  v_cvt_pk_bf16_f32 v206, v124, v125
  v_mfma_f32_32x32x16_bf16 v[88:103], v[44:47], v[196:199], v[88:103]
  ds_read_b128 v[40:43], v14 offset:20480
  v_exp_f32 v127, v191
  v_add_f32 v3, v3, v126
  v_add_f32 v3, v3, v127
  v_cvt_pk_bf16_f32 v207, v126, v127
  s_waitcnt lgkmcnt(5)
  v_mfma_f32_32x32x16_bf16 v[104:119], v[48:51], v[192:195], v[104:119]
  ds_read_b128 v[44:47], v14 offset:21504
  s_add_u32 s47, s47, 32768
  s_and_b32 s47, s47, 0x1ffff
  s_add_u32 s48, s48, 32768
  v_cmp_nge_f32 vcc, s31, v3
  s_cmp_eq_u32 s28, s61
  v_mfma_f32_32x32x16_bf16 v[104:119], v[52:55], v[196:199], v[104:119]
  ds_read_b128 v[48:51], v14 offset:22528
  s_cbranch_vccnz main_kernel_rare_35
main_kernel_back_36:
  s_cbranch_scc0 main_kernel_s_loop
  s_waitcnt vmcnt(8)
  s_barrier
  v_add_u32 v14, s46, v20
  ds_read_b128 v[24:27], v14 offset:8192
  ds_read_b128 v[28:31], v14 offset:9216
  ds_read_b128 v[32:35], v14 offset:10240
  ds_read_b128 v[36:39], v14 offset:11264
  ds_read_b128 v[40:43], v14 offset:12288
  ds_read_b128 v[44:47], v14 offset:13312
  ds_read_b128 v[48:51], v14 offset:14336
  ds_read_b128 v[52:55], v14 offset:15360
  s_add_u32 s46, s46, 32768
  s_and_b32 s46, s46, 0x1ffff
  v_cmp_ge_i32 s[64:65], v7, 0
  v_cmp_ge_i32 s[66:67], v7, 1
  v_cmp_ge_i32 s[68:69], v7, 2
  v_cmp_ge_i32 s[70:71], v7, 3
  v_cmp_ge_i32 s[72:73], v7, 8
  v_cmp_ge_i32 s[74:75], v7, 9
  v_cmp_ge_i32 s[76:77], v7, 10
  v_cmp_ge_i32 s[78:79], v7, 11
  v_cmp_ge_i32 s[80:81], v7, 16
  v_cmp_ge_i32 s[82:83], v7, 17
  v_cmp_ge_i32 s[84:85], v7, 18
  v_cmp_ge_i32 s[86:87], v7, 19
  v_cmp_ge_i32 s[88:89], v7, 24
  v_cmp_ge_i32 s[90:91], v7, 25
  v_cmp_ge_i32 s[92:93], v7, 26
  v_cmp_ge_i32 s[94:95], v7, 27
  v_cndmask_b32 v160, v8, v160, s[64:65]
  v_cndmask_b32 v161, v8, v161, s[66:67]
  v_cndmask_b32 v162, v8, v162, s[68:69]
  v_cndmask_b32 v163, v8, v163, s[70:71]
  s_waitcnt lgkmcnt(7)
  v_mfma_f32_32x32x16_bf16 v[56:71], v[24:27], v[200:203], v[56:71]
  s_mov_b32 m0, s47
  v_cndmask_b32 v164, v8, v164, s[72:73]
  v_cndmask_b32 v165, v8, v165, s[74:75]
  v_cndmask_b32 v166, v8, v166, s[76:77]
  v_cndmask_b32 v167, v8, v167, s[78:79]
  v_cndmask_b32 v168, v8, v168, s[80:81]
  v_cndmask_b32 v169, v8, v169, s[82:83]
  v_cndmask_b32 v170, v8, v170, s[84:85]
  v_cndmask_b32 v171, v8, v171, s[86:87]
  v_cndmask_b32 v172, v8, v172, s[88:89]
  s_waitcnt lgkmcnt(6)
  v_mfma_f32_32x32x16_bf16 v[56:71], v[28:31], v[204:207], v[56:71]
  buffer_load_dwordx4 v20, s[8:11], s48 offen sc1 lds
  v_cndmask_b32 v173, v8, v173, s[90:91]
  v_cndmask_b32 v174, v8, v174, s[92:93]
  v_cndmask_b32 v175, v8, v175, s[94:95]
  v_exp_f32 v120, v160
  v_exp_f32 v121, v161
  v_add_f32 v4, v3, v120
  v_exp_f32 v122, v162
  s_waitcnt lgkmcnt(5)
  v_mfma_f32_32x32x16_bf16 v[72:87], v[32:35], v[200:203], v[72:87]
  v_add_f32 v4, v4, v121
  v_cvt_pk_bf16_f32 v192, v120, v121
  v_exp_f32 v123, v163
  v_add_f32 v4, v4, v122
  v_exp_f32 v124, v164
  s_waitcnt lgkmcnt(4)
  v_mfma_f32_32x32x16_bf16 v[72:87], v[36:39], v[204:207], v[72:87]
  buffer_load_dwordx4 v20, s[8:11], s48 offen offset:1024 sc1 lds
  v_add_f32 v4, v4, v123
  v_cvt_pk_bf16_f32 v193, v122, v123
  v_exp_f32 v125, v165
  v_add_f32 v4, v4, v124
  v_exp_f32 v126, v166
  v_add_f32 v4, v4, v125
  v_cvt_pk_bf16_f32 v194, v124, v125
  s_waitcnt lgkmcnt(3)
  v_mfma_f32_32x32x16_bf16 v[88:103], v[40:43], v[200:203], v[88:103]
  v_exp_f32 v127, v167
  v_add_f32 v4, v4, v126
  v_exp_f32 v120, v168
  v_add_f32 v4, v4, v127
  v_cvt_pk_bf16_f32 v195, v126, v127
  v_exp_f32 v121, v169
  s_waitcnt lgkmcnt(2)
  v_mfma_f32_32x32x16_bf16 v[88:103], v[44:47], v[204:207], v[88:103]
  buffer_load_dwordx4 v20, s[8:11], s48 offen offset:2048 sc1 lds
  v_add_f32 v4, v4, v120
  v_exp_f32 v122, v170
  v_add_f32 v4, v4, v121
  v_cvt_pk_bf16_f32 v196, v120, v121
  v_exp_f32 v123, v171
  v_add_f32 v4, v4, v122
  s_waitcnt lgkmcnt(1)
  v_mfma_f32_32x32x16_bf16 v[104:119], v[48:51], v[200:203], v[104:119]
  buffer_load_dwordx4 v20, s[8:11], s48 offen offset:3072 sc1 lds
  v_exp_f32 v124, v172
  v_add_f32 v4, v4, v123
  v_cvt_pk_bf16_f32 v197, v122, v123
  v_exp_f32 v125, v173
  v_add_f32 v4, v4, v124
  v_exp_f32 v126, v174
  s_waitcnt lgkmcnt(0)
  v_mfma_f32_32x32x16_bf16 v[104:119], v[52:55], v[204:207], v[104:119]
  v_add_f32 v4, v4, v125
  v_cvt_pk_bf16_f32 v198, v124, v125
  v_exp_f32 v127, v175
  v_add_f32 v4, v4, v126
  s_nop 0
  v_add_f32 v4, v4, v127
  v_cvt_pk_bf16_f32 v199, v126, v127
  v_cmp_nge_f32 vcc, s31, v4
  s_cbranch_vccnz main_kernel_rare_37
main_kernel_back_38:
main_kernel_s_t0:
  ds_read_b128 v[24:27], v14 offset:24576
  ds_read_b128 v[28:31], v14 offset:25600
  ds_read_b128 v[32:35], v14 offset:26624
  ds_read_b128 v[36:39], v14 offset:27648
  ds_read_b128 v[40:43], v14 offset:28672
  ds_read_b128 v[44:47], v14 offset:29696
  ds_read_b128 v[48:51], v14 offset:30720
  ds_read_b128 v[52:55], v14 offset:31744
  s_waitcnt lgkmcnt(7)
  v_mfma_f32_32x32x16_bf16 v[56:71], v[24:27], v[192:195], v[56:71]
  s_waitcnt lgkmcnt(6)
  v_mfma_f32_32x32x16_bf16 v[56:71], v[28:31], v[196:199], v[56:71]
  s_waitcnt lgkmcnt(5)
  v_mfma_f32_32x32x16_bf16 v[72:87], v[32:35], v[192:195], v[72:87]
  s_waitcnt lgkmcnt(4)
  v_mfma_f32_32x32x16_bf16 v[72:87], v[36:39], v[196:199], v[72:87]
  s_waitcnt lgkmcnt(3)
  v_mfma_f32_32x32x16_bf16 v[88:103], v[40:43], v[192:195], v[88:103]
  s_waitcnt lgkmcnt(2)
  v_mfma_f32_32x32x16_bf16 v[88:103], v[44:47], v[196:199], v[88:103]
  s_waitcnt lgkmcnt(1)
  v_mfma_f32_32x32x16_bf16 v[104:119], v[48:51], v[192:195], v[104:119]
  s_waitcnt lgkmcnt(0)
  v_mfma_f32_32x32x16_bf16 v[104:119], v[52:55], v[196:199], v[104:119]
  s_add_u32 s49, s48, 4096
  s_add_u32 m0, s47, 4096
  s_nop 0
  buffer_load_dwordx4 v20, s[8:11], s49 offen sc1 lds
  buffer_load_dwordx4 v20, s[8:11], s49 offen offset:1024 sc1 lds
  buffer_load_dwordx4 v20, s[8:11], s49 offen offset:2048 sc1 lds
  buffer_load_dwordx4 v20, s[8:11], s49 offen offset:3072 sc1 lds
  s_add_u32 s47, s47, 32768
  s_and_b32 s47, s47, 0x1ffff
  s_add_u32 s48, s48, 32768
  s_branch main_kernel_s_fin
main_kernel_s_fin1:
  ds_read_b128 v[24:27], v14 offset:24576
  ds_read_b128 v[28:31], v14 offset:25600
  ds_read_b128 v[32:35], v14 offset:26624
  ds_read_b128 v[36:39], v14 offset:27648
  ds_read_b128 v[40:43], v14 offset:28672
  ds_read_b128 v[44:47], v14 offset:29696
  ds_read_b128 v[48:51], v14 offset:30720
  ds_read_b128 v[52:55], v14 offset:31744
  v_cmp_ge_i32 s[64:65], v7, 0
  v_cmp_ge_i32 s[66:67], v7, 1
  v_cmp_ge_i32 s[68:69], v7, 2
  v_cmp_ge_i32 s[70:71], v7, 3
  v_cmp_ge_i32 s[72:73], v7, 8
  v_cmp_ge_i32 s[74:75], v7, 9
  v_cmp_ge_i32 s[76:77], v7, 10
  v_cmp_ge_i32 s[78:79], v7, 11
  v_cmp_ge_i32 s[80:81], v7, 16
  v_cmp_ge_i32 s[82:83], v7, 17
  v_cmp_ge_i32 s[84:85], v7, 18
  v_cmp_ge_i32 s[86:87], v7, 19
  v_cmp_ge_i32 s[88:89], v7, 24
  v_cmp_ge_i32 s[90:91], v7, 25
  v_cmp_ge_i32 s[92:93], v7, 26
  v_cmp_ge_i32 s[94:95], v7, 27
  v_cndmask_b32 v176, v8, v176, s[64:65]
  v_cndmask_b32 v177, v8, v177, s[66:67]
  v_cndmask_b32 v178, v8, v178, s[68:69]
  v_cndmask_b32 v179, v8, v179, s[70:71]
  s_waitcnt lgkmcnt(7)
  v_mfma_f32_32x32x16_bf16 v[56:71], v[24:27], v[192:195], v[56:71]
  s_add_u32 s49, s48, 4096
  s_add_u32 m0, s47, 4096
  v_cndmask_b32 v180, v8, v180, s[72:73]
  v_cndmask_b32 v181, v8, v181, s[74:75]
  v_cndmask_b32 v182, v8, v182, s[76:77]
  v_cndmask_b32 v183, v8, v183, s[78:79]
  v_cndmask_b32 v184, v8, v184, s[80:81]
  v_cndmask_b32 v185, v8, v185, s[82:83]
  v_cndmask_b32 v186, v8, v186, s[84:85]
  v_cndmask_b32 v187, v8, v187, s[86:87]
  v_cndmask_b32 v188, v8, v188, s[88:89]
  s_waitcnt lgkmcnt(6)
  v_mfma_f32_32x32x16_bf16 v[56:71], v[28:31], v[196:199], v[56:71]
  buffer_load_dwordx4 v20, s[8:11], s49 offen sc1 lds
  v_cndmask_b32 v189, v8, v189, s[90:91]
  v_cndmask_b32 v190, v8, v190, s[92:93]
  v_cndmask_b32 v191, v8, v191, s[94:95]
  v_exp_f32 v120, v176
  v_exp_f32 v121, v177
  v_add_f32 v3, v4, v120
  v_exp_f32 v122, v178
  s_waitcnt lgkmcnt(5)
  v_mfma_f32_32x32x16_bf16 v[72:87], v[32:35], v[192:195], v[72:87]
  v_add_f32 v3, v3, v121
  v_cvt_pk_bf16_f32 v200, v120, v121
  v_exp_f32 v123, v179
  v_add_f32 v3, v3, v122
  v_exp_f32 v124, v180
  s_waitcnt lgkmcnt(4)
  v_mfma_f32_32x32x16_bf16 v[72:87], v[36:39], v[196:199], v[72:87]
  buffer_load_dwordx4 v20, s[8:11], s49 offen offset:1024 sc1 lds
  v_add_f32 v3, v3, v123
  v_cvt_pk_bf16_f32 v201, v122, v123
  v_exp_f32 v125, v181
  v_add_f32 v3, v3, v124
  v_exp_f32 v126, v182
  v_add_f32 v3, v3, v125
  v_cvt_pk_bf16_f32 v202, v124, v125
  s_waitcnt lgkmcnt(3)
  v_mfma_f32_32x32x16_bf16 v[88:103], v[40:43], v[192:195], v[88:103]
  v_exp_f32 v127, v183
  v_add_f32 v3, v3, v126
  v_exp_f32 v120, v184
  v_add_f32 v3, v3, v127
  v_cvt_pk_bf16_f32 v203, v126, v127
  v_exp_f32 v121, v185
  s_waitcnt lgkmcnt(2)
  v_mfma_f32_32x32x16_bf16 v[88:103], v[44:47], v[196:199], v[88:103]
  buffer_load_dwordx4 v20, s[8:11], s49 offen offset:2048 sc1 lds
  v_add_f32 v3, v3, v120
  v_exp_f32 v122, v186
  v_add_f32 v3, v3, v121
  v_cvt_pk_bf16_f32 v204, v120, v121
  v_exp_f32 v123, v187
  v_add_f32 v3, v3, v122
  s_waitcnt lgkmcnt(1)
  v_mfma_f32_32x32x16_bf16 v[104:119], v[48:51], v[192:195], v[104:119]
  buffer_load_dwordx4 v20, s[8:11], s49 offen offset:3072 sc1 lds
  v_exp_f32 v124, v188
  v_add_f32 v3, v3, v123
  v_cvt_pk_bf16_f32 v205, v122, v123
  v_exp_f32 v125, v189
  v_add_f32 v3, v3, v124
  v_exp_f32 v126, v190
  s_waitcnt lgkmcnt(0)
  v_mfma_f32_32x32x16_bf16 v[104:119], v[52:55], v[196:199], v[104:119]
  s_add_u32 s47, s47, 32768
  s_and_b32 s47, s47, 0x1ffff
  s_add_u32 s48, s48, 32768
  v_add_f32 v3, v3, v125
  v_cvt_pk_bf16_f32 v206, v124, v125
  v_exp_f32 v127, v191
  v_add_f32 v3, v3, v126
  s_nop 0
  v_add_f32 v3, v3, v127
  v_cvt_pk_bf16_f32 v207, v126, v127
  v_cmp_nge_f32 vcc, s31, v3
  s_cbranch_vccnz main_kernel_rare_39
main_kernel_back_40:
  s_waitcnt vmcnt(8)
  s_barrier
  v_mov_b32 v4, v3
  v_add_u32 v14, s46, v20
  ds_read_b128 v[24:27], v14 offset:8192
  ds_read_b128 v[28:31], v14 offset:9216
  ds_read_b128 v[32:35], v14 offset:10240
  ds_read_b128 v[36:39], v14 offset:11264
  ds_read_b128 v[40:43], v14 offset:12288
  ds_read_b128 v[44:47], v14 offset:13312
  ds_read_b128 v[48:51], v14 offset:14336
  ds_read_b128 v[52:55], v14 offset:15360
  s_waitcnt lgkmcnt(7)
  v_mfma_f32_32x32x16_bf16 v[56:71], v[24:27], v[200:203], v[56:71]
  s_waitcnt lgkmcnt(6)
  v_mfma_f32_32x32x16_bf16 v[56:71], v[28:31], v[204:207], v[56:71]
  s_waitcnt lgkmcnt(5)
  v_mfma_f32_32x32x16_bf16 v[72:87], v[32:35], v[200:203], v[72:87]
  s_waitcnt lgkmcnt(4)
  v_mfma_f32_32x32x16_bf16 v[72:87], v[36:39], v[204:207], v[72:87]
  s_waitcnt lgkmcnt(3)
  v_mfma_f32_32x32x16_bf16 v[88:103], v[40:43], v[200:203], v[88:103]
  s_waitcnt lgkmcnt(2)
  v_mfma_f32_32x32x16_bf16 v[88:103], v[44:47], v[204:207], v[88:103]
  s_waitcnt lgkmcnt(1)
  v_mfma_f32_32x32x16_bf16 v[104:119], v[48:51], v[200:203], v[104:119]
  s_waitcnt lgkmcnt(0)
  v_mfma_f32_32x32x16_bf16 v[104:119], v[52:55], v[204:207], v[104:119]
  s_mov_b32 m0, s47
  s_nop 0
  buffer_load_dwordx4 v20, s[8:11], s48 offen sc1 lds
  buffer_load_dwordx4 v20, s[8:11], s48 offen offset:1024 sc1 lds
  buffer_load_dwordx4 v20, s[8:11], s48 offen offset:2048 sc1 lds
  buffer_load_dwordx4 v20, s[8:11], s48 offen offset:3072 sc1 lds
  s_add_u32 s49, s48, 4096
  s_add_u32 m0, s47, 4096
  s_nop 0
  buffer_load_dwordx4 v20, s[8:11], s49 offen sc1 lds
  buffer_load_dwordx4 v20, s[8:11], s49 offen offset:1024 sc1 lds
  buffer_load_dwordx4 v20, s[8:11], s49 offen offset:2048 sc1 lds
  buffer_load_dwordx4 v20, s[8:11], s49 offen offset:3072 sc1 lds
  s_add_u32 s47, s47, 32768
  s_and_b32 s47, s47, 0x1ffff
  s_add_u32 s48, s48, 32768
main_kernel_s_fin:
  s_add_u32 s29, s40, 3
  s_lshr_b32 s29, s29, 1
  s_cmp_gt_u32 s29, s30
  s_cbranch_scc1 main_kernel_s_ep0
  s_waitcnt vmcnt(8)
  s_barrier
  s_mov_b32 m0, s47
  s_nop 0
  buffer_load_dwordx4 v20, s[8:11], s48 offen sc1 lds
  buffer_load_dwordx4 v20, s[8:11], s48 offen offset:1024 sc1 lds
  buffer_load_dwordx4 v20, s[8:11], s48 offen offset:2048 sc1 lds
  buffer_load_dwordx4 v20, s[8:11], s48 offen offset:3072 sc1 lds
  s_add_u32 s49, s48, 4096
  s_add_u32 m0, s47, 4096
  s_nop 0
  buffer_load_dwordx4 v20, s[8:11], s49 offen sc1 lds
  buffer_load_dwordx4 v20, s[8:11], s49 offen offset:1024 sc1 lds
  buffer_load_dwordx4 v20, s[8:11], s49 offen offset:2048 sc1 lds
  buffer_load_dwordx4 v20, s[8:11], s49 offen offset:3072 sc1 lds
  s_add_u32 s47, s47, 32768
  s_and_b32 s47, s47, 0x1ffff
  s_add_u32 s48, s48, 32768
  s_add_u32 s29, s29, 1
main_kernel_s_ep0:
  v_mov_b32 v9, v4
  s_nop 1
  v_permlane32_swap_b32 v4, v9
  s_nop 1
  v_add_f32 v4, v4, v9
  v_rcp_f32 v4, v4
  s_lshl_b32 s22, s40, 5
  s_add_u32 s22, s22, s43
  s_lshl_b32 s22, s22, 13
  s_add_u32 s23, s22, 4096
  s_nop 15
  v_mul_f32 v56, v56, v4
  v_mul_f32 v57, v57, v4
  v_mul_f32 v58, v58, v4
  v_mul_f32 v59, v59, v4
  v_mul_f32 v60, v60, v4
  v_mul_f32 v61, v61, v4
  v_mul_f32 v62, v62, v4
  v_mul_f32 v63, v63, v4
  v_cvt_pk_bf16_f32 v24, v56, v57
  v_cvt_pk_bf16_f32 v25, v58, v59
  v_cvt_pk_bf16_f32 v26, v60, v61
  v_cvt_pk_bf16_f32 v27, v62, v63
  buffer_store_dwordx4 v[24:27], v20, s[12:15], s22 offen sc1
  v_mul_f32 v64, v64, v4
  v_mul_f32 v65, v65, v4
  v_mul_f32 v66, v66, v4
  v_mul_f32 v67, v67, v4
  v_mul_f32 v68, v68, v4
  v_mul_f32 v69, v69, v4
  v_mul_f32 v70, v70, v4
  v_mul_f32 v71, v71, v4
  v_cvt_pk_bf16_f32 v28, v64, v65
  v_cvt_pk_bf16_f32 v29, v66, v67
  v_cvt_pk_bf16_f32 v30, v68, v69
  v_cvt_pk_bf16_f32 v31, v70, v71
  buffer_store_dwordx4 v[28:31], v20, s[12:15], s22 offen offset:1024 sc1
  v_mul_f32 v72, v72, v4
  v_mul_f32 v73, v73, v4
  v_mul_f32 v74, v74, v4
  v_mul_f32 v75, v75, v4
  v_mul_f32 v76, v76, v4
  v_mul_f32 v77, v77, v4
  v_mul_f32 v78, v78, v4
  v_mul_f32 v79, v79, v4
  v_cvt_pk_bf16_f32 v32, v72, v73
  v_cvt_pk_bf16_f32 v33, v74, v75
  v_cvt_pk_bf16_f32 v34, v76, v77
  v_cvt_pk_bf16_f32 v35, v78, v79
  buffer_store_dwordx4 v[32:35], v20, s[12:15], s22 offen offset:2048 sc1
  v_mul_f32 v80, v80, v4
  v_mul_f32 v81, v81, v4
  v_mul_f32 v82, v82, v4
  v_mul_f32 v83, v83, v4
  v_mul_f32 v84, v84, v4
  v_mul_f32 v85, v85, v4
  v_mul_f32 v86, v86, v4
  v_mul_f32 v87, v87, v4
  v_cvt_pk_bf16_f32 v36, v80, v81
  v_cvt_pk_bf16_f32 v37, v82, v83
  v_cvt_pk_bf16_f32 v38, v84, v85
  v_cvt_pk_bf16_f32 v39, v86, v87
  buffer_store_dwordx4 v[36:39], v20, s[12:15], s22 offen offset:3072 sc1
  v_mul_f32 v88, v88, v4
  v_mul_f32 v89, v89, v4
  v_mul_f32 v90, v90, v4
  v_mul_f32 v91, v91, v4
  v_mul_f32 v92, v92, v4
  v_mul_f32 v93, v93, v4
  v_mul_f32 v94, v94, v4
  v_mul_f32 v95, v95, v4
  v_cvt_pk_bf16_f32 v40, v88, v89
  v_cvt_pk_bf16_f32 v41, v90, v91
  v_cvt_pk_bf16_f32 v42, v92, v93
  v_cvt_pk_bf16_f32 v43, v94, v95
  buffer_store_dwordx4 v[40:43], v20, s[12:15], s23 offen sc1
  v_mul_f32 v96, v96, v4
  v_mul_f32 v97, v97, v4
  v_mul_f32 v98, v98, v4
  v_mul_f32 v99, v99, v4
  v_mul_f32 v100, v100, v4
  v_mul_f32 v101, v101, v4
  v_mul_f32 v102, v102, v4
  v_mul_f32 v103, v103, v4
  v_cvt_pk_bf16_f32 v44, v96, v97
  v_cvt_pk_bf16_f32 v45, v98, v99
  v_cvt_pk_bf16_f32 v46, v100, v101
  v_cvt_pk_bf16_f32 v47, v102, v103
  buffer_store_dwordx4 v[44:47], v20, s[12:15], s23 offen offset:1024 sc1
  v_mul_f32 v104, v104, v4
  v_mul_f32 v105, v105, v4
  v_mul_f32 v106, v106, v4
  v_mul_f32 v107, v107, v4
  v_mul_f32 v108, v108, v4
  v_mul_f32 v109, v109, v4
  v_mul_f32 v110, v110, v4
  v_mul_f32 v111, v111, v4
  v_cvt_pk_bf16_f32 v48, v104, v105
  v_cvt_pk_bf16_f32 v49, v106, v107
  v_cvt_pk_bf16_f32 v50, v108, v109
  v_cvt_pk_bf16_f32 v51, v110, v111
  buffer_store_dwordx4 v[48:51], v20, s[12:15], s23 offen offset:2048 sc1
  v_mul_f32 v112, v112, v4
  v_mul_f32 v113, v113, v4
  v_mul_f32 v114, v114, v4
  v_mul_f32 v115, v115, v4
  v_mul_f32 v116, v116, v4
  v_mul_f32 v117, v117, v4
  v_mul_f32 v118, v118, v4
  v_mul_f32 v119, v119, v4
  v_cvt_pk_bf16_f32 v52, v112, v113
  v_cvt_pk_bf16_f32 v53, v114, v115
  v_cvt_pk_bf16_f32 v54, v116, v117
  v_cvt_pk_bf16_f32 v55, v118, v119
  buffer_store_dwordx4 v[52:55], v20, s[12:15], s23 offen offset:3072 sc1
main_kernel_s_ld:
  s_cmp_gt_u32 s29, s30
  s_cbranch_scc1 main_kernel_s_ldend
  s_waitcnt vmcnt(8)
  s_barrier
  s_mov_b32 m0, s47
  s_nop 0
  buffer_load_dwordx4 v20, s[8:11], s48 offen sc1 lds
  buffer_load_dwordx4 v20, s[8:11], s48 offen offset:1024 sc1 lds
  buffer_load_dwordx4 v20, s[8:11], s48 offen offset:2048 sc1 lds
  buffer_load_dwordx4 v20, s[8:11], s48 offen offset:3072 sc1 lds
  s_add_u32 s49, s48, 4096
  s_add_u32 m0, s47, 4096
  s_nop 0
  buffer_load_dwordx4 v20, s[8:11], s49 offen sc1 lds
  buffer_load_dwordx4 v20, s[8:11], s49 offen offset:1024 sc1 lds
  buffer_load_dwordx4 v20, s[8:11], s49 offen offset:2048 sc1 lds
  buffer_load_dwordx4 v20, s[8:11], s49 offen offset:3072 sc1 lds
  s_add_u32 s47, s47, 32768
  s_and_b32 s47, s47, 0x1ffff
  s_add_u32 s48, s48, 32768
  s_add_u32 s29, s29, 1
  s_branch main_kernel_s_ld
main_kernel_s_ldend:
  s_getpc_b64 s[6:7]
main_kernel_pc_41:
  s_add_u32 s6, s6, out_kernel - main_kernel_pc_41
  s_addc_u32 s7, s7, 0
  v_lshlrev_b32 v5, 3, v20
  v_add_u32 v6, 8192, v5
  v_min_u32 v6, out_kernel_done - out_kernel, v6
  global_load_dword v5, v5, s[6:7]
  global_load_dword v6, v6, s[6:7]
  s_endpgm
main_kernel_rare_33:
  s_nop 15
  s_nop 15
  v_log_f32 v11, v3
  v_max3_f32 v9, v160, v161, v162
  v_max3_f32 v9, v9, v163, v164
  v_max3_f32 v9, v9, v165, v166
  v_max3_f32 v9, v9, v167, v168
  v_max3_f32 v9, v9, v169, v170
  v_max3_f32 v9, v9, v171, v172
  v_max3_f32 v9, v9, v173, v174
  v_max_f32 v9, v9, v175
  v_max_f32 v9, v9, v11
  v_mov_b32 v12, v9
  s_nop 1
  v_permlane32_swap_b32 v9, v12
  s_nop 1
  v_max_f32 v9, v9, v12
  v_ceil_f32 v9, v9
  v_max_f32 v9, 0, v9
  v_sub_f32 v10, 0, v9
  v_cvt_i32_f32 v10, v10
  v_sub_f32 v160, v160, v9
  v_sub_f32 v161, v161, v9
  v_sub_f32 v162, v162, v9
  v_sub_f32 v163, v163, v9
  v_sub_f32 v164, v164, v9
  v_sub_f32 v165, v165, v9
  v_sub_f32 v166, v166, v9
  v_sub_f32 v167, v167, v9
  v_sub_f32 v168, v168, v9
  v_sub_f32 v169, v169, v9
  v_sub_f32 v170, v170, v9
  v_sub_f32 v171, v171, v9
  v_sub_f32 v172, v172, v9
  v_sub_f32 v173, v173, v9
  v_sub_f32 v174, v174, v9
  v_sub_f32 v175, v175, v9
  v_sub_f32 v176, v176, v9
  v_sub_f32 v177, v177, v9
  v_sub_f32 v178, v178, v9
  v_sub_f32 v179, v179, v9
  v_sub_f32 v180, v180, v9
  v_sub_f32 v181, v181, v9
  v_sub_f32 v182, v182, v9
  v_sub_f32 v183, v183, v9
  v_sub_f32 v184, v184, v9
  v_sub_f32 v185, v185, v9
  v_sub_f32 v186, v186, v9
  v_sub_f32 v187, v187, v9
  v_sub_f32 v188, v188, v9
  v_sub_f32 v189, v189, v9
  v_sub_f32 v190, v190, v9
  v_sub_f32 v191, v191, v9
  v_sub_f32 v208, v208, v9
  v_sub_f32 v209, v209, v9
  v_sub_f32 v210, v210, v9
  v_sub_f32 v211, v211, v9
  v_sub_f32 v212, v212, v9
  v_sub_f32 v213, v213, v9
  v_sub_f32 v214, v214, v9
  v_sub_f32 v215, v215, v9
  v_sub_f32 v216, v216, v9
  v_sub_f32 v217, v217, v9
  v_sub_f32 v218, v218, v9
  v_sub_f32 v219, v219, v9
  v_sub_f32 v220, v220, v9
  v_sub_f32 v221, v221, v9
  v_sub_f32 v222, v222, v9
  v_sub_f32 v223, v223, v9
  v_ldexp_f32 v56, v56, v10
  v_ldexp_f32 v57, v57, v10
  v_ldexp_f32 v58, v58, v10
  v_ldexp_f32 v59, v59, v10
  v_ldexp_f32 v60, v60, v10
  v_ldexp_f32 v61, v61, v10
  v_ldexp_f32 v62, v62, v10
  v_ldexp_f32 v63, v63, v10
  v_ldexp_f32 v64, v64, v10
  v_ldexp_f32 v65, v65, v10
  v_ldexp_f32 v66, v66, v10
  v_ldexp_f32 v67, v67, v10
  v_ldexp_f32 v68, v68, v10
  v_ldexp_f32 v69, v69, v10
  v_ldexp_f32 v70, v70, v10
  v_ldexp_f32 v71, v71, v10
  v_ldexp_f32 v72, v72, v10
  v_ldexp_f32 v73, v73, v10
  v_ldexp_f32 v74, v74, v10
  v_ldexp_f32 v75, v75, v10
  v_ldexp_f32 v76, v76, v10
  v_ldexp_f32 v77, v77, v10
  v_ldexp_f32 v78, v78, v10
  v_ldexp_f32 v79, v79, v10
  v_ldexp_f32 v80, v80, v10
  v_ldexp_f32 v81, v81, v10
  v_ldexp_f32 v82, v82, v10
  v_ldexp_f32 v83, v83, v10
  v_ldexp_f32 v84, v84, v10
  v_ldexp_f32 v85, v85, v10
  v_ldexp_f32 v86, v86, v10
  v_ldexp_f32 v87, v87, v10
  v_ldexp_f32 v88, v88, v10
  v_ldexp_f32 v89, v89, v10
  v_ldexp_f32 v90, v90, v10
  v_ldexp_f32 v91, v91, v10
  v_ldexp_f32 v92, v92, v10
  v_ldexp_f32 v93, v93, v10
  v_ldexp_f32 v94, v94, v10
  v_ldexp_f32 v95, v95, v10
  v_ldexp_f32 v96, v96, v10
  v_ldexp_f32 v97, v97, v10
  v_ldexp_f32 v98, v98, v10
  v_ldexp_f32 v99, v99, v10
  v_ldexp_f32 v100, v100, v10
  v_ldexp_f32 v101, v101, v10
  v_ldexp_f32 v102, v102, v10
  v_ldexp_f32 v103, v103, v10
  v_ldexp_f32 v104, v104, v10
  v_ldexp_f32 v105, v105, v10
  v_ldexp_f32 v106, v106, v10
  v_ldexp_f32 v107, v107, v10
  v_ldexp_f32 v108, v108, v10
  v_ldexp_f32 v109, v109, v10
  v_ldexp_f32 v110, v110, v10
  v_ldexp_f32 v111, v111, v10
  v_ldexp_f32 v112, v112, v10
  v_ldexp_f32 v113, v113, v10
  v_ldexp_f32 v114, v114, v10
  v_ldexp_f32 v115, v115, v10
  v_ldexp_f32 v116, v116, v10
  v_ldexp_f32 v117, v117, v10
  v_ldexp_f32 v118, v118, v10
  v_ldexp_f32 v119, v119, v10
  v_ldexp_f32 v3, v3, v10
  v_exp_f32 v120, v160
  v_exp_f32 v121, v161
  v_add_f32 v4, v3, v120
  v_exp_f32 v122, v162
  v_add_f32 v4, v4, v121
  v_cvt_pk_bf16_f32 v192, v120, v121
  v_exp_f32 v123, v163
  v_add_f32 v4, v4, v122
  v_exp_f32 v124, v164
  v_add_f32 v4, v4, v123
  v_cvt_pk_bf16_f32 v193, v122, v123
  v_exp_f32 v125, v165
  v_add_f32 v4, v4, v124
  v_exp_f32 v126, v166
  v_add_f32 v4, v4, v125
  v_cvt_pk_bf16_f32 v194, v124, v125
  v_exp_f32 v127, v167
  v_add_f32 v4, v4, v126
  v_exp_f32 v120, v168
  v_add_f32 v4, v4, v127
  v_cvt_pk_bf16_f32 v195, v126, v127
  v_exp_f32 v121, v169
  v_add_f32 v4, v4, v120
  v_exp_f32 v122, v170
  v_add_f32 v4, v4, v121
  v_cvt_pk_bf16_f32 v196, v120, v121
  v_exp_f32 v123, v171
  v_add_f32 v4, v4, v122
  v_exp_f32 v124, v172
  v_add_f32 v4, v4, v123
  v_cvt_pk_bf16_f32 v197, v122, v123
  v_exp_f32 v125, v173
  v_add_f32 v4, v4, v124
  v_exp_f32 v126, v174
  v_add_f32 v4, v4, v125
  v_cvt_pk_bf16_f32 v198, v124, v125
  v_exp_f32 v127, v175
  v_add_f32 v4, v4, v126
  v_add_f32 v4, v4, v127
  v_cvt_pk_bf16_f32 v199, v126, v127
  s_nop 1
  s_branch main_kernel_back_34
main_kernel_rare_35:
  s_nop 15
  s_nop 15
  v_log_f32 v11, v4
  v_max3_f32 v9, v176, v177, v178
  v_max3_f32 v9, v9, v179, v180
  v_max3_f32 v9, v9, v181, v182
  v_max3_f32 v9, v9, v183, v184
  v_max3_f32 v9, v9, v185, v186
  v_max3_f32 v9, v9, v187, v188
  v_max3_f32 v9, v9, v189, v190
  v_max_f32 v9, v9, v191
  v_max_f32 v9, v9, v11
  v_mov_b32 v12, v9
  s_nop 1
  v_permlane32_swap_b32 v9, v12
  s_nop 1
  v_max_f32 v9, v9, v12
  v_ceil_f32 v9, v9
  v_max_f32 v9, 0, v9
  v_sub_f32 v10, 0, v9
  v_cvt_i32_f32 v10, v10
  v_sub_f32 v176, v176, v9
  v_sub_f32 v177, v177, v9
  v_sub_f32 v178, v178, v9
  v_sub_f32 v179, v179, v9
  v_sub_f32 v180, v180, v9
  v_sub_f32 v181, v181, v9
  v_sub_f32 v182, v182, v9
  v_sub_f32 v183, v183, v9
  v_sub_f32 v184, v184, v9
  v_sub_f32 v185, v185, v9
  v_sub_f32 v186, v186, v9
  v_sub_f32 v187, v187, v9
  v_sub_f32 v188, v188, v9
  v_sub_f32 v189, v189, v9
  v_sub_f32 v190, v190, v9
  v_sub_f32 v191, v191, v9
  v_sub_f32 v160, v160, v9
  v_sub_f32 v161, v161, v9
  v_sub_f32 v162, v162, v9
  v_sub_f32 v163, v163, v9
  v_sub_f32 v164, v164, v9
  v_sub_f32 v165, v165, v9
  v_sub_f32 v166, v166, v9
  v_sub_f32 v167, v167, v9
  v_sub_f32 v168, v168, v9
  v_sub_f32 v169, v169, v9
  v_sub_f32 v170, v170, v9
  v_sub_f32 v171, v171, v9
  v_sub_f32 v172, v172, v9
  v_sub_f32 v173, v173, v9
  v_sub_f32 v174, v174, v9
  v_sub_f32 v175, v175, v9
  v_sub_f32 v208, v208, v9
  v_sub_f32 v209, v209, v9
  v_sub_f32 v210, v210, v9
  v_sub_f32 v211, v211, v9
  v_sub_f32 v212, v212, v9
  v_sub_f32 v213, v213, v9
  v_sub_f32 v214, v214, v9
  v_sub_f32 v215, v215, v9
  v_sub_f32 v216, v216, v9
  v_sub_f32 v217, v217, v9
  v_sub_f32 v218, v218, v9
  v_sub_f32 v219, v219, v9
  v_sub_f32 v220, v220, v9
  v_sub_f32 v221, v221, v9
  v_sub_f32 v222, v222, v9
  v_sub_f32 v223, v223, v9
  v_ldexp_f32 v56, v56, v10
  v_ldexp_f32 v57, v57, v10
  v_ldexp_f32 v58, v58, v10
  v_ldexp_f32 v59, v59, v10
  v_ldexp_f32 v60, v60, v10
  v_ldexp_f32 v61, v61, v10
  v_ldexp_f32 v62, v62, v10
  v_ldexp_f32 v63, v63, v10
  v_ldexp_f32 v64, v64, v10
  v_ldexp_f32 v65, v65, v10
  v_ldexp_f32 v66, v66, v10
  v_ldexp_f32 v67, v67, v10
  v_ldexp_f32 v68, v68, v10
  v_ldexp_f32 v69, v69, v10
  v_ldexp_f32 v70, v70, v10
  v_ldexp_f32 v71, v71, v10
  v_ldexp_f32 v72, v72, v10
  v_ldexp_f32 v73, v73, v10
  v_ldexp_f32 v74, v74, v10
  v_ldexp_f32 v75, v75, v10
  v_ldexp_f32 v76, v76, v10
  v_ldexp_f32 v77, v77, v10
  v_ldexp_f32 v78, v78, v10
  v_ldexp_f32 v79, v79, v10
  v_ldexp_f32 v80, v80, v10
  v_ldexp_f32 v81, v81, v10
  v_ldexp_f32 v82, v82, v10
  v_ldexp_f32 v83, v83, v10
  v_ldexp_f32 v84, v84, v10
  v_ldexp_f32 v85, v85, v10
  v_ldexp_f32 v86, v86, v10
  v_ldexp_f32 v87, v87, v10
  v_ldexp_f32 v88, v88, v10
  v_ldexp_f32 v89, v89, v10
  v_ldexp_f32 v90, v90, v10
  v_ldexp_f32 v91, v91, v10
  v_ldexp_f32 v92, v92, v10
  v_ldexp_f32 v93, v93, v10
  v_ldexp_f32 v94, v94, v10
  v_ldexp_f32 v95, v95, v10
  v_ldexp_f32 v96, v96, v10
  v_ldexp_f32 v97, v97, v10
  v_ldexp_f32 v98, v98, v10
  v_ldexp_f32 v99, v99, v10
  v_ldexp_f32 v100, v100, v10
  v_ldexp_f32 v101, v101, v10
  v_ldexp_f32 v102, v102, v10
  v_ldexp_f32 v103, v103, v10
  v_ldexp_f32 v104, v104, v10
  v_ldexp_f32 v105, v105, v10
  v_ldexp_f32 v106, v106, v10
  v_ldexp_f32 v107, v107, v10
  v_ldexp_f32 v108, v108, v10
  v_ldexp_f32 v109, v109, v10
  v_ldexp_f32 v110, v110, v10
  v_ldexp_f32 v111, v111, v10
  v_ldexp_f32 v112, v112, v10
  v_ldexp_f32 v113, v113, v10
  v_ldexp_f32 v114, v114, v10
  v_ldexp_f32 v115, v115, v10
  v_ldexp_f32 v116, v116, v10
  v_ldexp_f32 v117, v117, v10
  v_ldexp_f32 v118, v118, v10
  v_ldexp_f32 v119, v119, v10
  v_ldexp_f32 v4, v4, v10
  v_exp_f32 v120, v176
  v_exp_f32 v121, v177
  v_add_f32 v3, v4, v120
  v_exp_f32 v122, v178
  v_add_f32 v3, v3, v121
  v_cvt_pk_bf16_f32 v200, v120, v121
  v_exp_f32 v123, v179
  v_add_f32 v3, v3, v122
  v_exp_f32 v124, v180
  v_add_f32 v3, v3, v123
  v_cvt_pk_bf16_f32 v201, v122, v123
  v_exp_f32 v125, v181
  v_add_f32 v3, v3, v124
  v_exp_f32 v126, v182
  v_add_f32 v3, v3, v125
  v_cvt_pk_bf16_f32 v202, v124, v125
  v_exp_f32 v127, v183
  v_add_f32 v3, v3, v126
  v_exp_f32 v120, v184
  v_add_f32 v3, v3, v127
  v_cvt_pk_bf16_f32 v203, v126, v127
  v_exp_f32 v121, v185
  v_add_f32 v3, v3, v120
  v_exp_f32 v122, v186
  v_add_f32 v3, v3, v121
  v_cvt_pk_bf16_f32 v204, v120, v121
  v_exp_f32 v123, v187
  v_add_f32 v3, v3, v122
  v_exp_f32 v124, v188
  v_add_f32 v3, v3, v123
  v_cvt_pk_bf16_f32 v205, v122, v123
  v_exp_f32 v125, v189
  v_add_f32 v3, v3, v124
  v_exp_f32 v126, v190
  v_add_f32 v3, v3, v125
  v_cvt_pk_bf16_f32 v206, v124, v125
  v_exp_f32 v127, v191
  v_add_f32 v3, v3, v126
  v_add_f32 v3, v3, v127
  v_cvt_pk_bf16_f32 v207, v126, v127
  s_nop 1
  s_branch main_kernel_back_36
main_kernel_rare_37:
  s_nop 15
  s_nop 15
  v_log_f32 v11, v3
  v_max3_f32 v9, v160, v161, v162
  v_max3_f32 v9, v9, v163, v164
  v_max3_f32 v9, v9, v165, v166
  v_max3_f32 v9, v9, v167, v168
  v_max3_f32 v9, v9, v169, v170
  v_max3_f32 v9, v9, v171, v172
  v_max3_f32 v9, v9, v173, v174
  v_max_f32 v9, v9, v175
  v_max_f32 v9, v9, v11
  v_mov_b32 v12, v9
  s_nop 1
  v_permlane32_swap_b32 v9, v12
  s_nop 1
  v_max_f32 v9, v9, v12
  v_ceil_f32 v9, v9
  v_max_f32 v9, 0, v9
  v_sub_f32 v10, 0, v9
  v_cvt_i32_f32 v10, v10
  v_sub_f32 v160, v160, v9
  v_sub_f32 v161, v161, v9
  v_sub_f32 v162, v162, v9
  v_sub_f32 v163, v163, v9
  v_sub_f32 v164, v164, v9
  v_sub_f32 v165, v165, v9
  v_sub_f32 v166, v166, v9
  v_sub_f32 v167, v167, v9
  v_sub_f32 v168, v168, v9
  v_sub_f32 v169, v169, v9
  v_sub_f32 v170, v170, v9
  v_sub_f32 v171, v171, v9
  v_sub_f32 v172, v172, v9
  v_sub_f32 v173, v173, v9
  v_sub_f32 v174, v174, v9
  v_sub_f32 v175, v175, v9
  v_sub_f32 v176, v176, v9
  v_sub_f32 v177, v177, v9
  v_sub_f32 v178, v178, v9
  v_sub_f32 v179, v179, v9
  v_sub_f32 v180, v180, v9
  v_sub_f32 v181, v181, v9
  v_sub_f32 v182, v182, v9
  v_sub_f32 v183, v183, v9
  v_sub_f32 v184, v184, v9
  v_sub_f32 v185, v185, v9
  v_sub_f32 v186, v186, v9
  v_sub_f32 v187, v187, v9
  v_sub_f32 v188, v188, v9
  v_sub_f32 v189, v189, v9
  v_sub_f32 v190, v190, v9
  v_sub_f32 v191, v191, v9
  v_sub_f32 v208, v208, v9
  v_sub_f32 v209, v209, v9
  v_sub_f32 v210, v210, v9
  v_sub_f32 v211, v211, v9
  v_sub_f32 v212, v212, v9
  v_sub_f32 v213, v213, v9
  v_sub_f32 v214, v214, v9
  v_sub_f32 v215, v215, v9
  v_sub_f32 v216, v216, v9
  v_sub_f32 v217, v217, v9
  v_sub_f32 v218, v218, v9
  v_sub_f32 v219, v219, v9
  v_sub_f32 v220, v220, v9
  v_sub_f32 v221, v221, v9
  v_sub_f32 v222, v222, v9
  v_sub_f32 v223, v223, v9
  v_ldexp_f32 v56, v56, v10
  v_ldexp_f32 v57, v57, v10
  v_ldexp_f32 v58, v58, v10
  v_ldexp_f32 v59, v59, v10
  v_ldexp_f32 v60, v60, v10
  v_ldexp_f32 v61, v61, v10
  v_ldexp_f32 v62, v62, v10
  v_ldexp_f32 v63, v63, v10
  v_ldexp_f32 v64, v64, v10
  v_ldexp_f32 v65, v65, v10
  v_ldexp_f32 v66, v66, v10
  v_ldexp_f32 v67, v67, v10
  v_ldexp_f32 v68, v68, v10
  v_ldexp_f32 v69, v69, v10
  v_ldexp_f32 v70, v70, v10
  v_ldexp_f32 v71, v71, v10
  v_ldexp_f32 v72, v72, v10
  v_ldexp_f32 v73, v73, v10
  v_ldexp_f32 v74, v74, v10
  v_ldexp_f32 v75, v75, v10
  v_ldexp_f32 v76, v76, v10
  v_ldexp_f32 v77, v77, v10
  v_ldexp_f32 v78, v78, v10
  v_ldexp_f32 v79, v79, v10
  v_ldexp_f32 v80, v80, v10
  v_ldexp_f32 v81, v81, v10
  v_ldexp_f32 v82, v82, v10
  v_ldexp_f32 v83, v83, v10
  v_ldexp_f32 v84, v84, v10
  v_ldexp_f32 v85, v85, v10
  v_ldexp_f32 v86, v86, v10
  v_ldexp_f32 v87, v87, v10
  v_ldexp_f32 v88, v88, v10
  v_ldexp_f32 v89, v89, v10
  v_ldexp_f32 v90, v90, v10
  v_ldexp_f32 v91, v91, v10
  v_ldexp_f32 v92, v92, v10
  v_ldexp_f32 v93, v93, v10
  v_ldexp_f32 v94, v94, v10
  v_ldexp_f32 v95, v95, v10
  v_ldexp_f32 v96, v96, v10
  v_ldexp_f32 v97, v97, v10
  v_ldexp_f32 v98, v98, v10
  v_ldexp_f32 v99, v99, v10
  v_ldexp_f32 v100, v100, v10
  v_ldexp_f32 v101, v101, v10
  v_ldexp_f32 v102, v102, v10
  v_ldexp_f32 v103, v103, v10
  v_ldexp_f32 v104, v104, v10
  v_ldexp_f32 v105, v105, v10
  v_ldexp_f32 v106, v106, v10
  v_ldexp_f32 v107, v107, v10
  v_ldexp_f32 v108, v108, v10
  v_ldexp_f32 v109, v109, v10
  v_ldexp_f32 v110, v110, v10
  v_ldexp_f32 v111, v111, v10
  v_ldexp_f32 v112, v112, v10
  v_ldexp_f32 v113, v113, v10
  v_ldexp_f32 v114, v114, v10
  v_ldexp_f32 v115, v115, v10
  v_ldexp_f32 v116, v116, v10
  v_ldexp_f32 v117, v117, v10
  v_ldexp_f32 v118, v118, v10
  v_ldexp_f32 v119, v119, v10
  v_ldexp_f32 v3, v3, v10
  v_exp_f32 v120, v160
  v_exp_f32 v121, v161
  v_add_f32 v4, v3, v120
  v_exp_f32 v122, v162
  v_add_f32 v4, v4, v121
  v_cvt_pk_bf16_f32 v192, v120, v121
  v_exp_f32 v123, v163
  v_add_f32 v4, v4, v122
  v_exp_f32 v124, v164
  v_add_f32 v4, v4, v123
  v_cvt_pk_bf16_f32 v193, v122, v123
  v_exp_f32 v125, v165
  v_add_f32 v4, v4, v124
  v_exp_f32 v126, v166
  v_add_f32 v4, v4, v125
  v_cvt_pk_bf16_f32 v194, v124, v125
  v_exp_f32 v127, v167
  v_add_f32 v4, v4, v126
  v_exp_f32 v120, v168
  v_add_f32 v4, v4, v127
  v_cvt_pk_bf16_f32 v195, v126, v127
  v_exp_f32 v121, v169
  v_add_f32 v4, v4, v120
  v_exp_f32 v122, v170
  v_add_f32 v4, v4, v121
  v_cvt_pk_bf16_f32 v196, v120, v121
  v_exp_f32 v123, v171
  v_add_f32 v4, v4, v122
  v_exp_f32 v124, v172
  v_add_f32 v4, v4, v123
  v_cvt_pk_bf16_f32 v197, v122, v123
  v_exp_f32 v125, v173
  v_add_f32 v4, v4, v124
  v_exp_f32 v126, v174
  v_add_f32 v4, v4, v125
  v_cvt_pk_bf16_f32 v198, v124, v125
  v_exp_f32 v127, v175
  v_add_f32 v4, v4, v126
  v_add_f32 v4, v4, v127
  v_cvt_pk_bf16_f32 v199, v126, v127
  s_nop 1
  s_branch main_kernel_back_38
main_kernel_rare_39:
  s_nop 15
  s_nop 15
  v_log_f32 v11, v4
  v_max3_f32 v9, v176, v177, v178
  v_max3_f32 v9, v9, v179, v180
  v_max3_f32 v9, v9, v181, v182
  v_max3_f32 v9, v9, v183, v184
  v_max3_f32 v9, v9, v185, v186
  v_max3_f32 v9, v9, v187, v188
  v_max3_f32 v9, v9, v189, v190
  v_max_f32 v9, v9, v191
  v_max_f32 v9, v9, v11
  v_mov_b32 v12, v9
  s_nop 1
  v_permlane32_swap_b32 v9, v12
  s_nop 1
  v_max_f32 v9, v9, v12
  v_ceil_f32 v9, v9
  v_max_f32 v9, 0, v9
  v_sub_f32 v10, 0, v9
  v_cvt_i32_f32 v10, v10
  v_sub_f32 v176, v176, v9
  v_sub_f32 v177, v177, v9
  v_sub_f32 v178, v178, v9
  v_sub_f32 v179, v179, v9
  v_sub_f32 v180, v180, v9
  v_sub_f32 v181, v181, v9
  v_sub_f32 v182, v182, v9
  v_sub_f32 v183, v183, v9
  v_sub_f32 v184, v184, v9
  v_sub_f32 v185, v185, v9
  v_sub_f32 v186, v186, v9
  v_sub_f32 v187, v187, v9
  v_sub_f32 v188, v188, v9
  v_sub_f32 v189, v189, v9
  v_sub_f32 v190, v190, v9
  v_sub_f32 v191, v191, v9
  v_sub_f32 v160, v160, v9
  v_sub_f32 v161, v161, v9
  v_sub_f32 v162, v162, v9
  v_sub_f32 v163, v163, v9
  v_sub_f32 v164, v164, v9
  v_sub_f32 v165, v165, v9
  v_sub_f32 v166, v166, v9
  v_sub_f32 v167, v167, v9
  v_sub_f32 v168, v168, v9
  v_sub_f32 v169, v169, v9
  v_sub_f32 v170, v170, v9
  v_sub_f32 v171, v171, v9
  v_sub_f32 v172, v172, v9
  v_sub_f32 v173, v173, v9
  v_sub_f32 v174, v174, v9
  v_sub_f32 v175, v175, v9
  v_sub_f32 v208, v208, v9
  v_sub_f32 v209, v209, v9
  v_sub_f32 v210, v210, v9
  v_sub_f32 v211, v211, v9
  v_sub_f32 v212, v212, v9
  v_sub_f32 v213, v213, v9
  v_sub_f32 v214, v214, v9
  v_sub_f32 v215, v215, v9
  v_sub_f32 v216, v216, v9
  v_sub_f32 v217, v217, v9
  v_sub_f32 v218, v218, v9
  v_sub_f32 v219, v219, v9
  v_sub_f32 v220, v220, v9
  v_sub_f32 v221, v221, v9
  v_sub_f32 v222, v222, v9
  v_sub_f32 v223, v223, v9
  v_ldexp_f32 v56, v56, v10
  v_ldexp_f32 v57, v57, v10
  v_ldexp_f32 v58, v58, v10
  v_ldexp_f32 v59, v59, v10
  v_ldexp_f32 v60, v60, v10
  v_ldexp_f32 v61, v61, v10
  v_ldexp_f32 v62, v62, v10
  v_ldexp_f32 v63, v63, v10
  v_ldexp_f32 v64, v64, v10
  v_ldexp_f32 v65, v65, v10
  v_ldexp_f32 v66, v66, v10
  v_ldexp_f32 v67, v67, v10
  v_ldexp_f32 v68, v68, v10
  v_ldexp_f32 v69, v69, v10
  v_ldexp_f32 v70, v70, v10
  v_ldexp_f32 v71, v71, v10
  v_ldexp_f32 v72, v72, v10
  v_ldexp_f32 v73, v73, v10
  v_ldexp_f32 v74, v74, v10
  v_ldexp_f32 v75, v75, v10
  v_ldexp_f32 v76, v76, v10
  v_ldexp_f32 v77, v77, v10
  v_ldexp_f32 v78, v78, v10
  v_ldexp_f32 v79, v79, v10
  v_ldexp_f32 v80, v80, v10
  v_ldexp_f32 v81, v81, v10
  v_ldexp_f32 v82, v82, v10
  v_ldexp_f32 v83, v83, v10
  v_ldexp_f32 v84, v84, v10
  v_ldexp_f32 v85, v85, v10
  v_ldexp_f32 v86, v86, v10
  v_ldexp_f32 v87, v87, v10
  v_ldexp_f32 v88, v88, v10
  v_ldexp_f32 v89, v89, v10
  v_ldexp_f32 v90, v90, v10
  v_ldexp_f32 v91, v91, v10
  v_ldexp_f32 v92, v92, v10
  v_ldexp_f32 v93, v93, v10
  v_ldexp_f32 v94, v94, v10
  v_ldexp_f32 v95, v95, v10
  v_ldexp_f32 v96, v96, v10
  v_ldexp_f32 v97, v97, v10
  v_ldexp_f32 v98, v98, v10
  v_ldexp_f32 v99, v99, v10
  v_ldexp_f32 v100, v100, v10
  v_ldexp_f32 v101, v101, v10
  v_ldexp_f32 v102, v102, v10
  v_ldexp_f32 v103, v103, v10
  v_ldexp_f32 v104, v104, v10
  v_ldexp_f32 v105, v105, v10
  v_ldexp_f32 v106, v106, v10
  v_ldexp_f32 v107, v107, v10
  v_ldexp_f32 v108, v108, v10
  v_ldexp_f32 v109, v109, v10
  v_ldexp_f32 v110, v110, v10
  v_ldexp_f32 v111, v111, v10
  v_ldexp_f32 v112, v112, v10
  v_ldexp_f32 v113, v113, v10
  v_ldexp_f32 v114, v114, v10
  v_ldexp_f32 v115, v115, v10
  v_ldexp_f32 v116, v116, v10
  v_ldexp_f32 v117, v117, v10
  v_ldexp_f32 v118, v118, v10
  v_ldexp_f32 v119, v119, v10
  v_ldexp_f32 v4, v4, v10
  v_exp_f32 v120, v176
  v_exp_f32 v121, v177
  v_add_f32 v3, v4, v120
  v_exp_f32 v122, v178
  v_add_f32 v3, v3, v121
  v_cvt_pk_bf16_f32 v200, v120, v121
  v_exp_f32 v123, v179
  v_add_f32 v3, v3, v122
  v_exp_f32 v124, v180
  v_add_f32 v3, v3, v123
  v_cvt_pk_bf16_f32 v201, v122, v123
  v_exp_f32 v125, v181
  v_add_f32 v3, v3, v124
  v_exp_f32 v126, v182
  v_add_f32 v3, v3, v125
  v_cvt_pk_bf16_f32 v202, v124, v125
  v_exp_f32 v127, v183
  v_add_f32 v3, v3, v126
  v_exp_f32 v120, v184
  v_add_f32 v3, v3, v127
  v_cvt_pk_bf16_f32 v203, v126, v127
  v_exp_f32 v121, v185
  v_add_f32 v3, v3, v120
  v_exp_f32 v122, v186
  v_add_f32 v3, v3, v121
  v_cvt_pk_bf16_f32 v204, v120, v121
  v_exp_f32 v123, v187
  v_add_f32 v3, v3, v122
  v_exp_f32 v124, v188
  v_add_f32 v3, v3, v123
  v_cvt_pk_bf16_f32 v205, v122, v123
  v_exp_f32 v125, v189
  v_add_f32 v3, v3, v124
  v_exp_f32 v126, v190
  v_add_f32 v3, v3, v125
  v_cvt_pk_bf16_f32 v206, v124, v125
  v_exp_f32 v127, v191
  v_add_f32 v3, v3, v126
  v_add_f32 v3, v3, v127
  v_cvt_pk_bf16_f32 v207, v126, v127
  s_nop 1
  s_branch main_kernel_back_40
main_kernel_done:
  s_endpgm
.globl out_kernel
.p2align 8
.type out_kernel,@function
out_kernel:
  s_cmp_ge_u32 s2, 256
  s_cbranch_scc1 out_kernel_done
  s_load_dwordx2 s[4:5], s[0:1], 40
  s_load_dwordx2 s[6:7], s[0:1], 104
  s_load_dwordx2 s[48:49], s[0:1], 80
  s_load_dwordx2 s[50:51], s[0:1], 0
  s_load_dwordx2 s[52:53], s[0:1], 88
  v_lshrrev_b32 v1, 6, v0
  v_and_b32 v2, 63, v0
  v_lshlrev_b32 v3, 4, v2
  v_readfirstlane_b32 s32, v1
  s_and_b32 s35, s2, 3
  s_bfe_u32 s36, s2, 0x10002
  s_lshl_b32 s36, s36, 3
  s_bfe_u32 s33, s2, 0x30003
  s_add_u32 s36, s36, s33
  s_lshr_b32 s37, s2, 6
  s_and_b32 s38, s32, 3
  s_lshr_b32 s39, s32, 2
  v_lshrrev_b32 v5, 4, v2
  v_and_b32 v6, 15, v2
  v_lshlrev_b32 v7, 2, v5
  v_xor_b32 v6, v7, v6
  v_lshlrev_b32 v5, 10, v5
  v_lshl_add_u32 v4, v6, 4, v5
  s_lshl_b32 s33, s35, 1
  s_add_u32 s33, s33, s39
  s_mul_i32 s40, s33, 43
  s_cmp_eq_u32 s33, 5
  s_cselect_b32 s34, 1, 0
  s_sub_u32 s40, s40, s34
  s_cmp_ge_u32 s33, 4
  s_cselect_b32 s41, 42, 43
  s_lshl_b32 s34, s36, 2
  s_add_u32 s34, s34, s38
  s_lshl_b32 s54, s34, 18
  s_add_u32 s54, s54, 0x2400000
  s_mul_i32 s55, s34, 88064
  s_add_u32 s55, s55, 0x3800000
  s_mul_i32 s43, s39, 43
  s_cmp_eq_u32 s35, 3
  s_cselect_b32 s40, s43, s40
  s_cselect_b32 s41, 43, s41
  s_cselect_b32 s54, s55, s54
  s_waitcnt lgkmcnt(0)
  s_cmp_eq_u32 s35, 3
  s_cselect_b32 s4, s48, s4
  s_cselect_b32 s5, s49, s5
  s_lshl_b32 s33, s40, 14
  s_lshl_b32 s34, s37, 8
  s_add_u32 s33, s33, s34
  s_add_u32 s8, s4, s33
  s_addc_u32 s9, s5, 0
  s_lshl_b32 s10, s41, 14
  s_sub_u32 s10, s10, s34
  s_mov_b32 s11, 0x00020000
  s_lshl_b32 s33, s40, 10
  s_add_u32 s54, s54, s33
  s_add_u32 s12, s6, s54
  s_addc_u32 s13, s7, 0
  s_lshl_b32 s14, s41, 10
  s_mov_b32 s15, 0x00020000
  s_lshl_b32 s42, s39, 16
  s_lshl_b32 s33, s38, 10
  s_add_u32 s42, s42, s33
  s_lshl_b32 s43, s38, 12
  s_add_u32 m0, s42, 0
  s_add_u32 s33, s43, 0
  buffer_load_dwordx4 v4, s[8:11], s33 offen lds
  s_mov_b32 s34, 0
  buffer_load_dwordx4 v[64:67], v3, s[12:15], s34 offen
  s_add_u32 m0, s42, 4096
  s_add_u32 s33, s43, 16384
  buffer_load_dwordx4 v4, s[8:11], s33 offen lds
  s_mov_b32 s34, 0
  buffer_load_dwordx4 v[68:71], v3, s[12:15], s34 offen offset:1024
  s_add_u32 m0, s42, 8192
  s_add_u32 s33, s43, 32768
  buffer_load_dwordx4 v4, s[8:11], s33 offen lds
  s_mov_b32 s34, 0
  buffer_load_dwordx4 v[72:75], v3, s[12:15], s34 offen offset:2048
  s_add_u32 m0, s42, 12288
  s_add_u32 s33, s43, 49152
  buffer_load_dwordx4 v4, s[8:11], s33 offen lds
  s_mov_b32 s34, 0
  buffer_load_dwordx4 v[76:79], v3, s[12:15], s34 offen offset:3072
  s_mov_b32 s16, s52
  s_mov_b32 s17, s53
  s_mov_b32 s18, 0x200000
  s_mov_b32 s19, 0x00020000
  s_mov_b32 s20, s50
  s_mov_b32 s21, s51
  s_mov_b32 s22, 0x200000
  s_mov_b32 s23, 0x00020000
  s_add_u32 s24, s6, 0x3600000
  s_addc_u32 s25, s7, 0
  s_mov_b32 s26, 0x200000
  s_mov_b32 s27, 0x00020000
  s_add_u32 s28, s6, 0x4800000
  s_addc_u32 s29, s7, 0
  s_mov_b32 s30, 0x600000
  s_mov_b32 s31, 0x00020000
  v_and_b32 v5, 31, v2
  v_lshrrev_b32 v6, 5, v2
  v_bfe_u32 v7, v2, 2, 2
  v_lshl_add_u32 v8, v6, 2, v7
  v_lshlrev_b32 v8, 8, v8
  v_bfe_u32 v9, v2, 4, 1
  v_lshl_add_u32 v8, v9, 5, v8
  v_and_b32 v9, 3, v2
  v_lshl_add_u32 v8, v9, 3, v8
  s_lshl_b32 s33, s39, 16
  v_add_u32 v8, s33, v8
  s_lshl_b32 s33, s39, 1
  v_xor_b32 v7, s33, v7
  v_xor_b32 v9, 0, v7
  v_lshl_add_u32 v10, v9, 6, v8
  v_xor_b32 v9, 1, v7
  v_lshl_add_u32 v11, v9, 6, v8
  v_xor_b32 v9, 2, v7
  v_lshl_add_u32 v12, v9, 6, v8
  v_xor_b32 v9, 3, v7
  v_lshl_add_u32 v13, v9, 6, v8
  s_lshl_b32 s33, s36, 2
  s_add_u32 s33, s33, s35
  s_lshl_b32 s33, s33, 15
  s_lshl_b32 s34, s37, 3
  s_add_u32 s34, s34, s32
  s_lshl_b32 s45, s34, 10
  s_add_u32 s45, s45, s33
  s_lshl_b32 s46, s34, 5
  s_add_u32 s46, s46, s33
  v_lshlrev_b32 v16, 10, v5
  v_lshl_add_u32 v16, v6, 3, v16
  s_add_u32 m0, s42, 16384
  s_add_u32 s33, s43, 65536
  buffer_load_dwordx4 v4, s[8:11], s33 offen lds
  s_mov_b32 s34, 4096
  buffer_load_dwordx4 v[80:83], v3, s[12:15], s34 offen
  s_add_u32 m0, s42, 20480
  s_add_u32 s33, s43, 81920
  buffer_load_dwordx4 v4, s[8:11], s33 offen lds
  s_mov_b32 s34, 4096
  buffer_load_dwordx4 v[84:87], v3, s[12:15], s34 offen offset:1024
  s_add_u32 m0, s42, 24576
  s_add_u32 s33, s43, 98304
  buffer_load_dwordx4 v4, s[8:11], s33 offen lds
  s_mov_b32 s34, 4096
  buffer_load_dwordx4 v[88:91], v3, s[12:15], s34 offen offset:2048
  s_add_u32 m0, s42, 28672
  s_add_u32 s33, s43, 114688
  buffer_load_dwordx4 v4, s[8:11], s33 offen lds
  s_mov_b32 s34, 4096
  buffer_load_dwordx4 v[92:95], v3, s[12:15], s34 offen offset:3072
  s_waitcnt vmcnt(12)
  s_barrier
  ds_read_b64_tr_b16 v[192:193], v10 offset:0
  ds_read_b64_tr_b16 v[194:195], v10 offset:2048
  ds_read_b64_tr_b16 v[196:197], v11 offset:0
  ds_read_b64_tr_b16 v[198:199], v11 offset:2048
  ds_read_b64_tr_b16 v[200:201], v12 offset:0
  ds_read_b64_tr_b16 v[202:203], v12 offset:2048
  ds_read_b64_tr_b16 v[204:205], v13 offset:0
  ds_read_b64_tr_b16 v[206:207], v13 offset:2048
  s_waitcnt vmcnt(8)
  s_barrier
  s_waitcnt lgkmcnt(6)
  v_mfma_f32_32x32x16_bf16 v[128:143], v[192:195], v[64:67], 0
  ds_read_b64_tr_b16 v[208:209], v10 offset:4096
  ds_read_b64_tr_b16 v[210:211], v10 offset:6144
  s_waitcnt lgkmcnt(6)
  v_mfma_f32_32x32x16_bf16 v[144:159], v[196:199], v[64:67], 0
  ds_read_b64_tr_b16 v[212:213], v11 offset:4096
  ds_read_b64_tr_b16 v[214:215], v11 offset:6144
  s_add_u32 m0, s42, 32768
  s_add_u32 s33, s43, 131072
  buffer_load_dwordx4 v4, s[8:11], s33 offen lds
  s_mov_b32 s34, 8192
  buffer_load_dwordx4 v[96:99], v3, s[12:15], s34 offen
  s_waitcnt lgkmcnt(6)
  v_mfma_f32_32x32x16_bf16 v[160:175], v[200:203], v[64:67], 0
  ds_read_b64_tr_b16 v[216:217], v12 offset:4096
  ds_read_b64_tr_b16 v[218:219], v12 offset:6144
  s_waitcnt lgkmcnt(6)
  v_mfma_f32_32x32x16_bf16 v[176:191], v[204:207], v[64:67], 0
  ds_read_b64_tr_b16 v[220:221], v13 offset:4096
  ds_read_b64_tr_b16 v[222:223], v13 offset:6144
  s_add_u32 m0, s42, 36864
  s_add_u32 s33, s43, 147456
  buffer_load_dwordx4 v4, s[8:11], s33 offen lds
  s_mov_b32 s34, 8192
  buffer_load_dwordx4 v[100:103], v3, s[12:15], s34 offen offset:1024
  s_waitcnt lgkmcnt(6)
  v_mfma_f32_32x32x16_bf16 v[128:143], v[208:211], v[68:71], v[128:143]
  ds_read_b64_tr_b16 v[192:193], v10 offset:8192
  ds_read_b64_tr_b16 v[194:195], v10 offset:10240
  s_waitcnt lgkmcnt(6)
  v_mfma_f32_32x32x16_bf16 v[144:159], v[212:215], v[68:71], v[144:159]
  ds_read_b64_tr_b16 v[196:197], v11 offset:8192
  ds_read_b64_tr_b16 v[198:199], v11 offset:10240
  s_add_u32 m0, s42, 40960
  s_add_u32 s33, s43, 163840
  buffer_load_dwordx4 v4, s[8:11], s33 offen lds
  s_mov_b32 s34, 8192
  buffer_load_dwordx4 v[104:107], v3, s[12:15], s34 offen offset:2048
  s_waitcnt lgkmcnt(6)
  v_mfma_f32_32x32x16_bf16 v[160:175], v[216:219], v[68:71], v[160:175]
  ds_read_b64_tr_b16 v[200:201], v12 offset:8192
  ds_read_b64_tr_b16 v[202:203], v12 offset:10240
  s_waitcnt lgkmcnt(6)
  v_mfma_f32_32x32x16_bf16 v[176:191], v[220:223], v[68:71], v[176:191]
  ds_read_b64_tr_b16 v[204:205], v13 offset:8192
  ds_read_b64_tr_b16 v[206:207], v13 offset:10240
  s_add_u32 m0, s42, 45056
  s_add_u32 s33, s43, 180224
  buffer_load_dwordx4 v4, s[8:11], s33 offen lds
  s_mov_b32 s34, 8192
  buffer_load_dwordx4 v[108:111], v3, s[12:15], s34 offen offset:3072
  s_waitcnt vmcnt(12)
  s_barrier
  s_waitcnt lgkmcnt(6)
  v_mfma_f32_32x32x16_bf16 v[128:143], v[192:195], v[72:75], v[128:143]
  ds_read_b64_tr_b16 v[208:209], v10 offset:12288
  ds_read_b64_tr_b16 v[210:211], v10 offset:14336
  s_waitcnt lgkmcnt(6)
  v_mfma_f32_32x32x16_bf16 v[144:159], v[196:199], v[72:75], v[144:159]
  ds_read_b64_tr_b16 v[212:213], v11 offset:12288
  ds_read_b64_tr_b16 v[214:215], v11 offset:14336
  s_add_u32 m0, s42, 49152
  s_add_u32 s33, s43, 196608
  buffer_load_dwordx4 v4, s[8:11], s33 offen lds
  s_mov_b32 s34, 12288
  buffer_load_dwordx4 v[112:115], v3, s[12:15], s34 offen
  s_waitcnt lgkmcnt(6)
  v_mfma_f32_32x32x16_bf16 v[160:175], v[200:203], v[72:75], v[160:175]
  ds_read_b64_tr_b16 v[216:217], v12 offset:12288
  ds_read_b64_tr_b16 v[218:219], v12 offset:14336
  s_waitcnt lgkmcnt(6)
  v_mfma_f32_32x32x16_bf16 v[176:191], v[204:207], v[72:75], v[176:191]
  ds_read_b64_tr_b16 v[220:221], v13 offset:12288
  ds_read_b64_tr_b16 v[222:223], v13 offset:14336
  s_add_u32 m0, s42, 53248
  s_add_u32 s33, s43, 212992
  buffer_load_dwordx4 v4, s[8:11], s33 offen lds
  s_mov_b32 s34, 12288
  buffer_load_dwordx4 v[116:119], v3, s[12:15], s34 offen offset:1024
  s_waitcnt lgkmcnt(6)
  v_mfma_f32_32x32x16_bf16 v[128:143], v[208:211], v[76:79], v[128:143]
  ds_read_b64_tr_b16 v[192:193], v10 offset:16384
  ds_read_b64_tr_b16 v[194:195], v10 offset:18432
  s_waitcnt lgkmcnt(6)
  v_mfma_f32_32x32x16_bf16 v[144:159], v[212:215], v[76:79], v[144:159]
  ds_read_b64_tr_b16 v[196:197], v11 offset:16384
  ds_read_b64_tr_b16 v[198:199], v11 offset:18432
  s_add_u32 m0, s42, 57344
  s_add_u32 s33, s43, 229376
  buffer_load_dwordx4 v4, s[8:11], s33 offen lds
  s_mov_b32 s34, 12288
  buffer_load_dwordx4 v[120:123], v3, s[12:15], s34 offen offset:2048
  s_waitcnt lgkmcnt(6)
  v_mfma_f32_32x32x16_bf16 v[160:175], v[216:219], v[76:79], v[160:175]
  ds_read_b64_tr_b16 v[200:201], v12 offset:16384
  ds_read_b64_tr_b16 v[202:203], v12 offset:18432
  s_waitcnt lgkmcnt(6)
  v_mfma_f32_32x32x16_bf16 v[176:191], v[220:223], v[76:79], v[176:191]
  ds_read_b64_tr_b16 v[204:205], v13 offset:16384
  ds_read_b64_tr_b16 v[206:207], v13 offset:18432
  s_add_u32 m0, s42, 61440
  s_add_u32 s33, s43, 245760
  buffer_load_dwordx4 v4, s[8:11], s33 offen lds
  s_mov_b32 s34, 12288
  buffer_load_dwordx4 v[124:127], v3, s[12:15], s34 offen offset:3072
  s_waitcnt vmcnt(16)
  s_barrier
  s_waitcnt lgkmcnt(6)
  v_mfma_f32_32x32x16_bf16 v[128:143], v[192:195], v[80:83], v[128:143]
  ds_read_b64_tr_b16 v[208:209], v10 offset:20480
  ds_read_b64_tr_b16 v[210:211], v10 offset:22528
  s_waitcnt lgkmcnt(6)
  v_mfma_f32_32x32x16_bf16 v[144:159], v[196:199], v[80:83], v[144:159]
  ds_read_b64_tr_b16 v[212:213], v11 offset:20480
  ds_read_b64_tr_b16 v[214:215], v11 offset:22528
  s_add_u32 m0, s42, 0
  s_add_u32 s33, s43, 262144
  buffer_load_dwordx4 v4, s[8:11], s33 offen lds
  s_mov_b32 s34, 16384
  buffer_load_dwordx4 v[64:67], v3, s[12:15], s34 offen
  s_waitcnt lgkmcnt(6)
  v_mfma_f32_32x32x16_bf16 v[160:175], v[200:203], v[80:83], v[160:175]
  ds_read_b64_tr_b16 v[216:217], v12 offset:20480
  ds_read_b64_tr_b16 v[218:219], v12 offset:22528
  s_waitcnt lgkmcnt(6)
  v_mfma_f32_32x32x16_bf16 v[176:191], v[204:207], v[80:83], v[176:191]
  ds_read_b64_tr_b16 v[220:221], v13 offset:20480
  ds_read_b64_tr_b16 v[222:223], v13 offset:22528
  s_add_u32 m0, s42, 4096
  s_add_u32 s33, s43, 278528
  buffer_load_dwordx4 v4, s[8:11], s33 offen lds
  s_mov_b32 s34, 16384
  buffer_load_dwordx4 v[68:71], v3, s[12:15], s34 offen offset:1024
  s_waitcnt lgkmcnt(6)
  v_mfma_f32_32x32x16_bf16 v[128:143], v[208:211], v[84:87], v[128:143]
  ds_read_b64_tr_b16 v[192:193], v10 offset:24576
  ds_read_b64_tr_b16 v[194:195], v10 offset:26624
  s_waitcnt lgkmcnt(6)
  v_mfma_f32_32x32x16_bf16 v[144:159], v[212:215], v[84:87], v[144:159]
  ds_read_b64_tr_b16 v[196:197], v11 offset:24576
  ds_read_b64_tr_b16 v[198:199], v11 offset:26624
  s_add_u32 m0, s42, 8192
  s_add_u32 s33, s43, 294912
  buffer_load_dwordx4 v4, s[8:11], s33 offen lds
  s_mov_b32 s34, 16384
  buffer_load_dwordx4 v[72:75], v3, s[12:15], s34 offen offset:2048
  s_waitcnt lgkmcnt(6)
  v_mfma_f32_32x32x16_bf16 v[160:175], v[216:219], v[84:87], v[160:175]
  ds_read_b64_tr_b16 v[200:201], v12 offset:24576
  ds_read_b64_tr_b16 v[202:203], v12 offset:26624
  s_waitcnt lgkmcnt(6)
  v_mfma_f32_32x32x16_bf16 v[176:191], v[220:223], v[84:87], v[176:191]
  ds_read_b64_tr_b16 v[204:205], v13 offset:24576
  ds_read_b64_tr_b16 v[206:207], v13 offset:26624
  s_add_u32 m0, s42, 12288
  s_add_u32 s33, s43, 311296
  buffer_load_dwordx4 v4, s[8:11], s33 offen lds
  s_mov_b32 s34, 16384
  buffer_load_dwordx4 v[76:79], v3, s[12:15], s34 offen offset:3072
  s_waitcnt vmcnt(20)
  s_barrier
  s_waitcnt lgkmcnt(6)
  v_mfma_f32_32x32x16_bf16 v[128:143], v[192:195], v[88:91], v[128:143]
  ds_read_b64_tr_b16 v[208:209], v10 offset:28672
  ds_read_b64_tr_b16 v[210:211], v10 offset:30720
  s_waitcnt lgkmcnt(6)
  v_mfma_f32_32x32x16_bf16 v[144:159], v[196:199], v[88:91], v[144:159]
  ds_read_b64_tr_b16 v[212:213], v11 offset:28672
  ds_read_b64_tr_b16 v[214:215], v11 offset:30720
  s_add_u32 m0, s42, 16384
  s_add_u32 s33, s43, 327680
  buffer_load_dwordx4 v4, s[8:11], s33 offen lds
  s_mov_b32 s34, 20480
  buffer_load_dwordx4 v[80:83], v3, s[12:15], s34 offen
  s_waitcnt lgkmcnt(6)
  v_mfma_f32_32x32x16_bf16 v[160:175], v[200:203], v[88:91], v[160:175]
  ds_read_b64_tr_b16 v[216:217], v12 offset:28672
  ds_read_b64_tr_b16 v[218:219], v12 offset:30720
  s_waitcnt lgkmcnt(6)
  v_mfma_f32_32x32x16_bf16 v[176:191], v[204:207], v[88:91], v[176:191]
  ds_read_b64_tr_b16 v[220:221], v13 offset:28672
  ds_read_b64_tr_b16 v[222:223], v13 offset:30720
  s_waitcnt lgkmcnt(6)
  v_mfma_f32_32x32x16_bf16 v[128:143], v[208:211], v[92:95], v[128:143]
  ds_read_b64_tr_b16 v[192:193], v10 offset:32768
  ds_read_b64_tr_b16 v[194:195], v10 offset:34816
  s_waitcnt lgkmcnt(6)
  v_mfma_f32_32x32x16_bf16 v[144:159], v[212:215], v[92:95], v[144:159]
  ds_read_b64_tr_b16 v[196:197], v11 offset:32768
  ds_read_b64_tr_b16 v[198:199], v11 offset:34816
  s_add_u32 m0, s42, 20480
  s_add_u32 s33, s43, 344064
  buffer_load_dwordx4 v4, s[8:11], s33 offen lds
  s_mov_b32 s34, 20480
  buffer_load_dwordx4 v[84:87], v3, s[12:15], s34 offen offset:1024
  s_waitcnt lgkmcnt(6)
  v_mfma_f32_32x32x16_bf16 v[160:175], v[216:219], v[92:95], v[160:175]
  ds_read_b64_tr_b16 v[200:201], v12 offset:32768
  ds_read_b64_tr_b16 v[202:203], v12 offset:34816
  s_waitcnt lgkmcnt(6)
  v_mfma_f32_32x32x16_bf16 v[176:191], v[220:223], v[92:95], v[176:191]
  ds_read_b64_tr_b16 v[204:205], v13 offset:32768
  ds_read_b64_tr_b16 v[206:207], v13 offset:34816
  s_waitcnt vmcnt(20)
  s_barrier
  s_waitcnt lgkmcnt(6)
  v_mfma_f32_32x32x16_bf16 v[128:143], v[192:195], v[96:99], v[128:143]
  ds_read_b64_tr_b16 v[208:209], v10 offset:36864
  ds_read_b64_tr_b16 v[210:211], v10 offset:38912
  s_waitcnt lgkmcnt(6)
  v_mfma_f32_32x32x16_bf16 v[144:159], v[196:199], v[96:99], v[144:159]
  ds_read_b64_tr_b16 v[212:213], v11 offset:36864
  ds_read_b64_tr_b16 v[214:215], v11 offset:38912
  s_add_u32 m0, s42, 24576
  s_add_u32 s33, s43, 360448
  buffer_load_dwordx4 v4, s[8:11], s33 offen lds
  s_mov_b32 s34, 20480
  buffer_load_dwordx4 v[88:91], v3, s[12:15], s34 offen offset:2048
  s_waitcnt lgkmcnt(6)
  v_mfma_f32_32x32x16_bf16 v[160:175], v[200:203], v[96:99], v[160:175]
  ds_read_b64_tr_b16 v[216:217], v12 offset:36864
  ds_read_b64_tr_b16 v[218:219], v12 offset:38912
  s_waitcnt lgkmcnt(6)
  v_mfma_f32_32x32x16_bf16 v[176:191], v[204:207], v[96:99], v[176:191]
  ds_read_b64_tr_b16 v[220:221], v13 offset:36864
  ds_read_b64_tr_b16 v[222:223], v13 offset:38912
  s_waitcnt lgkmcnt(6)
  v_mfma_f32_32x32x16_bf16 v[128:143], v[208:211], v[100:103], v[128:143]
  ds_read_b64_tr_b16 v[192:193], v10 offset:40960
  ds_read_b64_tr_b16 v[194:195], v10 offset:43008
  s_waitcnt lgkmcnt(6)
  v_mfma_f32_32x32x16_bf16 v[144:159], v[212:215], v[100:103], v[144:159]
  ds_read_b64_tr_b16 v[196:197], v11 offset:40960
  ds_read_b64_tr_b16 v[198:199], v11 offset:43008
  s_add_u32 m0, s42, 28672
  s_add_u32 s33, s43, 376832
  buffer_load_dwordx4 v4, s[8:11], s33 offen lds
  s_mov_b32 s34, 20480
  buffer_load_dwordx4 v[92:95], v3, s[12:15], s34 offen offset:3072
  s_waitcnt lgkmcnt(6)
  v_mfma_f32_32x32x16_bf16 v[160:175], v[216:219], v[100:103], v[160:175]
  ds_read_b64_tr_b16 v[200:201], v12 offset:40960
  ds_read_b64_tr_b16 v[202:203], v12 offset:43008
  s_waitcnt lgkmcnt(6)
  v_mfma_f32_32x32x16_bf16 v[176:191], v[220:223], v[100:103], v[176:191]
  ds_read_b64_tr_b16 v[204:205], v13 offset:40960
  ds_read_b64_tr_b16 v[206:207], v13 offset:43008
  s_waitcnt vmcnt(20)
  s_barrier
  s_waitcnt lgkmcnt(6)
  v_mfma_f32_32x32x16_bf16 v[128:143], v[192:195], v[104:107], v[128:143]
  ds_read_b64_tr_b16 v[208:209], v10 offset:45056
  ds_read_b64_tr_b16 v[210:211], v10 offset:47104
  s_waitcnt lgkmcnt(6)
  v_mfma_f32_32x32x16_bf16 v[144:159], v[196:199], v[104:107], v[144:159]
  ds_read_b64_tr_b16 v[212:213], v11 offset:45056
  ds_read_b64_tr_b16 v[214:215], v11 offset:47104
  s_add_u32 m0, s42, 32768
  s_add_u32 s33, s43, 393216
  buffer_load_dwordx4 v4, s[8:11], s33 offen lds
  s_mov_b32 s34, 24576
  buffer_load_dwordx4 v[96:99], v3, s[12:15], s34 offen
  s_waitcnt lgkmcnt(6)
  v_mfma_f32_32x32x16_bf16 v[160:175], v[200:203], v[104:107], v[160:175]
  ds_read_b64_tr_b16 v[216:217], v12 offset:45056
  ds_read_b64_tr_b16 v[218:219], v12 offset:47104
  s_waitcnt lgkmcnt(6)
  v_mfma_f32_32x32x16_bf16 v[176:191], v[204:207], v[104:107], v[176:191]
  ds_read_b64_tr_b16 v[220:221], v13 offset:45056
  ds_read_b64_tr_b16 v[222:223], v13 offset:47104
  s_waitcnt lgkmcnt(6)
  v_mfma_f32_32x32x16_bf16 v[128:143], v[208:211], v[108:111], v[128:143]
  ds_read_b64_tr_b16 v[192:193], v10 offset:49152
  ds_read_b64_tr_b16 v[194:195], v10 offset:51200
  s_waitcnt lgkmcnt(6)
  v_mfma_f32_32x32x16_bf16 v[144:159], v[212:215], v[108:111], v[144:159]
  ds_read_b64_tr_b16 v[196:197], v11 offset:49152
  ds_read_b64_tr_b16 v[198:199], v11 offset:51200
  s_add_u32 m0, s42, 36864
  s_add_u32 s33, s43, 409600
  buffer_load_dwordx4 v4, s[8:11], s33 offen lds
  s_mov_b32 s34, 24576
  buffer_load_dwordx4 v[100:103], v3, s[12:15], s34 offen offset:1024
  s_waitcnt lgkmcnt(6)
  v_mfma_f32_32x32x16_bf16 v[160:175], v[216:219], v[108:111], v[160:175]
  ds_read_b64_tr_b16 v[200:201], v12 offset:49152
  ds_read_b64_tr_b16 v[202:203], v12 offset:51200
  s_waitcnt lgkmcnt(6)
  v_mfma_f32_32x32x16_bf16 v[176:191], v[220:223], v[108:111], v[176:191]
  ds_read_b64_tr_b16 v[204:205], v13 offset:49152
  ds_read_b64_tr_b16 v[206:207], v13 offset:51200
  s_waitcnt vmcnt(20)
  s_barrier
  s_waitcnt lgkmcnt(6)
  v_mfma_f32_32x32x16_bf16 v[128:143], v[192:195], v[112:115], v[128:143]
  ds_read_b64_tr_b16 v[208:209], v10 offset:53248
  ds_read_b64_tr_b16 v[210:211], v10 offset:55296
  s_waitcnt lgkmcnt(6)
  v_mfma_f32_32x32x16_bf16 v[144:159], v[196:199], v[112:115], v[144:159]
  ds_read_b64_tr_b16 v[212:213], v11 offset:53248
  ds_read_b64_tr_b16 v[214:215], v11 offset:55296
  s_add_u32 m0, s42, 40960
  s_add_u32 s33, s43, 425984
  buffer_load_dwordx4 v4, s[8:11], s33 offen lds
  s_mov_b32 s34, 24576
  buffer_load_dwordx4 v[104:107], v3, s[12:15], s34 offen offset:2048
  s_waitcnt lgkmcnt(6)
  v_mfma_f32_32x32x16_bf16 v[160:175], v[200:203], v[112:115], v[160:175]
  ds_read_b64_tr_b16 v[216:217], v12 offset:53248
  ds_read_b64_tr_b16 v[218:219], v12 offset:55296
  s_waitcnt lgkmcnt(6)
  v_mfma_f32_32x32x16_bf16 v[176:191], v[204:207], v[112:115], v[176:191]
  ds_read_b64_tr_b16 v[220:221], v13 offset:53248
  ds_read_b64_tr_b16 v[222:223], v13 offset:55296
  s_waitcnt lgkmcnt(6)
  v_mfma_f32_32x32x16_bf16 v[128:143], v[208:211], v[116:119], v[128:143]
  ds_read_b64_tr_b16 v[192:193], v10 offset:57344
  ds_read_b64_tr_b16 v[194:195], v10 offset:59392
  s_waitcnt lgkmcnt(6)
  v_mfma_f32_32x32x16_bf16 v[144:159], v[212:215], v[116:119], v[144:159]
  ds_read_b64_tr_b16 v[196:197], v11 offset:57344
  ds_read_b64_tr_b16 v[198:199], v11 offset:59392
  s_add_u32 m0, s42, 45056
  s_add_u32 s33, s43, 442368
  buffer_load_dwordx4 v4, s[8:11], s33 offen lds
  s_mov_b32 s34, 24576
  buffer_load_dwordx4 v[108:111], v3, s[12:15], s34 offen offset:3072
  s_waitcnt lgkmcnt(6)
  v_mfma_f32_32x32x16_bf16 v[160:175], v[216:219], v[116:119], v[160:175]
  ds_read_b64_tr_b16 v[200:201], v12 offset:57344
  ds_read_b64_tr_b16 v[202:203], v12 offset:59392
  s_waitcnt lgkmcnt(6)
  v_mfma_f32_32x32x16_bf16 v[176:191], v[220:223], v[116:119], v[176:191]
  ds_read_b64_tr_b16 v[204:205], v13 offset:57344
  ds_read_b64_tr_b16 v[206:207], v13 offset:59392
  s_waitcnt vmcnt(20)
  s_barrier
  s_waitcnt lgkmcnt(6)
  v_mfma_f32_32x32x16_bf16 v[128:143], v[192:195], v[120:123], v[128:143]
  ds_read_b64_tr_b16 v[208:209], v10 offset:61440
  ds_read_b64_tr_b16 v[210:211], v10 offset:63488
  s_waitcnt lgkmcnt(6)
  v_mfma_f32_32x32x16_bf16 v[144:159], v[196:199], v[120:123], v[144:159]
  ds_read_b64_tr_b16 v[212:213], v11 offset:61440
  ds_read_b64_tr_b16 v[214:215], v11 offset:63488
  s_add_u32 m0, s42, 49152
  s_add_u32 s33, s43, 458752
  buffer_load_dwordx4 v4, s[8:11], s33 offen lds
  s_mov_b32 s34, 28672
  buffer_load_dwordx4 v[112:115], v3, s[12:15], s34 offen
  s_waitcnt lgkmcnt(6)
  v_mfma_f32_32x32x16_bf16 v[160:175], v[200:203], v[120:123], v[160:175]
  ds_read_b64_tr_b16 v[216:217], v12 offset:61440
  ds_read_b64_tr_b16 v[218:219], v12 offset:63488
  s_waitcnt lgkmcnt(6)
  v_mfma_f32_32x32x16_bf16 v[176:191], v[204:207], v[120:123], v[176:191]
  ds_read_b64_tr_b16 v[220:221], v13 offset:61440
  ds_read_b64_tr_b16 v[222:223], v13 offset:63488
  s_waitcnt lgkmcnt(6)
  v_mfma_f32_32x32x16_bf16 v[128:143], v[208:211], v[124:127], v[128:143]
  ds_read_b64_tr_b16 v[192:193], v10 offset:0
  ds_read_b64_tr_b16 v[194:195], v10 offset:2048
  s_waitcnt lgkmcnt(6)
  v_mfma_f32_32x32x16_bf16 v[144:159], v[212:215], v[124:127], v[144:159]
  ds_read_b64_tr_b16 v[196:197], v11 offset:0
  ds_read_b64_tr_b16 v[198:199], v11 offset:2048
  s_add_u32 m0, s42, 53248
  s_add_u32 s33, s43, 475136
  buffer_load_dwordx4 v4, s[8:11], s33 offen lds
  s_mov_b32 s34, 28672
  buffer_load_dwordx4 v[116:119], v3, s[12:15], s34 offen offset:1024
  s_waitcnt lgkmcnt(6)
  v_mfma_f32_32x32x16_bf16 v[160:175], v[216:219], v[124:127], v[160:175]
  ds_read_b64_tr_b16 v[200:201], v12 offset:0
  ds_read_b64_tr_b16 v[202:203], v12 offset:2048
  s_waitcnt lgkmcnt(6)
  v_mfma_f32_32x32x16_bf16 v[176:191], v[220:223], v[124:127], v[176:191]
  ds_read_b64_tr_b16 v[204:205], v13 offset:0
  ds_read_b64_tr_b16 v[206:207], v13 offset:2048
  s_waitcnt vmcnt(20)
  s_barrier
  s_waitcnt lgkmcnt(6)
  v_mfma_f32_32x32x16_bf16 v[128:143], v[192:195], v[64:67], v[128:143]
  ds_read_b64_tr_b16 v[208:209], v10 offset:4096
  ds_read_b64_tr_b16 v[210:211], v10 offset:6144
  s_waitcnt lgkmcnt(6)
  v_mfma_f32_32x32x16_bf16 v[144:159], v[196:199], v[64:67], v[144:159]
  ds_read_b64_tr_b16 v[212:213], v11 offset:4096
  ds_read_b64_tr_b16 v[214:215], v11 offset:6144
  s_add_u32 m0, s42, 57344
  s_add_u32 s33, s43, 491520
  buffer_load_dwordx4 v4, s[8:11], s33 offen lds
  s_mov_b32 s34, 28672
  buffer_load_dwordx4 v[120:123], v3, s[12:15], s34 offen offset:2048
  s_waitcnt lgkmcnt(6)
  v_mfma_f32_32x32x16_bf16 v[160:175], v[200:203], v[64:67], v[160:175]
  ds_read_b64_tr_b16 v[216:217], v12 offset:4096
  ds_read_b64_tr_b16 v[218:219], v12 offset:6144
  s_waitcnt lgkmcnt(6)
  v_mfma_f32_32x32x16_bf16 v[176:191], v[204:207], v[64:67], v[176:191]
  ds_read_b64_tr_b16 v[220:221], v13 offset:4096
  ds_read_b64_tr_b16 v[222:223], v13 offset:6144
  s_waitcnt lgkmcnt(6)
  v_mfma_f32_32x32x16_bf16 v[128:143], v[208:211], v[68:71], v[128:143]
  ds_read_b64_tr_b16 v[192:193], v10 offset:8192
  ds_read_b64_tr_b16 v[194:195], v10 offset:10240
  s_waitcnt lgkmcnt(6)
  v_mfma_f32_32x32x16_bf16 v[144:159], v[212:215], v[68:71], v[144:159]
  ds_read_b64_tr_b16 v[196:197], v11 offset:8192
  ds_read_b64_tr_b16 v[198:199], v11 offset:10240
  s_add_u32 m0, s42, 61440
  s_add_u32 s33, s43, 507904
  buffer_load_dwordx4 v4, s[8:11], s33 offen lds
  s_mov_b32 s34, 28672
  buffer_load_dwordx4 v[124:127], v3, s[12:15], s34 offen offset:3072
  s_waitcnt lgkmcnt(6)
  v_mfma_f32_32x32x16_bf16 v[160:175], v[216:219], v[68:71], v[160:175]
  ds_read_b64_tr_b16 v[200:201], v12 offset:8192
  ds_read_b64_tr_b16 v[202:203], v12 offset:10240
  s_waitcnt lgkmcnt(6)
  v_mfma_f32_32x32x16_bf16 v[176:191], v[220:223], v[68:71], v[176:191]
  ds_read_b64_tr_b16 v[204:205], v13 offset:8192
  ds_read_b64_tr_b16 v[206:207], v13 offset:10240
  s_waitcnt vmcnt(20)
  s_barrier
  s_waitcnt lgkmcnt(6)
  v_mfma_f32_32x32x16_bf16 v[128:143], v[192:195], v[72:75], v[128:143]
  ds_read_b64_tr_b16 v[208:209], v10 offset:12288
  ds_read_b64_tr_b16 v[210:211], v10 offset:14336
  s_waitcnt lgkmcnt(6)
  v_mfma_f32_32x32x16_bf16 v[144:159], v[196:199], v[72:75], v[144:159]
  ds_read_b64_tr_b16 v[212:213], v11 offset:12288
  ds_read_b64_tr_b16 v[214:215], v11 offset:14336
  s_add_u32 m0, s42, 0
  s_add_u32 s33, s43, 524288
  buffer_load_dwordx4 v4, s[8:11], s33 offen lds
  s_mov_b32 s34, 32768
  buffer_load_dwordx4 v[64:67], v3, s[12:15], s34 offen
  s_waitcnt lgkmcnt(6)
  v_mfma_f32_32x32x16_bf16 v[160:175], v[200:203], v[72:75], v[160:175]
  ds_read_b64_tr_b16 v[216:217], v12 offset:12288
  ds_read_b64_tr_b16 v[218:219], v12 offset:14336
  s_waitcnt lgkmcnt(6)
  v_mfma_f32_32x32x16_bf16 v[176:191], v[204:207], v[72:75], v[176:191]
  ds_read_b64_tr_b16 v[220:221], v13 offset:12288
  ds_read_b64_tr_b16 v[222:223], v13 offset:14336
  s_waitcnt lgkmcnt(6)
  v_mfma_f32_32x32x16_bf16 v[128:143], v[208:211], v[76:79], v[128:143]
  ds_read_b64_tr_b16 v[192:193], v10 offset:16384
  ds_read_b64_tr_b16 v[194:195], v10 offset:18432
  s_waitcnt lgkmcnt(6)
  v_mfma_f32_32x32x16_bf16 v[144:159], v[212:215], v[76:79], v[144:159]
  ds_read_b64_tr_b16 v[196:197], v11 offset:16384
  ds_read_b64_tr_b16 v[198:199], v11 offset:18432
  s_add_u32 m0, s42, 4096
  s_add_u32 s33, s43, 540672
  buffer_load_dwordx4 v4, s[8:11], s33 offen lds
  s_mov_b32 s34, 32768
  buffer_load_dwordx4 v[68:71], v3, s[12:15], s34 offen offset:1024
  s_waitcnt lgkmcnt(6)
  v_mfma_f32_32x32x16_bf16 v[160:175], v[216:219], v[76:79], v[160:175]
  ds_read_b64_tr_b16 v[200:201], v12 offset:16384
  ds_read_b64_tr_b16 v[202:203], v12 offset:18432
  s_waitcnt lgkmcnt(6)
  v_mfma_f32_32x32x16_bf16 v[176:191], v[220:223], v[76:79], v[176:191]
  ds_read_b64_tr_b16 v[204:205], v13 offset:16384
  ds_read_b64_tr_b16 v[206:207], v13 offset:18432
  s_waitcnt vmcnt(20)
  s_barrier
  s_waitcnt lgkmcnt(6)
  v_mfma_f32_32x32x16_bf16 v[128:143], v[192:195], v[80:83], v[128:143]
  ds_read_b64_tr_b16 v[208:209], v10 offset:20480
  ds_read_b64_tr_b16 v[210:211], v10 offset:22528
  s_waitcnt lgkmcnt(6)
  v_mfma_f32_32x32x16_bf16 v[144:159], v[196:199], v[80:83], v[144:159]
  ds_read_b64_tr_b16 v[212:213], v11 offset:20480
  ds_read_b64_tr_b16 v[214:215], v11 offset:22528
  s_add_u32 m0, s42, 8192
  s_add_u32 s33, s43, 557056
  buffer_load_dwordx4 v4, s[8:11], s33 offen lds
  s_mov_b32 s34, 32768
  buffer_load_dwordx4 v[72:75], v3, s[12:15], s34 offen offset:2048
  s_waitcnt lgkmcnt(6)
  v_mfma_f32_32x32x16_bf16 v[160:175], v[200:203], v[80:83], v[160:175]
  ds_read_b64_tr_b16 v[216:217], v12 offset:20480
  ds_read_b64_tr_b16 v[218:219], v12 offset:22528
  s_waitcnt lgkmcnt(6)
  v_mfma_f32_32x32x16_bf16 v[176:191], v[204:207], v[80:83], v[176:191]
  ds_read_b64_tr_b16 v[220:221], v13 offset:20480
  ds_read_b64_tr_b16 v[222:223], v13 offset:22528
  s_waitcnt lgkmcnt(6)
  v_mfma_f32_32x32x16_bf16 v[128:143], v[208:211], v[84:87], v[128:143]
  ds_read_b64_tr_b16 v[192:193], v10 offset:24576
  ds_read_b64_tr_b16 v[194:195], v10 offset:26624
  s_waitcnt lgkmcnt(6)
  v_mfma_f32_32x32x16_bf16 v[144:159], v[212:215], v[84:87], v[144:159]
  ds_read_b64_tr_b16 v[196:197], v11 offset:24576
  ds_read_b64_tr_b16 v[198:199], v11 offset:26624
  s_add_u32 m0, s42, 12288
  s_add_u32 s33, s43, 573440
  buffer_load_dwordx4 v4, s[8:11], s33 offen lds
  s_mov_b32 s34, 32768
  buffer_load_dwordx4 v[76:79], v3, s[12:15], s34 offen offset:3072
  s_waitcnt lgkmcnt(6)
  v_mfma_f32_32x32x16_bf16 v[160:175], v[216:219], v[84:87], v[160:175]
  ds_read_b64_tr_b16 v[200:201], v12 offset:24576
  ds_read_b64_tr_b16 v[202:203], v12 offset:26624
  s_waitcnt lgkmcnt(6)
  v_mfma_f32_32x32x16_bf16 v[176:191], v[220:223], v[84:87], v[176:191]
  ds_read_b64_tr_b16 v[204:205], v13 offset:24576
  ds_read_b64_tr_b16 v[206:207], v13 offset:26624
  s_waitcnt vmcnt(20)
  s_barrier
  s_waitcnt lgkmcnt(6)
  v_mfma_f32_32x32x16_bf16 v[128:143], v[192:195], v[88:91], v[128:143]
  ds_read_b64_tr_b16 v[208:209], v10 offset:28672
  ds_read_b64_tr_b16 v[210:211], v10 offset:30720
  s_waitcnt lgkmcnt(6)
  v_mfma_f32_32x32x16_bf16 v[144:159], v[196:199], v[88:91], v[144:159]
  ds_read_b64_tr_b16 v[212:213], v11 offset:28672
  ds_read_b64_tr_b16 v[214:215], v11 offset:30720
  s_add_u32 m0, s42, 16384
  s_add_u32 s33, s43, 589824
  buffer_load_dwordx4 v4, s[8:11], s33 offen lds
  s_mov_b32 s34, 36864
  buffer_load_dwordx4 v[80:83], v3, s[12:15], s34 offen
  s_waitcnt lgkmcnt(6)
  v_mfma_f32_32x32x16_bf16 v[160:175], v[200:203], v[88:91], v[160:175]
  ds_read_b64_tr_b16 v[216:217], v12 offset:28672
  ds_read_b64_tr_b16 v[218:219], v12 offset:30720
  s_waitcnt lgkmcnt(6)
  v_mfma_f32_32x32x16_bf16 v[176:191], v[204:207], v[88:91], v[176:191]
  ds_read_b64_tr_b16 v[220:221], v13 offset:28672
  ds_read_b64_tr_b16 v[222:223], v13 offset:30720
  s_waitcnt lgkmcnt(6)
  v_mfma_f32_32x32x16_bf16 v[128:143], v[208:211], v[92:95], v[128:143]
  ds_read_b64_tr_b16 v[192:193], v10 offset:32768
  ds_read_b64_tr_b16 v[194:195], v10 offset:34816
  s_waitcnt lgkmcnt(6)
  v_mfma_f32_32x32x16_bf16 v[144:159], v[212:215], v[92:95], v[144:159]
  ds_read_b64_tr_b16 v[196:197], v11 offset:32768
  ds_read_b64_tr_b16 v[198:199], v11 offset:34816
  s_add_u32 m0, s42, 20480
  s_add_u32 s33, s43, 606208
  buffer_load_dwordx4 v4, s[8:11], s33 offen lds
  s_mov_b32 s34, 36864
  buffer_load_dwordx4 v[84:87], v3, s[12:15], s34 offen offset:1024
  s_waitcnt lgkmcnt(6)
  v_mfma_f32_32x32x16_bf16 v[160:175], v[216:219], v[92:95], v[160:175]
  ds_read_b64_tr_b16 v[200:201], v12 offset:32768
  ds_read_b64_tr_b16 v[202:203], v12 offset:34816
  s_waitcnt lgkmcnt(6)
  v_mfma_f32_32x32x16_bf16 v[176:191], v[220:223], v[92:95], v[176:191]
  ds_read_b64_tr_b16 v[204:205], v13 offset:32768
  ds_read_b64_tr_b16 v[206:207], v13 offset:34816
  s_waitcnt vmcnt(20)
  s_barrier
  s_waitcnt lgkmcnt(6)
  v_mfma_f32_32x32x16_bf16 v[128:143], v[192:195], v[96:99], v[128:143]
  ds_read_b64_tr_b16 v[208:209], v10 offset:36864
  ds_read_b64_tr_b16 v[210:211], v10 offset:38912
  s_waitcnt lgkmcnt(6)
  v_mfma_f32_32x32x16_bf16 v[144:159], v[196:199], v[96:99], v[144:159]
  ds_read_b64_tr_b16 v[212:213], v11 offset:36864
  ds_read_b64_tr_b16 v[214:215], v11 offset:38912
  s_add_u32 m0, s42, 24576
  s_add_u32 s33, s43, 622592
  buffer_load_dwordx4 v4, s[8:11], s33 offen lds
  s_mov_b32 s34, 36864
  buffer_load_dwordx4 v[88:91], v3, s[12:15], s34 offen offset:2048
  s_waitcnt lgkmcnt(6)
  v_mfma_f32_32x32x16_bf16 v[160:175], v[200:203], v[96:99], v[160:175]
  ds_read_b64_tr_b16 v[216:217], v12 offset:36864
  ds_read_b64_tr_b16 v[218:219], v12 offset:38912
  s_waitcnt lgkmcnt(6)
  v_mfma_f32_32x32x16_bf16 v[176:191], v[204:207], v[96:99], v[176:191]
  ds_read_b64_tr_b16 v[220:221], v13 offset:36864
  ds_read_b64_tr_b16 v[222:223], v13 offset:38912
  s_waitcnt lgkmcnt(6)
  v_mfma_f32_32x32x16_bf16 v[128:143], v[208:211], v[100:103], v[128:143]
  ds_read_b64_tr_b16 v[192:193], v10 offset:40960
  ds_read_b64_tr_b16 v[194:195], v10 offset:43008
  s_waitcnt lgkmcnt(6)
  v_mfma_f32_32x32x16_bf16 v[144:159], v[212:215], v[100:103], v[144:159]
  ds_read_b64_tr_b16 v[196:197], v11 offset:40960
  ds_read_b64_tr_b16 v[198:199], v11 offset:43008
  s_add_u32 m0, s42, 28672
  s_add_u32 s33, s43, 638976
  buffer_load_dwordx4 v4, s[8:11], s33 offen lds
  s_mov_b32 s34, 36864
  buffer_load_dwordx4 v[92:95], v3, s[12:15], s34 offen offset:3072
  s_waitcnt lgkmcnt(6)
  v_mfma_f32_32x32x16_bf16 v[160:175], v[216:219], v[100:103], v[160:175]
  ds_read_b64_tr_b16 v[200:201], v12 offset:40960
  ds_read_b64_tr_b16 v[202:203], v12 offset:43008
  s_waitcnt lgkmcnt(6)
  v_mfma_f32_32x32x16_bf16 v[176:191], v[220:223], v[100:103], v[176:191]
  ds_read_b64_tr_b16 v[204:205], v13 offset:40960
  ds_read_b64_tr_b16 v[206:207], v13 offset:43008
  s_waitcnt vmcnt(20)
  s_barrier
  s_waitcnt lgkmcnt(6)
  v_mfma_f32_32x32x16_bf16 v[128:143], v[192:195], v[104:107], v[128:143]
  ds_read_b64_tr_b16 v[208:209], v10 offset:45056
  ds_read_b64_tr_b16 v[210:211], v10 offset:47104
  s_waitcnt lgkmcnt(6)
  v_mfma_f32_32x32x16_bf16 v[144:159], v[196:199], v[104:107], v[144:159]
  ds_read_b64_tr_b16 v[212:213], v11 offset:45056
  ds_read_b64_tr_b16 v[214:215], v11 offset:47104
  s_add_u32 m0, s42, 32768
  s_add_u32 s33, s43, 655360
  buffer_load_dwordx4 v4, s[8:11], s33 offen lds
  s_mov_b32 s34, 40960
  buffer_load_dwordx4 v[96:99], v3, s[12:15], s34 offen
  s_waitcnt lgkmcnt(6)
  v_mfma_f32_32x32x16_bf16 v[160:175], v[200:203], v[104:107], v[160:175]
  ds_read_b64_tr_b16 v[216:217], v12 offset:45056
  ds_read_b64_tr_b16 v[218:219], v12 offset:47104
  s_waitcnt lgkmcnt(6)
  v_mfma_f32_32x32x16_bf16 v[176:191], v[204:207], v[104:107], v[176:191]
  ds_read_b64_tr_b16 v[220:221], v13 offset:45056
  ds_read_b64_tr_b16 v[222:223], v13 offset:47104
  s_waitcnt lgkmcnt(6)
  v_mfma_f32_32x32x16_bf16 v[128:143], v[208:211], v[108:111], v[128:143]
  ds_read_b64_tr_b16 v[192:193], v10 offset:49152
  ds_read_b64_tr_b16 v[194:195], v10 offset:51200
  s_waitcnt lgkmcnt(6)
  v_mfma_f32_32x32x16_bf16 v[144:159], v[212:215], v[108:111], v[144:159]
  ds_read_b64_tr_b16 v[196:197], v11 offset:49152
  ds_read_b64_tr_b16 v[198:199], v11 offset:51200
  s_add_u32 m0, s42, 36864
  s_add_u32 s33, s43, 671744
  buffer_load_dwordx4 v4, s[8:11], s33 offen lds
  s_mov_b32 s34, 40960
  buffer_load_dwordx4 v[100:103], v3, s[12:15], s34 offen offset:1024
  s_waitcnt lgkmcnt(6)
  v_mfma_f32_32x32x16_bf16 v[160:175], v[216:219], v[108:111], v[160:175]
  ds_read_b64_tr_b16 v[200:201], v12 offset:49152
  ds_read_b64_tr_b16 v[202:203], v12 offset:51200
  s_waitcnt lgkmcnt(6)
  v_mfma_f32_32x32x16_bf16 v[176:191], v[220:223], v[108:111], v[176:191]
  ds_read_b64_tr_b16 v[204:205], v13 offset:49152
  ds_read_b64_tr_b16 v[206:207], v13 offset:51200
  s_waitcnt vmcnt(20)
  s_barrier
  s_waitcnt lgkmcnt(6)
  v_mfma_f32_32x32x16_bf16 v[128:143], v[192:195], v[112:115], v[128:143]
  ds_read_b64_tr_b16 v[208:209], v10 offset:53248
  ds_read_b64_tr_b16 v[210:211], v10 offset:55296
  s_waitcnt lgkmcnt(6)
  v_mfma_f32_32x32x16_bf16 v[144:159], v[196:199], v[112:115], v[144:159]
  ds_read_b64_tr_b16 v[212:213], v11 offset:53248
  ds_read_b64_tr_b16 v[214:215], v11 offset:55296
  s_add_u32 m0, s42, 40960
  s_add_u32 s33, s43, 688128
  buffer_load_dwordx4 v4, s[8:11], s33 offen lds
  s_mov_b32 s34, 40960
  buffer_load_dwordx4 v[104:107], v3, s[12:15], s34 offen offset:2048
  s_waitcnt lgkmcnt(6)
  v_mfma_f32_32x32x16_bf16 v[160:175], v[200:203], v[112:115], v[160:175]
  ds_read_b64_tr_b16 v[216:217], v12 offset:53248
  ds_read_b64_tr_b16 v[218:219], v12 offset:55296
  s_waitcnt lgkmcnt(6)
  v_mfma_f32_32x32x16_bf16 v[176:191], v[204:207], v[112:115], v[176:191]
  ds_read_b64_tr_b16 v[220:221], v13 offset:53248
  ds_read_b64_tr_b16 v[222:223], v13 offset:55296
  s_waitcnt lgkmcnt(6)
  v_mfma_f32_32x32x16_bf16 v[128:143], v[208:211], v[116:119], v[128:143]
  ds_read_b64_tr_b16 v[192:193], v10 offset:57344
  ds_read_b64_tr_b16 v[194:195], v10 offset:59392
  s_waitcnt lgkmcnt(6)
  v_mfma_f32_32x32x16_bf16 v[144:159], v[212:215], v[116:119], v[144:159]
  ds_read_b64_tr_b16 v[196:197], v11 offset:57344
  ds_read_b64_tr_b16 v[198:199], v11 offset:59392
  s_waitcnt lgkmcnt(6)
  v_mfma_f32_32x32x16_bf16 v[160:175], v[216:219], v[116:119], v[160:175]
  ds_read_b64_tr_b16 v[200:201], v12 offset:57344
  ds_read_b64_tr_b16 v[202:203], v12 offset:59392
  s_waitcnt lgkmcnt(6)
  v_mfma_f32_32x32x16_bf16 v[176:191], v[220:223], v[116:119], v[176:191]
  ds_read_b64_tr_b16 v[204:205], v13 offset:57344
  ds_read_b64_tr_b16 v[206:207], v13 offset:59392
  s_waitcnt vmcnt(18)
  s_barrier
  s_waitcnt lgkmcnt(6)
  v_mfma_f32_32x32x16_bf16 v[128:143], v[192:195], v[120:123], v[128:143]
  ds_read_b64_tr_b16 v[208:209], v10 offset:61440
  ds_read_b64_tr_b16 v[210:211], v10 offset:63488
  s_waitcnt lgkmcnt(6)
  v_mfma_f32_32x32x16_bf16 v[144:159], v[196:199], v[120:123], v[144:159]
  ds_read_b64_tr_b16 v[212:213], v11 offset:61440
  ds_read_b64_tr_b16 v[214:215], v11 offset:63488
  s_waitcnt lgkmcnt(6)
  v_mfma_f32_32x32x16_bf16 v[160:175], v[200:203], v[120:123], v[160:175]
  ds_read_b64_tr_b16 v[216:217], v12 offset:61440
  ds_read_b64_tr_b16 v[218:219], v12 offset:63488
  s_waitcnt lgkmcnt(6)
  v_mfma_f32_32x32x16_bf16 v[176:191], v[204:207], v[120:123], v[176:191]
  ds_read_b64_tr_b16 v[220:221], v13 offset:61440
  ds_read_b64_tr_b16 v[222:223], v13 offset:63488
  s_waitcnt lgkmcnt(6)
  v_mfma_f32_32x32x16_bf16 v[128:143], v[208:211], v[124:127], v[128:143]
  ds_read_b64_tr_b16 v[192:193], v10 offset:0
  ds_read_b64_tr_b16 v[194:195], v10 offset:2048
  s_waitcnt lgkmcnt(6)
  v_mfma_f32_32x32x16_bf16 v[144:159], v[212:215], v[124:127], v[144:159]
  ds_read_b64_tr_b16 v[196:197], v11 offset:0
  ds_read_b64_tr_b16 v[198:199], v11 offset:2048
  s_waitcnt lgkmcnt(6)
  v_mfma_f32_32x32x16_bf16 v[160:175], v[216:219], v[124:127], v[160:175]
  ds_read_b64_tr_b16 v[200:201], v12 offset:0
  ds_read_b64_tr_b16 v[202:203], v12 offset:2048
  s_waitcnt lgkmcnt(6)
  v_mfma_f32_32x32x16_bf16 v[176:191], v[220:223], v[124:127], v[176:191]
  ds_read_b64_tr_b16 v[204:205], v13 offset:0
  ds_read_b64_tr_b16 v[206:207], v13 offset:2048
  s_waitcnt vmcnt(14)
  s_barrier
  s_waitcnt lgkmcnt(6)
  v_mfma_f32_32x32x16_bf16 v[128:143], v[192:195], v[64:67], v[128:143]
  ds_read_b64_tr_b16 v[208:209], v10 offset:4096
  ds_read_b64_tr_b16 v[210:211], v10 offset:6144
  s_waitcnt lgkmcnt(6)
  v_mfma_f32_32x32x16_bf16 v[144:159], v[196:199], v[64:67], v[144:159]
  ds_read_b64_tr_b16 v[212:213], v11 offset:4096
  ds_read_b64_tr_b16 v[214:215], v11 offset:6144
  s_waitcnt lgkmcnt(6)
  v_mfma_f32_32x32x16_bf16 v[160:175], v[200:203], v[64:67], v[160:175]
  ds_read_b64_tr_b16 v[216:217], v12 offset:4096
  ds_read_b64_tr_b16 v[218:219], v12 offset:6144
  s_waitcnt lgkmcnt(6)
  v_mfma_f32_32x32x16_bf16 v[176:191], v[204:207], v[64:67], v[176:191]
  ds_read_b64_tr_b16 v[220:221], v13 offset:4096
  ds_read_b64_tr_b16 v[222:223], v13 offset:6144
  s_waitcnt lgkmcnt(6)
  v_mfma_f32_32x32x16_bf16 v[128:143], v[208:211], v[68:71], v[128:143]
  ds_read_b64_tr_b16 v[192:193], v10 offset:8192
  ds_read_b64_tr_b16 v[194:195], v10 offset:10240
  s_waitcnt lgkmcnt(6)
  v_mfma_f32_32x32x16_bf16 v[144:159], v[212:215], v[68:71], v[144:159]
  ds_read_b64_tr_b16 v[196:197], v11 offset:8192
  ds_read_b64_tr_b16 v[198:199], v11 offset:10240
  s_waitcnt lgkmcnt(6)
  v_mfma_f32_32x32x16_bf16 v[160:175], v[216:219], v[68:71], v[160:175]
  ds_read_b64_tr_b16 v[200:201], v12 offset:8192
  ds_read_b64_tr_b16 v[202:203], v12 offset:10240
  s_waitcnt lgkmcnt(6)
  v_mfma_f32_32x32x16_bf16 v[176:191], v[220:223], v[68:71], v[176:191]
  ds_read_b64_tr_b16 v[204:205], v13 offset:8192
  ds_read_b64_tr_b16 v[206:207], v13 offset:10240
  s_waitcnt vmcnt(10)
  s_barrier
  s_waitcnt lgkmcnt(6)
  v_mfma_f32_32x32x16_bf16 v[128:143], v[192:195], v[72:75], v[128:143]
  ds_read_b64_tr_b16 v[208:209], v10 offset:12288
  ds_read_b64_tr_b16 v[210:211], v10 offset:14336
  s_waitcnt lgkmcnt(6)
  v_mfma_f32_32x32x16_bf16 v[144:159], v[196:199], v[72:75], v[144:159]
  ds_read_b64_tr_b16 v[212:213], v11 offset:12288
  ds_read_b64_tr_b16 v[214:215], v11 offset:14336
  s_waitcnt lgkmcnt(6)
  v_mfma_f32_32x32x16_bf16 v[160:175], v[200:203], v[72:75], v[160:175]
  ds_read_b64_tr_b16 v[216:217], v12 offset:12288
  ds_read_b64_tr_b16 v[218:219], v12 offset:14336
  s_waitcnt lgkmcnt(6)
  v_mfma_f32_32x32x16_bf16 v[176:191], v[204:207], v[72:75], v[176:191]
  ds_read_b64_tr_b16 v[220:221], v13 offset:12288
  ds_read_b64_tr_b16 v[222:223], v13 offset:14336
  s_waitcnt lgkmcnt(6)
  v_mfma_f32_32x32x16_bf16 v[128:143], v[208:211], v[76:79], v[128:143]
  ds_read_b64_tr_b16 v[192:193], v10 offset:16384
  ds_read_b64_tr_b16 v[194:195], v10 offset:18432
  s_waitcnt lgkmcnt(6)
  v_mfma_f32_32x32x16_bf16 v[144:159], v[212:215], v[76:79], v[144:159]
  ds_read_b64_tr_b16 v[196:197], v11 offset:16384
  ds_read_b64_tr_b16 v[198:199], v11 offset:18432
  s_waitcnt lgkmcnt(6)
  v_mfma_f32_32x32x16_bf16 v[160:175], v[216:219], v[76:79], v[160:175]
  ds_read_b64_tr_b16 v[200:201], v12 offset:16384
  ds_read_b64_tr_b16 v[202:203], v12 offset:18432
  s_waitcnt lgkmcnt(6)
  v_mfma_f32_32x32x16_bf16 v[176:191], v[220:223], v[76:79], v[176:191]
  ds_read_b64_tr_b16 v[204:205], v13 offset:16384
  ds_read_b64_tr_b16 v[206:207], v13 offset:18432
  s_waitcnt vmcnt(6)
  s_barrier
  s_waitcnt lgkmcnt(6)
  v_mfma_f32_32x32x16_bf16 v[128:143], v[192:195], v[80:83], v[128:143]
  ds_read_b64_tr_b16 v[208:209], v10 offset:20480
  ds_read_b64_tr_b16 v[210:211], v10 offset:22528
  s_waitcnt lgkmcnt(6)
  v_mfma_f32_32x32x16_bf16 v[144:159], v[196:199], v[80:83], v[144:159]
  ds_read_b64_tr_b16 v[212:213], v11 offset:20480
  ds_read_b64_tr_b16 v[214:215], v11 offset:22528
  s_waitcnt lgkmcnt(6)
  v_mfma_f32_32x32x16_bf16 v[160:175], v[200:203], v[80:83], v[160:175]
  ds_read_b64_tr_b16 v[216:217], v12 offset:20480
  ds_read_b64_tr_b16 v[218:219], v12 offset:22528
  s_waitcnt lgkmcnt(6)
  v_mfma_f32_32x32x16_bf16 v[176:191], v[204:207], v[80:83], v[176:191]
  ds_read_b64_tr_b16 v[220:221], v13 offset:20480
  ds_read_b64_tr_b16 v[222:223], v13 offset:22528
  s_waitcnt lgkmcnt(6)
  v_mfma_f32_32x32x16_bf16 v[128:143], v[208:211], v[84:87], v[128:143]
  ds_read_b64_tr_b16 v[192:193], v10 offset:24576
  ds_read_b64_tr_b16 v[194:195], v10 offset:26624
  s_waitcnt lgkmcnt(6)
  v_mfma_f32_32x32x16_bf16 v[144:159], v[212:215], v[84:87], v[144:159]
  ds_read_b64_tr_b16 v[196:197], v11 offset:24576
  ds_read_b64_tr_b16 v[198:199], v11 offset:26624
  s_waitcnt lgkmcnt(6)
  v_mfma_f32_32x32x16_bf16 v[160:175], v[216:219], v[84:87], v[160:175]
  ds_read_b64_tr_b16 v[200:201], v12 offset:24576
  ds_read_b64_tr_b16 v[202:203], v12 offset:26624
  s_waitcnt lgkmcnt(6)
  v_mfma_f32_32x32x16_bf16 v[176:191], v[220:223], v[84:87], v[176:191]
  ds_read_b64_tr_b16 v[204:205], v13 offset:24576
  ds_read_b64_tr_b16 v[206:207], v13 offset:26624
  s_waitcnt vmcnt(2)
  s_barrier
  s_waitcnt lgkmcnt(6)
  v_mfma_f32_32x32x16_bf16 v[128:143], v[192:195], v[88:91], v[128:143]
  ds_read_b64_tr_b16 v[208:209], v10 offset:28672
  ds_read_b64_tr_b16 v[210:211], v10 offset:30720
  s_waitcnt lgkmcnt(6)
  v_mfma_f32_32x32x16_bf16 v[144:159], v[196:199], v[88:91], v[144:159]
  ds_read_b64_tr_b16 v[212:213], v11 offset:28672
  ds_read_b64_tr_b16 v[214:215], v11 offset:30720
  s_waitcnt lgkmcnt(6)
  v_mfma_f32_32x32x16_bf16 v[160:175], v[200:203], v[88:91], v[160:175]
  ds_read_b64_tr_b16 v[216:217], v12 offset:28672
  ds_read_b64_tr_b16 v[218:219], v12 offset:30720
  s_waitcnt lgkmcnt(6)
  v_mfma_f32_32x32x16_bf16 v[176:191], v[204:207], v[88:91], v[176:191]
  ds_read_b64_tr_b16 v[220:221], v13 offset:28672
  ds_read_b64_tr_b16 v[222:223], v13 offset:30720
  s_waitcnt lgkmcnt(6)
  v_mfma_f32_32x32x16_bf16 v[128:143], v[208:211], v[92:95], v[128:143]
  ds_read_b64_tr_b16 v[192:193], v10 offset:32768
  ds_read_b64_tr_b16 v[194:195], v10 offset:34816
  s_waitcnt lgkmcnt(6)
  v_mfma_f32_32x32x16_bf16 v[144:159], v[212:215], v[92:95], v[144:159]
  ds_read_b64_tr_b16 v[196:197], v11 offset:32768
  ds_read_b64_tr_b16 v[198:199], v11 offset:34816
  s_waitcnt lgkmcnt(6)
  v_mfma_f32_32x32x16_bf16 v[160:175], v[216:219], v[92:95], v[160:175]
  ds_read_b64_tr_b16 v[200:201], v12 offset:32768
  ds_read_b64_tr_b16 v[202:203], v12 offset:34816
  s_waitcnt lgkmcnt(6)
  v_mfma_f32_32x32x16_bf16 v[176:191], v[220:223], v[92:95], v[176:191]
  ds_read_b64_tr_b16 v[204:205], v13 offset:32768
  ds_read_b64_tr_b16 v[206:207], v13 offset:34816
  s_waitcnt vmcnt(0)
  s_barrier
  s_waitcnt lgkmcnt(6)
  v_mfma_f32_32x32x16_bf16 v[128:143], v[192:195], v[96:99], v[128:143]
  ds_read_b64_tr_b16 v[208:209], v10 offset:36864
  ds_read_b64_tr_b16 v[210:211], v10 offset:38912
  s_waitcnt lgkmcnt(6)
  v_mfma_f32_32x32x16_bf16 v[144:159], v[196:199], v[96:99], v[144:159]
  ds_read_b64_tr_b16 v[212:213], v11 offset:36864
  ds_read_b64_tr_b16 v[214:215], v11 offset:38912
  s_waitcnt lgkmcnt(6)
  v_mfma_f32_32x32x16_bf16 v[160:175], v[200:203], v[96:99], v[160:175]
  ds_read_b64_tr_b16 v[216:217], v12 offset:36864
  ds_read_b64_tr_b16 v[218:219], v12 offset:38912
  s_waitcnt lgkmcnt(6)
  v_mfma_f32_32x32x16_bf16 v[176:191], v[204:207], v[96:99], v[176:191]
  ds_read_b64_tr_b16 v[220:221], v13 offset:36864
  ds_read_b64_tr_b16 v[222:223], v13 offset:38912
  s_waitcnt lgkmcnt(6)
  v_mfma_f32_32x32x16_bf16 v[128:143], v[208:211], v[100:103], v[128:143]
  ds_read_b64_tr_b16 v[192:193], v10 offset:40960
  ds_read_b64_tr_b16 v[194:195], v10 offset:43008
  s_waitcnt lgkmcnt(6)
  v_mfma_f32_32x32x16_bf16 v[144:159], v[212:215], v[100:103], v[144:159]
  ds_read_b64_tr_b16 v[196:197], v11 offset:40960
  ds_read_b64_tr_b16 v[198:199], v11 offset:43008
  s_waitcnt lgkmcnt(6)
  v_mfma_f32_32x32x16_bf16 v[160:175], v[216:219], v[100:103], v[160:175]
  ds_read_b64_tr_b16 v[200:201], v12 offset:40960
  ds_read_b64_tr_b16 v[202:203], v12 offset:43008
  s_waitcnt lgkmcnt(6)
  v_mfma_f32_32x32x16_bf16 v[176:191], v[220:223], v[100:103], v[176:191]
  ds_read_b64_tr_b16 v[204:205], v13 offset:40960
  ds_read_b64_tr_b16 v[206:207], v13 offset:43008
  s_waitcnt vmcnt(0)
  s_barrier
  s_waitcnt lgkmcnt(6)
  v_mfma_f32_32x32x16_bf16 v[128:143], v[192:195], v[104:107], v[128:143]
  s_waitcnt lgkmcnt(4)
  v_mfma_f32_32x32x16_bf16 v[144:159], v[196:199], v[104:107], v[144:159]
  s_waitcnt lgkmcnt(2)
  v_mfma_f32_32x32x16_bf16 v[160:175], v[200:203], v[104:107], v[160:175]
  s_waitcnt lgkmcnt(0)
  v_mfma_f32_32x32x16_bf16 v[176:191], v[204:207], v[104:107], v[176:191]
  buffer_load_dwordx4 v[20:23], v3, s[24:27], s45 offen
  buffer_load_dwordx2 v[24:25], v16, s[20:23], s46 offen
  buffer_load_dwordx2 v[26:27], v16, s[20:23], s46 offen offset:16
  s_lshl_b32 s33, s32, 13
  v_add_u32 v17, s33, v3
  s_xor_b32 s33, s33, 0x8000
  v_add_u32 v18, s33, v3
  s_barrier
  s_nop 7
  ds_write_b128 v17, v[160:163] offset:0
  ds_write_b128 v17, v[164:167] offset:1024
  ds_write_b128 v17, v[168:171] offset:2048
  ds_write_b128 v17, v[172:175] offset:3072
  ds_write_b128 v17, v[176:179] offset:4096
  ds_write_b128 v17, v[180:183] offset:5120
  ds_write_b128 v17, v[184:187] offset:6144
  ds_write_b128 v17, v[188:191] offset:7168
  s_waitcnt lgkmcnt(0)
  s_barrier
  ds_read_b128 v[64:67], v18 offset:0
  ds_read_b128 v[68:71], v18 offset:1024
  ds_read_b128 v[72:75], v18 offset:2048
  ds_read_b128 v[76:79], v18 offset:3072
  ds_read_b128 v[80:83], v18 offset:4096
  ds_read_b128 v[84:87], v18 offset:5120
  ds_read_b128 v[88:91], v18 offset:6144
  ds_read_b128 v[92:95], v18 offset:7168
  s_waitcnt lgkmcnt(7)
  v_add_f32 v128, v128, v64
  v_add_f32 v129, v129, v65
  v_add_f32 v130, v130, v66
  v_add_f32 v131, v131, v67
  s_waitcnt lgkmcnt(6)
  v_add_f32 v132, v132, v68
  v_add_f32 v133, v133, v69
  v_add_f32 v134, v134, v70
  v_add_f32 v135, v135, v71
  s_waitcnt lgkmcnt(5)
  v_add_f32 v136, v136, v72
  v_add_f32 v137, v137, v73
  v_add_f32 v138, v138, v74
  v_add_f32 v139, v139, v75
  s_waitcnt lgkmcnt(4)
  v_add_f32 v140, v140, v76
  v_add_f32 v141, v141, v77
  v_add_f32 v142, v142, v78
  v_add_f32 v143, v143, v79
  s_waitcnt lgkmcnt(3)
  v_add_f32 v144, v144, v80
  v_add_f32 v145, v145, v81
  v_add_f32 v146, v146, v82
  v_add_f32 v147, v147, v83
  s_waitcnt lgkmcnt(2)
  v_add_f32 v148, v148, v84
  v_add_f32 v149, v149, v85
  v_add_f32 v150, v150, v86
  v_add_f32 v151, v151, v87
  s_waitcnt lgkmcnt(1)
  v_add_f32 v152, v152, v88
  v_add_f32 v153, v153, v89
  v_add_f32 v154, v154, v90
  v_add_f32 v155, v155, v91
  s_waitcnt lgkmcnt(0)
  v_add_f32 v156, v156, v92
  v_add_f32 v157, v157, v93
  v_add_f32 v158, v158, v94
  v_add_f32 v159, v159, v95
  s_cmp_eq_u32 s38, s35
  s_cbranch_scc1 out_kernel_own
  s_lshl_b32 s33, s36, 2
  s_add_u32 s33, s33, s37
  s_lshl_b32 s33, s33, 2
  s_add_u32 s33, s33, s38
  s_mul_i32 s33, s33, 3
  s_xor_b32 s34, s38, s35
  s_add_u32 s33, s33, s34
  s_sub_u32 s33, s33, 1
  s_lshl_b32 s33, s33, 13
  s_lshl_b32 s34, s39, 12
  s_add_u32 s33, s33, s34
  v_cvt_pk_bf16_f32 v32, v128, v129
  v_cvt_pk_bf16_f32 v33, v130, v131
  v_cvt_pk_bf16_f32 v34, v132, v133
  v_cvt_pk_bf16_f32 v35, v134, v135
  buffer_store_dwordx4 v[32:35], v3, s[28:31], s33 offen sc1
  v_cvt_pk_bf16_f32 v36, v136, v137
  v_cvt_pk_bf16_f32 v37, v138, v139
  v_cvt_pk_bf16_f32 v38, v140, v141
  v_cvt_pk_bf16_f32 v39, v142, v143
  buffer_store_dwordx4 v[36:39], v3, s[28:31], s33 offen offset:1024 sc1
  v_cvt_pk_bf16_f32 v40, v144, v145
  v_cvt_pk_bf16_f32 v41, v146, v147
  v_cvt_pk_bf16_f32 v42, v148, v149
  v_cvt_pk_bf16_f32 v43, v150, v151
  buffer_store_dwordx4 v[40:43], v3, s[28:31], s33 offen offset:2048 sc1
  v_cvt_pk_bf16_f32 v44, v152, v153
  v_cvt_pk_bf16_f32 v45, v154, v155
  v_cvt_pk_bf16_f32 v46, v156, v157
  v_cvt_pk_bf16_f32 v47, v158, v159
  buffer_store_dwordx4 v[44:47], v3, s[28:31], s33 offen offset:3072 sc1
  s_branch out_kernel_pub
out_kernel_own:
  s_lshl_b32 s33, s39, 13
  s_add_u32 s33, s33, 65536
  v_add_u32 v17, s33, v3
  ds_write_b128 v17, v[128:131] offset:0
  ds_write_b128 v17, v[132:135] offset:1024
  ds_write_b128 v17, v[136:139] offset:2048
  ds_write_b128 v17, v[140:143] offset:3072
  ds_write_b128 v17, v[144:147] offset:4096
  ds_write_b128 v17, v[148:151] offset:5120
  ds_write_b128 v17, v[152:155] offset:6144
  ds_write_b128 v17, v[156:159] offset:7168
out_kernel_pub:
  s_lshl_b32 s33, s32, 11
  s_add_u32 s33, s33, 65536
  v_add_u32 v18, s33, v3
  s_lshl_b32 s33, s36, 2
  s_add_u32 s33, s33, s37
  s_lshl_b32 s33, s33, 2
  s_add_u32 s33, s33, s35
  s_mul_i32 s33, s33, 24576
  s_mul_i32 s34, s32, 1024
  s_add_u32 s33, s33, s34
  s_add_u32 s34, s33, 8192
  s_add_u32 s43, s33, 16384
  s_waitcnt lgkmcnt(0)
  s_barrier
  ds_read_b128 v[64:67], v18 offset:0
  ds_read_b128 v[68:71], v18 offset:1024
  s_mov_b32 s44, 16384
out_kernel_spin:
  buffer_load_dwordx4 v[52:55], v3, s[28:31], s33 offen sc1
  buffer_load_dwordx4 v[56:59], v3, s[28:31], s34 offen sc1
  buffer_load_dwordx4 v[60:63], v3, s[28:31], s43 offen sc1
  s_waitcnt vmcnt(0)
  v_max3_u32 v19, v52, v53, v54
  v_max3_u32 v19, v19, v55, v56
  v_max3_u32 v19, v19, v57, v58
  v_max3_u32 v19, v19, v59, v60
  v_max3_u32 v19, v19, v61, v62
  v_max_u32 v19, v19, v63
  v_cmp_eq_u32 vcc, -1, v19
  s_nop 1
  s_cbranch_vccz out_kernel_ok
  s_sub_u32 s44, s44, 1
  s_cbranch_scc1 out_kernel_ok
  s_sleep 4
  s_branch out_kernel_spin
out_kernel_ok:
  v_lshlrev_b32 v72, 16, v52
  v_and_b32 v73, 0xffff0000, v52
  v_lshlrev_b32 v74, 16, v53
  v_and_b32 v75, 0xffff0000, v53
  v_lshlrev_b32 v76, 16, v54
  v_and_b32 v77, 0xffff0000, v54
  v_lshlrev_b32 v78, 16, v55
  v_and_b32 v79, 0xffff0000, v55
  v_lshlrev_b32 v80, 16, v56
  v_and_b32 v81, 0xffff0000, v56
  v_lshlrev_b32 v82, 16, v57
  v_and_b32 v83, 0xffff0000, v57
  v_lshlrev_b32 v84, 16, v58
  v_and_b32 v85, 0xffff0000, v58
  v_lshlrev_b32 v86, 16, v59
  v_and_b32 v87, 0xffff0000, v59
  v_lshlrev_b32 v88, 16, v60
  v_and_b32 v89, 0xffff0000, v60
  v_lshlrev_b32 v90, 16, v61
  v_and_b32 v91, 0xffff0000, v61
  v_lshlrev_b32 v92, 16, v62
  v_and_b32 v93, 0xffff0000, v62
  v_lshlrev_b32 v94, 16, v63
  v_and_b32 v95, 0xffff0000, v63
  s_waitcnt lgkmcnt(0)
  s_cmp_eq_u32 s35, 1
  s_cbranch_scc1 out_kernel_r1
  s_cmp_eq_u32 s35, 2
  s_cbranch_scc1 out_kernel_r2
  s_cmp_eq_u32 s35, 3
  s_cbranch_scc1 out_kernel_r3
out_kernel_r0:
  v_add_f32 v96, v64, v72
  v_add_f32 v97, v65, v73
  v_add_f32 v98, v66, v74
  v_add_f32 v99, v67, v75
  v_add_f32 v100, v68, v76
  v_add_f32 v101, v69, v77
  v_add_f32 v102, v70, v78
  v_add_f32 v103, v71, v79
  v_add_f32 v96, v96, v80
  v_add_f32 v97, v97, v81
  v_add_f32 v98, v98, v82
  v_add_f32 v99, v99, v83
  v_add_f32 v100, v100, v84
  v_add_f32 v101, v101, v85
  v_add_f32 v102, v102, v86
  v_add_f32 v103, v103, v87
  v_lshlrev_b32 v32, 16, v20
  v_and_b32 v33, 0xffff0000, v20
  v_lshlrev_b32 v34, 16, v21
  v_and_b32 v35, 0xffff0000, v21
  v_lshlrev_b32 v36, 16, v22
  v_and_b32 v37, 0xffff0000, v22
  v_lshlrev_b32 v38, 16, v23
  v_and_b32 v39, 0xffff0000, v23
  v_add_f32 v104, v88, v32
  v_add_f32 v105, v89, v33
  v_add_f32 v106, v90, v34
  v_add_f32 v107, v91, v35
  v_add_f32 v108, v92, v36
  v_add_f32 v109, v93, v37
  v_add_f32 v110, v94, v38
  v_add_f32 v111, v95, v39
  s_branch out_kernel_fin
out_kernel_r1:
  v_add_f32 v96, v64, v72
  v_add_f32 v97, v65, v73
  v_add_f32 v98, v66, v74
  v_add_f32 v99, v67, v75
  v_add_f32 v100, v68, v76
  v_add_f32 v101, v69, v77
  v_add_f32 v102, v70, v78
  v_add_f32 v103, v71, v79
  v_add_f32 v96, v96, v88
  v_add_f32 v97, v97, v89
  v_add_f32 v98, v98, v90
  v_add_f32 v99, v99, v91
  v_add_f32 v100, v100, v92
  v_add_f32 v101, v101, v93
  v_add_f32 v102, v102, v94
  v_add_f32 v103, v103, v95
  v_lshlrev_b32 v32, 16, v20
  v_and_b32 v33, 0xffff0000, v20
  v_lshlrev_b32 v34, 16, v21
  v_and_b32 v35, 0xffff0000, v21
  v_lshlrev_b32 v36, 16, v22
  v_and_b32 v37, 0xffff0000, v22
  v_lshlrev_b32 v38, 16, v23
  v_and_b32 v39, 0xffff0000, v23
  v_add_f32 v104, v80, v32
  v_add_f32 v105, v81, v33
  v_add_f32 v106, v82, v34
  v_add_f32 v107, v83, v35
  v_add_f32 v108, v84, v36
  v_add_f32 v109, v85, v37
  v_add_f32 v110, v86, v38
  v_add_f32 v111, v87, v39
  s_branch out_kernel_fin
out_kernel_r2:
  v_add_f32 v96, v64, v80
  v_add_f32 v97, v65, v81
  v_add_f32 v98, v66, v82
  v_add_f32 v99, v67, v83
  v_add_f32 v100, v68, v84
  v_add_f32 v101, v69, v85
  v_add_f32 v102, v70, v86
  v_add_f32 v103, v71, v87
  v_add_f32 v96, v96, v88
  v_add_f32 v97, v97, v89
  v_add_f32 v98, v98, v90
  v_add_f32 v99, v99, v91
  v_add_f32 v100, v100, v92
  v_add_f32 v101, v101, v93
  v_add_f32 v102, v102, v94
  v_add_f32 v103, v103, v95
  v_lshlrev_b32 v32, 16, v20
  v_and_b32 v33, 0xffff0000, v20
  v_lshlrev_b32 v34, 16, v21
  v_and_b32 v35, 0xffff0000, v21
  v_lshlrev_b32 v36, 16, v22
  v_and_b32 v37, 0xffff0000, v22
  v_lshlrev_b32 v38, 16, v23
  v_and_b32 v39, 0xffff0000, v23
  v_add_f32 v104, v72, v32
  v_add_f32 v105, v73, v33
  v_add_f32 v106, v74, v34
  v_add_f32 v107, v75, v35
  v_add_f32 v108, v76, v36
  v_add_f32 v109, v77, v37
  v_add_f32 v110, v78, v38
  v_add_f32 v111, v79, v39
  s_branch out_kernel_fin
out_kernel_r3:
  v_add_f32 v96, v72, v80
  v_add_f32 v97, v73, v81
  v_add_f32 v98, v74, v82
  v_add_f32 v99, v75, v83
  v_add_f32 v100, v76, v84
  v_add_f32 v101, v77, v85
  v_add_f32 v102, v78, v86
  v_add_f32 v103, v79, v87
  v_add_f32 v96, v96, v88
  v_add_f32 v97, v97, v89
  v_add_f32 v98, v98, v90
  v_add_f32 v99, v99, v91
  v_add_f32 v100, v100, v92
  v_add_f32 v101, v101, v93
  v_add_f32 v102, v102, v94
  v_add_f32 v103, v103, v95
  v_lshlrev_b32 v32, 16, v20
  v_and_b32 v33, 0xffff0000, v20
  v_lshlrev_b32 v34, 16, v21
  v_and_b32 v35, 0xffff0000, v21
  v_lshlrev_b32 v36, 16, v22
  v_and_b32 v37, 0xffff0000, v22
  v_lshlrev_b32 v38, 16, v23
  v_and_b32 v39, 0xffff0000, v23
  v_add_f32 v104, v64, v32
  v_add_f32 v105, v65, v33
  v_add_f32 v106, v66, v34
  v_add_f32 v107, v67, v35
  v_add_f32 v108, v68, v36
  v_add_f32 v109, v69, v37
  v_add_f32 v110, v70, v38
  v_add_f32 v111, v71, v39
out_kernel_fin:
  v_lshlrev_b32 v40, 16, v24
  v_and_b32 v41, 0xffff0000, v24
  v_lshlrev_b32 v42, 16, v25
  v_and_b32 v43, 0xffff0000, v25
  v_lshlrev_b32 v44, 16, v26
  v_and_b32 v45, 0xffff0000, v26
  v_lshlrev_b32 v46, 16, v27
  v_and_b32 v47, 0xffff0000, v27
  v_mul_f32 v32, 0xbfb8aa3b, v104
  v_mul_f32 v33, 0xbfb8aa3b, v105
  v_mul_f32 v34, 0xbfb8aa3b, v106
  v_mul_f32 v35, 0xbfb8aa3b, v107
  v_mul_f32 v36, 0xbfb8aa3b, v108
  v_mul_f32 v37, 0xbfb8aa3b, v109
  v_mul_f32 v38, 0xbfb8aa3b, v110
  v_mul_f32 v39, 0xbfb8aa3b, v111
  v_exp_f32 v32, v32
  v_exp_f32 v33, v33
  v_exp_f32 v34, v34
  v_exp_f32 v35, v35
  v_exp_f32 v36, v36
  v_exp_f32 v37, v37
  v_exp_f32 v38, v38
  v_exp_f32 v39, v39
  s_nop 0
  v_add_f32 v32, 1.0, v32
  v_add_f32 v33, 1.0, v33
  v_add_f32 v34, 1.0, v34
  v_add_f32 v35, 1.0, v35
  v_add_f32 v36, 1.0, v36
  v_add_f32 v37, 1.0, v37
  v_add_f32 v38, 1.0, v38
  v_add_f32 v39, 1.0, v39
  v_rcp_f32 v32, v32
  v_rcp_f32 v33, v33
  v_rcp_f32 v34, v34
  v_rcp_f32 v35, v35
  v_rcp_f32 v36, v36
  v_rcp_f32 v37, v37
  v_rcp_f32 v38, v38
  v_rcp_f32 v39, v39
  s_nop 0
  v_mul_f32 v32, v32, v104
  v_mul_f32 v33, v33, v105
  v_mul_f32 v34, v34, v106
  v_mul_f32 v35, v35, v107
  v_mul_f32 v36, v36, v108
  v_mul_f32 v37, v37, v109
  v_mul_f32 v38, v38, v110
  v_mul_f32 v39, v39, v111
  v_fma_f32 v40, v96, v32, v40
  v_fma_f32 v41, v97, v33, v41
  v_fma_f32 v42, v98, v34, v42
  v_fma_f32 v43, v99, v35, v43
  v_fma_f32 v44, v100, v36, v44
  v_fma_f32 v45, v101, v37, v45
  v_fma_f32 v46, v102, v38, v46
  v_fma_f32 v47, v103, v39, v47
  v_cvt_pk_bf16_f32 v48, v40, v41
  v_cvt_pk_bf16_f32 v49, v42, v43
  v_cvt_pk_bf16_f32 v50, v44, v45
  v_cvt_pk_bf16_f32 v51, v46, v47
  v_mul_u32_u24 v40, 272, v5
  v_lshl_add_u32 v40, v6, 3, v40
  s_lshl_b32 s33, s32, 5
  v_add_u32 v40, s33, v40
  ds_write_b64 v40, v[48:49]
  ds_write_b64 v40, v[50:51] offset:16
  s_sub_u32 s46, s46, s33
  s_lshl_b32 s33, s32, 2
  v_lshrrev_b32 v41, 4, v2
  v_add_u32 v41, s33, v41
  v_and_b32 v42, 15, v2
  v_lshlrev_b32 v42, 4, v42
  v_lshl_add_u32 v43, v41, 10, v42
  v_mul_u32_u24 v41, 272, v41
  v_add_u32 v41, v41, v42
  s_waitcnt lgkmcnt(0)
  s_barrier
  ds_read_b128 v[44:47], v41
  s_waitcnt lgkmcnt(0)
  buffer_store_dwordx4 v[44:47], v43, s[16:19], s46 offen
out_kernel_done:
  s_endpgm
.section .rodata,"a"
.p2align 6
.amdhsa_kernel main_kernel
  .amdhsa_next_free_vgpr 256
  .amdhsa_next_free_sgpr 102
  .amdhsa_accum_offset 256
  .amdhsa_group_segment_fixed_size 0
  .amdhsa_kernarg_size 112
  .amdhsa_user_sgpr_count 2
  .amdhsa_user_sgpr_kernarg_segment_ptr 1
  .amdhsa_system_sgpr_workgroup_id_x 1
.end_amdhsa_kernel
.p2align 6
.amdhsa_kernel out_kernel
  .amdhsa_next_free_vgpr 256
  .amdhsa_next_free_sgpr 102
  .amdhsa_accum_offset 256
  .amdhsa_group_segment_fixed_size 0
  .amdhsa_kernarg_size 112
  .amdhsa_user_sgpr_count 2
  .amdhsa_user_sgpr_kernarg_segment_ptr 1
  .amdhsa_system_sgpr_workgroup_id_x 1
.end_amdhsa_kernel
```
